```python
import torch

def _softmax(x, axis=-1):
    return torch.softmax(x, dim=axis)

def _gelu(x):
    return torch.nn.functional.gelu(x, approximate='tanh')

def _silu(x):
    return torch.nn.functional.silu(x)

def _sigmoid(x):
    return torch.sigmoid(x)

def _layernorm(x, axis=-1, eps=1e-05):
    m = x.mean(dim=axis, keepdim=True)
    v = x.var(dim=axis, keepdim=True, unbiased=False)
    return (x - m) / torch.sqrt(v + eps)

def _scatter_add(tgt, idx, src, axis=0):
    return tgt.clone().index_add_(axis, idx, src)

def _segment_sum(src, seg, n):
    out = torch.zeros((n,) + src.shape[1:], dtype=src.dtype)
    return out.index_add_(0, seg, src)

def _pad(x, pw):
    flat = tuple((v for pair in reversed(pw) for v in pair))
    return torch.nn.functional.pad(x, flat)
kernel_name = 'gated_mix__memory_aug_recurrent_mem_tr__glu_gated_bilinear__prompt'

def setup_inputs():

    _w = lambda a: (lambda t: t.to(torch.bfloat16) if t.is_floating_point() else t)(torch.as_tensor(a))

    def _A_setup():
        B, S, Dm = (1, 2048, 640)
        H, Dh = (32, 128)
        M, seg = (8, 32)
        seg = min(seg, S)
        S = S // seg * seg
        return {'x': _w((lambda *s: torch.randn(*s, dtype=torch.bfloat16) * 0.05)(B, S, Dm)), 'mem0': _w((lambda *s: torch.randn(*s, dtype=torch.bfloat16) * 0.4)(B, M, Dm)), 'Wq': _w((lambda *s: torch.randn(*s, dtype=torch.bfloat16) * 6.4)(Dm, H, Dh) * Dm ** (-0.5)), 'Wk': _w((lambda *s: torch.randn(*s, dtype=torch.bfloat16) * 6.4)(Dm, H, Dh) * Dm ** (-0.5)), 'Wv': _w((lambda *s: torch.randn(*s, dtype=torch.bfloat16) * 0.4)(Dm, H, Dh) * Dm ** (-0.5)), 'Wo': _w((lambda *s: torch.randn(*s, dtype=torch.bfloat16) * 0.4)(H, Dh, Dm) * (H * Dh) ** (-0.5)), 'seg_len': seg}
    _A_in = _A_setup()

    def _B_setup():
        B, S, D, F = (1, 2048, 640, 1728)
        return {'x': _w((lambda *s: torch.randn(*s, dtype=torch.bfloat16) * 0.05)(B, S, D)), 'w_gate': _w((lambda *s: torch.randn(*s, dtype=torch.bfloat16) * 1.6)(D, F) * D ** (-0.5)), 'w_up': _w((lambda *s: torch.randn(*s, dtype=torch.bfloat16) * 1.6)(D, F) * D ** (-0.5)), 'w_down': _w((lambda *s: torch.randn(*s, dtype=torch.bfloat16) * 1.6)(F, D) * F ** (-0.5))}
    _B_in = _B_setup()
    return {'A_x': _A_in['x'], 'A_mem0': _A_in['mem0'], 'A_Wq': _A_in['Wq'], 'A_Wk': _A_in['Wk'], 'A_Wv': _A_in['Wv'], 'A_Wo': _A_in['Wo'], 'A_seg_len': _A_in['seg_len'], 'B_x': _B_in['x'], 'B_w_gate': _B_in['w_gate'], 'B_w_up': _B_in['w_up'], 'B_w_down': _B_in['w_down'], 'gate_w': _w((lambda *s: torch.randn(*s, dtype=torch.bfloat16) * 0.05)(640) * 16.0)}

def reference(A_x, A_mem0, A_Wq, A_Wk, A_Wv, A_Wo, A_seg_len, B_x, B_w_gate, B_w_up, B_w_down, gate_w):

    def _A_ref(x, mem0, Wq, Wk, Wv, Wo, seg_len):
        B, S, Dm = x.shape
        H, Dh = (Wq.shape[1], Wq.shape[2])
        M = mem0.shape[1]
        scale = Dh ** (-0.5)
        n_seg = S // seg_len
        L = M + seg_len
        idx = torch.arange(L)
        mask = (idx[:, None] < M) | (idx[:, None] >= idx[None, :])
        mem = mem0
        outs = []
        for s in range(n_seg):
            xs = x[:, s * seg_len:(s + 1) * seg_len, :].clone()
            h = torch.concatenate([mem, xs], axis=1)
            q = torch.einsum('btd,dhe->bhte', h, Wq)
            k = torch.einsum('btd,dhe->bhte', h, Wk)
            v = torch.einsum('btd,dhe->bhte', h, Wv)
            scores = torch.einsum('bhqe,bhke->bhqk', q, k) * scale
            scores = torch.where(mask[None, None], scores, -1000000000.0)
            p = _softmax(scores, axis=-1)
            o = torch.einsum('bhqk,bhke->bhqe', p, v)
            o = torch.einsum('bhte,hed->btd', o, Wo)
            mem = o[:, :M, :].clone()
            outs.append(o[:, M:, :])
        return torch.concatenate(outs, axis=1)

    def _B_ref(x, w_gate, w_up, w_down):
        g = torch.einsum('bsd,df->bsf', x, w_gate)
        u = torch.einsum('bsd,df->bsf', x, w_up)
        h = g * u
        return torch.einsum('bsf,fd->bsd', h, w_down)
    x = A_x
    g = _sigmoid((x * gate_w).sum(-1, keepdims=True))
    a = _A_ref(x, A_mem0, A_Wq, A_Wk, A_Wv, A_Wo, A_seg_len)
    b = _B_ref(x, B_w_gate, B_w_up, B_w_down)
    return g * a + (1 - g) * b
```

```asm
; @launch grid=(256,1,1) block=(256,1,1) lds=163840
.amdgcn_target "amdgcn-amd-amdhsa--gfx950"
.text
.globl gated_mix__memory_aug_recurrent_mem_tr__glu_gated_bilinear__prompt_kernel
.p2align 8
.type gated_mix__memory_aug_recurrent_mem_tr__glu_gated_bilinear__prompt_kernel,@function
gated_mix__memory_aug_recurrent_mem_tr__glu_gated_bilinear__prompt_kernel:
    s_cmp_ge_u32 s2, 256
    s_cbranch_scc1 K_EXIT
    s_load_dwordx2 s[36:37], s[0:1], 112
    s_load_dwordx2 s[38:39], s[0:1], 104
    v_lshrrev_b32 v1, 6, v0
    s_nop 0
    v_readfirstlane_b32 s5, v1
    s_and_b32 s3, s2, 7
    s_lshr_b32 s4, s2, 3
    s_waitcnt lgkmcnt(0)
    s_mov_b32 s8, s36
    s_and_b32 s9, s37, 0xffff
    s_mov_b32 s10, 0x10000000
    s_mov_b32 s11, 0x20000
    s_mov_b32 s12, s38
    s_and_b32 s13, s39, 0xffff
    s_mov_b32 s14, 0x100
    s_mov_b32 s15, 0x20000
    s_getpc_b64 s[40:41]
K_PC:
    s_lshl_b32 s6, s4, 2
    s_add_u32 s6, s6, s5
    s_lshl_b32 s6, s6, 10
    s_cmp_lt_u32 s6, K_CODE_END - K_PC - 1024
    s_cbranch_scc0 K_NOCP
    v_and_b32 v1, 63, v0
    v_lshlrev_b32 v1, 4, v1
    v_add_u32 v1, s6, v1
    global_load_dwordx4 v[4:7], v1, s[40:41]
K_NOCP:
    s_or_b32 s6, s2, s5
    s_cmp_eq_u32 s6, 0
    s_cbranch_scc0 K_ROTW
    s_getreg_b32 s6, hwreg(HW_REG_XCC_ID, 0, 3)
    s_or_b32 s6, s6, 8
    v_mov_b32 v1, s6
    s_mov_b64 exec, 1
    buffer_store_dword v1, off, s[12:15], 0 offset:28 sc1
    s_mov_b64 exec, -1
K_ROTW:
    s_mov_b32 s7, 200000
K_ROTL:
    buffer_load_dword v1, off, s[12:15], 0 offset:28 sc1
    s_waitcnt vmcnt(0)
    v_readfirstlane_b32 s6, v1
    s_nop 0
    s_cmp_lg_u32 s6, 0
    s_cbranch_scc1 K_ROTD
    s_sub_u32 s7, s7, 1
    s_cbranch_scc0 K_ROTL
    s_endpgm
K_ROTD:
    s_add_u32 s3, s3, s6
    s_and_b32 s3, s3, 7
    s_cmp_lt_u32 s3, 2
    s_cbranch_scc1 K_CHAIN
    s_sub_u32 s3, s3, 2
    s_mov_b32 s60, 0
    s_lshl_b32 s6, s3, 5
    s_add_u32 s6, s6, s4
    s_cmp_eq_u32 s6, 5
    s_cbranch_scc0 K_NOPROBE
    s_cmp_eq_u32 s5, 0
    s_cbranch_scc0 K_PROBED
    s_mov_b32 s66, 0x55fc000
    s_add_u32 s67, s66, 8192
    s_mov_b32 s64, -1
    s_mov_b32 s65, -1
    s_mov_b64 exec, 1
    s_mov_b32 s73, 4
K_PROBE:
    s_memtime s[68:69]
    s_waitcnt lgkmcnt(0)
    buffer_store_dword v0, off, s[8:11], s66 sc1
    s_waitcnt vmcnt(0)
    s_memtime s[70:71]
    s_waitcnt lgkmcnt(0)
    s_sub_u32 s72, s70, s68
    s_min_u32 s64, s64, s72
    s_memtime s[68:69]
    s_waitcnt lgkmcnt(0)
    buffer_store_dword v0, off, s[8:11], s67 sc1
    s_waitcnt vmcnt(0)
    s_memtime s[70:71]
    s_waitcnt lgkmcnt(0)
    s_sub_u32 s72, s70, s68
    s_min_u32 s65, s65, s72
    s_sub_u32 s73, s73, 1
    s_cbranch_scc0 K_PROBE
    s_cmp_lt_u32 s65, s64
    s_cselect_b32 s72, 3, 2
    v_mov_b32 v1, s72
    buffer_store_dword v1, off, s[12:15], 0 offset:12 sc1
    s_mov_b64 exec, -1
K_PROBED:
    s_barrier
K_NOPROBE:
    s_load_dwordx2 s[36:37], s[0:1], 0
    s_waitcnt lgkmcnt(0)
    s_mov_b32 s16, s36
    s_and_b32 s17, s37, 0xffff
    s_mov_b32 s18, 0x280000
    s_mov_b32 s19, 0x20000
    v_and_b32 v17, 63, v0
    v_and_b32 v18, 31, v17
    v_lshrrev_b32 v19, 5, v17
    v_bfe_u32 v20, v17, 2, 2
    v_xor_b32 v19, v19, v20
    v_lshlrev_b32 v19, 4, v19
    v_lshl_add_u32 v22, v18, 6, v19
    v_lshrrev_b32 v18, 5, v17
    v_bfe_u32 v19, v17, 2, 2
    v_lshl_add_u32 v18, v18, 3, v19
    v_lshlrev_b32 v18, 7, v18
    v_bfe_u32 v19, v17, 3, 1
    v_lshl_add_u32 v18, v19, 6, v18
    v_bfe_u32 v19, v17, 4, 1
    v_lshl_add_u32 v18, v19, 5, v18
    v_and_b32 v19, 3, v17
    v_lshl_add_u32 v18, v19, 3, v18
    s_lshr_b32 s33, s5, 1
    s_lshl_b32 s33, s33, 13
    v_add_u32 v5, s33, v18
    v_xor_b32 v6, 64, v5
    v_add_u32 v7, 0x10000, v5
    v_add_u32 v8, 0x10000, v6
    v_lshrrev_b32 v18, 2, v17
    v_mul_u32_u24 v18, 1280, v18
    v_and_b32 v19, 3, v17
    v_lshrrev_b32 v20, 4, v17
    v_xor_b32 v19, v19, v20
    v_lshl_add_u32 v9, v19, 4, v18
    v_add_u32 v10, 19456, v9
    v_add_u32 v11, 38912, v9
    v_add_u32 v12, 58368, v9
    s_lshl_b32 s41, s5, 12
    s_add_u32 s41, s41, 16384
    v_lshlrev_b32 v21, 4, v17
    s_lshl_b32 s7, s3, 5
    s_add_u32 s7, s7, s4
    s_mov_b32 s6, 0
    s_mov_b32 s46, 0
    s_mov_b32 s48, 0
    s_mov_b32 s47, 0
    v_mov_b32 v25, 1
    v_mov_b32 v24, 0x80000000
G_ROUND:
    s_mov_b32 s43, 2
    s_cmp_eq_u32 s6, 1
    s_cbranch_scc1 G_DEC_R1
    s_cmp_eq_u32 s6, 2
    s_cbranch_scc1 G_DEC_R2
    s_mov_b32 s43, 1
    s_cmp_eq_u32 s6, 3
    s_cbranch_scc1 G_DEC_R3
    s_mul_i32 s27, s7, 43691
    s_lshr_b32 s27, s27, 18
    s_mul_i32 s33, s27, 6
    s_sub_u32 s24, s7, s33
    s_branch G_DEC_KV
G_DEC_R1:
    s_sub_u32 s33, s7, 64
    s_cbranch_scc0 G_DEC_Q
    s_lshr_b32 s27, s7, 1
    s_and_b32 s24, s7, 1
    s_lshl_b32 s24, s24, 1
    s_add_u32 s24, s24, 6
    s_branch G_DEC_KV
G_DEC_R2:
    s_sub_u32 s33, s7, 96
    s_cbranch_scc0 G_DEC_F4
    s_mul_i32 s27, s7, 43691
    s_lshr_b32 s27, s27, 17
    s_mul_i32 s33, s27, 3
    s_sub_u32 s24, s7, s33
    s_lshl_b32 s24, s24, 1
    s_add_u32 s24, s24, 10
G_DEC_KV:
    s_load_dwordx2 s[36:37], s[0:1], 24
    s_load_dwordx2 s[38:39], s[0:1], 32
    s_waitcnt lgkmcnt(0)
    s_cmp_ge_u32 s5, 2
    s_cselect_b32 s36, s38, s36
    s_cselect_b32 s37, s39, s37
    s_cselect_b32 s25, 1, 0
    s_cselect_b32 s28, 0x2000000, 0x0
    s_lshl_b32 s30, s27, 8
    s_and_b32 s33, s5, 1
    s_lshl_b32 s33, s33, 7
    s_add_u32 s30, s30, s33
    s_lshl_b32 s33, s27, 14
    s_add_u32 s28, s28, s33
    s_branch G_DEC_QKV
G_DEC_Q:
    s_and_b32 s24, s33, 7
    s_lshl_b32 s24, s24, 1
    s_lshr_b32 s27, s33, 3
    s_load_dwordx2 s[36:37], s[0:1], 16
    s_waitcnt lgkmcnt(0)
    s_mov_b32 s25, 2
    s_lshl_b32 s30, s27, 9
    s_lshl_b32 s33, s5, 7
    s_add_u32 s30, s30, s33
    s_lshl_b32 s33, s27, 1
    s_lshr_b32 s34, s5, 1
    s_add_u32 s33, s33, s34
    s_lshl_b32 s33, s33, 14
    s_add_u32 s28, s33, 0x2000
G_DEC_QKV:
    s_mov_b32 s26, 8192
    s_mov_b32 s42, 5242880
    s_mov_b32 s32, 524288
    s_branch G_DEC_DONE
G_DEC_R3:
    s_sub_u32 s33, s4, 26
    s_cbranch_scc1 G_END
    s_mul_i32 s34, s3, 6
    s_add_u32 s33, s33, s34
    s_cmp_ge_u32 s33, 32
    s_cbranch_scc1 G_END
    s_and_b32 s24, s33, 15
    s_lshr_b32 s27, s33, 4
    s_add_u32 s27, s27, 12
    s_branch G_DEC_FFN
G_DEC_F4:
    s_and_b32 s24, s33, 7
    s_lshl_b32 s24, s24, 1
    s_lshr_b32 s27, s33, 3
G_DEC_FFN:
    s_load_dwordx2 s[36:37], s[0:1], 64
    s_load_dwordx2 s[38:39], s[0:1], 72
    s_waitcnt lgkmcnt(0)
    s_bitcmp1_b32 s5, 0
    s_cselect_b32 s36, s38, s36
    s_cselect_b32 s37, s39, s37
    s_mov_b32 s25, 3
    s_lshl_b32 s30, s27, 8
    s_lshr_b32 s33, s5, 1
    s_lshl_b32 s34, s33, 7
    s_add_u32 s30, s30, s34
    s_lshl_b32 s33, s33, 1
    s_lshl_b32 s34, s27, 2
    s_add_u32 s27, s33, s34
    s_lshl_b32 s28, s27, 11
    s_add_u32 s28, s28, 0x4000000
    s_mov_b32 s26, 3456
    s_mov_b32 s42, 2211840
    s_mov_b32 s32, 110592
G_DEC_DONE:
    s_and_b32 s34, s5, 1
    s_lshl_b32 s34, s34, s43
    s_lshl_b32 s44, s24, 2
    s_add_u32 s44, s44, s34
    s_mul_i32 s33, s44, s32
    s_add_u32 s28, s28, s33
    s_lshl_b32 s34, s34, 11
    v_add_u32 v1, s34, v22
    v_xor_b32 v2, 32, v1
    v_add_u32 v3, 0x10000, v1
    v_add_u32 v4, 0x10000, v2
    s_lshl_b32 s33, s5, s43
    s_lshl_b32 s40, s33, 10
    s_mul_i32 s33, s33, 20480
    s_mul_i32 s29, s24, 163840
    s_add_u32 s29, s29, s33
    s_mov_b32 s20, s36
    s_and_b32 s21, s37, 0xffff
    s_mov_b32 s22, s42
    s_mov_b32 s23, 0x20000
    s_lshl_b32 s31, s26, 5
    v_lshrrev_b32 v18, 3, v17
    v_mul_lo_u32 v18, v18, s26
    v_bfe_u32 v19, v17, 4, 1
    v_lshlrev_b32 v19, 2, v19
    v_and_b32 v20, 7, v17
    v_xor_b32 v19, v19, v20
    v_lshl_add_u32 v13, v19, 4, v18
    s_lshl_b32 s33, s26, 3
    s_sub_u32 s33, s33, 1024
    v_add_u32 v14, s33, v13
    v_add_u32 v15, s33, v14
    v_add_u32 v16, s33, v15
    s_mul_i32 s33, s24, 5
    s_lshr_b32 s33, s33, 2
    s_mul_i32 s34, s24, 0
    s_cmp_eq_u32 s6, 0
    s_cselect_b32 s33, s34, s33
    s_sub_u32 s45, 20, s33
    s_lshl_b32 s34, s33, 6
    s_add_u32 s29, s29, s34
    s_mul_i32 s34, s33, s31
    s_add_u32 s30, s30, s34
    s_cmp_eq_u32 s43, 2
    s_cbranch_scc1 G4_START
G2_START:
    s_add_u32 m0, s40, 0
    s_nop 0
    buffer_load_dwordx4 v9, s[16:19], s29 offen offset:0 lds
    buffer_load_dwordx4 v10, s[16:19], s29 offen offset:1024 lds
    s_add_u32 m0, s41, 0
    s_add_u32 s29, s29, 64
    buffer_load_dwordx4 v13, s[20:23], s30 offen offset:0 lds
    buffer_load_dwordx4 v14, s[20:23], s30 offen offset:1024 lds
    buffer_load_dwordx4 v15, s[20:23], s30 offen offset:2048 lds
    buffer_load_dwordx4 v16, s[20:23], s30 offen offset:3072 lds
    s_add_u32 s30, s30, s31
    s_sub_u32 s45, s45, 1
    s_cmp_eq_u32 s45, 0
    s_cselect_b32 s33, 1280, 0
    s_cselect_b32 s34, s42, 0
    s_sub_u32 s29, s29, s33
    s_sub_u32 s30, s30, s34
    s_add_u32 m0, s40, 32768
    s_nop 0
    buffer_load_dwordx4 v9, s[16:19], s29 offen offset:0 lds
    buffer_load_dwordx4 v10, s[16:19], s29 offen offset:1024 lds
    s_add_u32 m0, s41, 32768
    s_add_u32 s29, s29, 64
    buffer_load_dwordx4 v13, s[20:23], s30 offen offset:0 lds
    buffer_load_dwordx4 v14, s[20:23], s30 offen offset:1024 lds
    buffer_load_dwordx4 v15, s[20:23], s30 offen offset:2048 lds
    buffer_load_dwordx4 v16, s[20:23], s30 offen offset:3072 lds
    s_add_u32 s30, s30, s31
    s_sub_u32 s45, s45, 1
    s_cmp_eq_u32 s45, 0
    s_cselect_b32 s33, 1280, 0
    s_cselect_b32 s34, s42, 0
    s_sub_u32 s29, s29, s33
    s_sub_u32 s30, s30, s34
    s_add_u32 m0, s40, 65536
    s_nop 0
    buffer_load_dwordx4 v9, s[16:19], s29 offen offset:0 lds
    buffer_load_dwordx4 v10, s[16:19], s29 offen offset:1024 lds
    s_add_u32 m0, s41, 65536
    s_add_u32 s29, s29, 64
    buffer_load_dwordx4 v13, s[20:23], s30 offen offset:0 lds
    buffer_load_dwordx4 v14, s[20:23], s30 offen offset:1024 lds
    buffer_load_dwordx4 v15, s[20:23], s30 offen offset:2048 lds
    buffer_load_dwordx4 v16, s[20:23], s30 offen offset:3072 lds
    s_add_u32 s30, s30, s31
    s_sub_u32 s45, s45, 1
    s_cmp_eq_u32 s45, 0
    s_cselect_b32 s33, 1280, 0
    s_cselect_b32 s34, s42, 0
    s_sub_u32 s29, s29, s33
    s_sub_u32 s30, s30, s34
    s_add_u32 m0, s40, 98304
    s_nop 0
    buffer_load_dwordx4 v9, s[16:19], s29 offen offset:0 lds
    buffer_load_dwordx4 v10, s[16:19], s29 offen offset:1024 lds
    s_add_u32 m0, s41, 98304
    s_add_u32 s29, s29, 64
    buffer_load_dwordx4 v13, s[20:23], s30 offen offset:0 lds
    buffer_load_dwordx4 v14, s[20:23], s30 offen offset:1024 lds
    buffer_load_dwordx4 v15, s[20:23], s30 offen offset:2048 lds
    buffer_load_dwordx4 v16, s[20:23], s30 offen offset:3072 lds
    s_add_u32 s30, s30, s31
    s_sub_u32 s45, s45, 1
    s_cmp_eq_u32 s45, 0
    s_cselect_b32 s33, 1280, 0
    s_cselect_b32 s34, s42, 0
    s_sub_u32 s29, s29, s33
    s_sub_u32 s30, s30, s34
    s_waitcnt vmcnt(18)
    s_barrier
    ds_read_b128 v[64:67], v1 offset:0
    ds_read_b64_tr_b16 v[80:81], v5 offset:16384
    ds_read_b64_tr_b16 v[82:83], v5 offset:16896
    ds_read_b128 v[68:71], v1 offset:2048
    ds_read_b64_tr_b16 v[84:85], v6 offset:16384
    ds_read_b64_tr_b16 v[86:87], v6 offset:16896
    ds_read_b64_tr_b16 v[88:89], v5 offset:20480
    ds_read_b64_tr_b16 v[90:91], v5 offset:20992
    ds_read_b64_tr_b16 v[92:93], v6 offset:20480
    ds_read_b64_tr_b16 v[94:95], v6 offset:20992
    s_cmp_eq_u32 s25, 1
    s_cbranch_scc1 G2_LOOP_V
G2_LOOP_K:
    s_waitcnt lgkmcnt(0)
    v_mfma_f32_32x32x16_bf16 a[0:15], v[80:83], v[64:67], 0
    ds_read_b128 v[96:99], v2 offset:0
    ds_read_b64_tr_b16 v[112:113], v5 offset:18432
    v_mfma_f32_32x32x16_bf16 a[16:31], v[80:83], v[68:71], 0
    ds_read_b64_tr_b16 v[114:115], v5 offset:18944
    ds_read_b128 v[100:103], v2 offset:2048
    v_mfma_f32_32x32x16_bf16 a[64:79], v[84:87], v[64:67], 0
    ds_read_b64_tr_b16 v[116:117], v6 offset:18432
    ds_read_b64_tr_b16 v[118:119], v6 offset:18944
    v_mfma_f32_32x32x16_bf16 a[80:95], v[84:87], v[68:71], 0
    ds_read_b64_tr_b16 v[120:121], v5 offset:22528
    ds_read_b64_tr_b16 v[122:123], v5 offset:23040
    v_mfma_f32_32x32x16_bf16 a[128:143], v[88:91], v[64:67], 0
    ds_read_b64_tr_b16 v[124:125], v6 offset:22528
    ds_read_b64_tr_b16 v[126:127], v6 offset:23040
    v_mfma_f32_32x32x16_bf16 a[144:159], v[88:91], v[68:71], 0
    v_mfma_f32_32x32x16_bf16 a[192:207], v[92:95], v[64:67], 0
    v_mfma_f32_32x32x16_bf16 a[208:223], v[92:95], v[68:71], 0
    s_waitcnt vmcnt(12) lgkmcnt(0)
    s_barrier
    v_mfma_f32_32x32x16_bf16 a[0:15], v[112:115], v[96:99], a[0:15]
    ds_read_b128 v[64:67], v1 offset:32768
    ds_read_b64_tr_b16 v[80:81], v5 offset:49152
    ds_read_b64_tr_b16 v[82:83], v5 offset:49664
    v_mfma_f32_32x32x16_bf16 a[16:31], v[112:115], v[100:103], a[16:31]
    ds_read_b128 v[68:71], v1 offset:34816
    ds_read_b64_tr_b16 v[84:85], v6 offset:49152
    ds_read_b64_tr_b16 v[86:87], v6 offset:49664
    v_mfma_f32_32x32x16_bf16 a[64:79], v[116:119], v[96:99], a[64:79]
    ds_read_b64_tr_b16 v[88:89], v5 offset:53248
    ds_read_b64_tr_b16 v[90:91], v5 offset:53760
    ds_read_b64_tr_b16 v[92:93], v6 offset:53248
    v_mfma_f32_32x32x16_bf16 a[80:95], v[116:119], v[100:103], a[80:95]
    ds_read_b64_tr_b16 v[94:95], v6 offset:53760
    v_mfma_f32_32x32x16_bf16 a[128:143], v[120:123], v[96:99], a[128:143]
    s_add_u32 m0, s40, 0
    s_nop 0
    buffer_load_dwordx4 v9, s[16:19], s29 offen offset:0 lds
    buffer_load_dwordx4 v10, s[16:19], s29 offen offset:1024 lds
    v_mfma_f32_32x32x16_bf16 a[144:159], v[120:123], v[100:103], a[144:159]
    s_add_u32 m0, s41, 0
    s_add_u32 s29, s29, 64
    buffer_load_dwordx4 v13, s[20:23], s30 offen offset:0 lds
    v_mfma_f32_32x32x16_bf16 a[192:207], v[124:127], v[96:99], a[192:207]
    buffer_load_dwordx4 v14, s[20:23], s30 offen offset:1024 lds
    buffer_load_dwordx4 v15, s[20:23], s30 offen offset:2048 lds
    v_mfma_f32_32x32x16_bf16 a[208:223], v[124:127], v[100:103], a[208:223]
    buffer_load_dwordx4 v16, s[20:23], s30 offen offset:3072 lds
    s_add_u32 s30, s30, s31
    s_sub_u32 s45, s45, 1
    s_cmp_eq_u32 s45, 0
    s_cselect_b32 s33, 1280, 0
    s_cselect_b32 s34, s42, 0
    s_sub_u32 s29, s29, s33
    s_sub_u32 s30, s30, s34
    s_mov_b32 s32, 0
    s_branch G2_LOOP_K_1
G2_LOOP_K_0:
    s_waitcnt lgkmcnt(0)
    v_mfma_f32_32x32x16_bf16 a[0:15], v[80:83], v[64:67], a[0:15]
    ds_read_b128 v[96:99], v2 offset:0
    ds_read_b64_tr_b16 v[112:113], v5 offset:18432
    v_mfma_f32_32x32x16_bf16 a[16:31], v[80:83], v[68:71], a[16:31]
    ds_read_b64_tr_b16 v[114:115], v5 offset:18944
    ds_read_b128 v[100:103], v2 offset:2048
    v_mfma_f32_32x32x16_bf16 a[64:79], v[84:87], v[64:67], a[64:79]
    ds_read_b64_tr_b16 v[116:117], v6 offset:18432
    ds_read_b64_tr_b16 v[118:119], v6 offset:18944
    v_mfma_f32_32x32x16_bf16 a[80:95], v[84:87], v[68:71], a[80:95]
    ds_read_b64_tr_b16 v[120:121], v5 offset:22528
    ds_read_b64_tr_b16 v[122:123], v5 offset:23040
    v_mfma_f32_32x32x16_bf16 a[128:143], v[88:91], v[64:67], a[128:143]
    ds_read_b64_tr_b16 v[124:125], v6 offset:22528
    ds_read_b64_tr_b16 v[126:127], v6 offset:23040
    v_mfma_f32_32x32x16_bf16 a[144:159], v[88:91], v[68:71], a[144:159]
    v_mfma_f32_32x32x16_bf16 a[192:207], v[92:95], v[64:67], a[192:207]
    v_mfma_f32_32x32x16_bf16 a[208:223], v[92:95], v[68:71], a[208:223]
    s_waitcnt vmcnt(12) lgkmcnt(0)
    s_barrier
    v_mfma_f32_32x32x16_bf16 a[0:15], v[112:115], v[96:99], a[0:15]
    ds_read_b128 v[64:67], v1 offset:32768
    ds_read_b64_tr_b16 v[80:81], v5 offset:49152
    ds_read_b64_tr_b16 v[82:83], v5 offset:49664
    v_mfma_f32_32x32x16_bf16 a[16:31], v[112:115], v[100:103], a[16:31]
    ds_read_b128 v[68:71], v1 offset:34816
    ds_read_b64_tr_b16 v[84:85], v6 offset:49152
    ds_read_b64_tr_b16 v[86:87], v6 offset:49664
    v_mfma_f32_32x32x16_bf16 a[64:79], v[116:119], v[96:99], a[64:79]
    ds_read_b64_tr_b16 v[88:89], v5 offset:53248
    ds_read_b64_tr_b16 v[90:91], v5 offset:53760
    ds_read_b64_tr_b16 v[92:93], v6 offset:53248
    v_mfma_f32_32x32x16_bf16 a[80:95], v[116:119], v[100:103], a[80:95]
    ds_read_b64_tr_b16 v[94:95], v6 offset:53760
    v_mfma_f32_32x32x16_bf16 a[128:143], v[120:123], v[96:99], a[128:143]
    s_add_u32 m0, s40, 0
    s_nop 0
    buffer_load_dwordx4 v9, s[16:19], s29 offen offset:0 lds
    buffer_load_dwordx4 v10, s[16:19], s29 offen offset:1024 lds
    v_mfma_f32_32x32x16_bf16 a[144:159], v[120:123], v[100:103], a[144:159]
    s_add_u32 m0, s41, 0
    s_add_u32 s29, s29, 64
    buffer_load_dwordx4 v13, s[20:23], s30 offen offset:0 lds
    v_mfma_f32_32x32x16_bf16 a[192:207], v[124:127], v[96:99], a[192:207]
    buffer_load_dwordx4 v14, s[20:23], s30 offen offset:1024 lds
    buffer_load_dwordx4 v15, s[20:23], s30 offen offset:2048 lds
    v_mfma_f32_32x32x16_bf16 a[208:223], v[124:127], v[100:103], a[208:223]
    buffer_load_dwordx4 v16, s[20:23], s30 offen offset:3072 lds
    s_add_u32 s30, s30, s31
    s_sub_u32 s45, s45, 1
    s_cmp_eq_u32 s45, 0
    s_cselect_b32 s33, 1280, 0
    s_cselect_b32 s34, s42, 0
    s_sub_u32 s29, s29, s33
    s_sub_u32 s30, s30, s34
G2_LOOP_K_1:
    s_waitcnt lgkmcnt(0)
    v_mfma_f32_32x32x16_bf16 a[0:15], v[80:83], v[64:67], a[0:15]
    ds_read_b128 v[96:99], v2 offset:32768
    ds_read_b64_tr_b16 v[112:113], v5 offset:51200
    v_mfma_f32_32x32x16_bf16 a[16:31], v[80:83], v[68:71], a[16:31]
    ds_read_b64_tr_b16 v[114:115], v5 offset:51712
    ds_read_b128 v[100:103], v2 offset:34816
    v_mfma_f32_32x32x16_bf16 a[64:79], v[84:87], v[64:67], a[64:79]
    ds_read_b64_tr_b16 v[116:117], v6 offset:51200
    ds_read_b64_tr_b16 v[118:119], v6 offset:51712
    v_mfma_f32_32x32x16_bf16 a[80:95], v[84:87], v[68:71], a[80:95]
    ds_read_b64_tr_b16 v[120:121], v5 offset:55296
    ds_read_b64_tr_b16 v[122:123], v5 offset:55808
    v_mfma_f32_32x32x16_bf16 a[128:143], v[88:91], v[64:67], a[128:143]
    ds_read_b64_tr_b16 v[124:125], v6 offset:55296
    ds_read_b64_tr_b16 v[126:127], v6 offset:55808
    v_mfma_f32_32x32x16_bf16 a[144:159], v[88:91], v[68:71], a[144:159]
    v_mfma_f32_32x32x16_bf16 a[192:207], v[92:95], v[64:67], a[192:207]
    v_mfma_f32_32x32x16_bf16 a[208:223], v[92:95], v[68:71], a[208:223]
    s_waitcnt vmcnt(12) lgkmcnt(0)
    s_barrier
    v_mfma_f32_32x32x16_bf16 a[0:15], v[112:115], v[96:99], a[0:15]
    ds_read_b128 v[64:67], v3 offset:0
    ds_read_b64_tr_b16 v[80:81], v7 offset:16384
    ds_read_b64_tr_b16 v[82:83], v7 offset:16896
    v_mfma_f32_32x32x16_bf16 a[16:31], v[112:115], v[100:103], a[16:31]
    ds_read_b128 v[68:71], v3 offset:2048
    ds_read_b64_tr_b16 v[84:85], v8 offset:16384
    ds_read_b64_tr_b16 v[86:87], v8 offset:16896
    v_mfma_f32_32x32x16_bf16 a[64:79], v[116:119], v[96:99], a[64:79]
    ds_read_b64_tr_b16 v[88:89], v7 offset:20480
    ds_read_b64_tr_b16 v[90:91], v7 offset:20992
    ds_read_b64_tr_b16 v[92:93], v8 offset:20480
    v_mfma_f32_32x32x16_bf16 a[80:95], v[116:119], v[100:103], a[80:95]
    ds_read_b64_tr_b16 v[94:95], v8 offset:20992
    v_mfma_f32_32x32x16_bf16 a[128:143], v[120:123], v[96:99], a[128:143]
    s_add_u32 m0, s40, 32768
    s_nop 0
    buffer_load_dwordx4 v9, s[16:19], s29 offen offset:0 lds
    buffer_load_dwordx4 v10, s[16:19], s29 offen offset:1024 lds
    v_mfma_f32_32x32x16_bf16 a[144:159], v[120:123], v[100:103], a[144:159]
    s_add_u32 m0, s41, 32768
    s_add_u32 s29, s29, 64
    buffer_load_dwordx4 v13, s[20:23], s30 offen offset:0 lds
    v_mfma_f32_32x32x16_bf16 a[192:207], v[124:127], v[96:99], a[192:207]
    buffer_load_dwordx4 v14, s[20:23], s30 offen offset:1024 lds
    buffer_load_dwordx4 v15, s[20:23], s30 offen offset:2048 lds
    v_mfma_f32_32x32x16_bf16 a[208:223], v[124:127], v[100:103], a[208:223]
    buffer_load_dwordx4 v16, s[20:23], s30 offen offset:3072 lds
    s_add_u32 s30, s30, s31
    s_sub_u32 s45, s45, 1
    s_cmp_eq_u32 s45, 0
    s_cselect_b32 s33, 1280, 0
    s_cselect_b32 s34, s42, 0
    s_sub_u32 s29, s29, s33
    s_sub_u32 s30, s30, s34
    s_waitcnt lgkmcnt(0)
    v_mfma_f32_32x32x16_bf16 a[0:15], v[80:83], v[64:67], a[0:15]
    ds_read_b128 v[96:99], v4 offset:0
    ds_read_b64_tr_b16 v[112:113], v7 offset:18432
    v_mfma_f32_32x32x16_bf16 a[16:31], v[80:83], v[68:71], a[16:31]
    ds_read_b64_tr_b16 v[114:115], v7 offset:18944
    ds_read_b128 v[100:103], v4 offset:2048
    v_mfma_f32_32x32x16_bf16 a[64:79], v[84:87], v[64:67], a[64:79]
    ds_read_b64_tr_b16 v[116:117], v8 offset:18432
    ds_read_b64_tr_b16 v[118:119], v8 offset:18944
    v_mfma_f32_32x32x16_bf16 a[80:95], v[84:87], v[68:71], a[80:95]
    ds_read_b64_tr_b16 v[120:121], v7 offset:22528
    ds_read_b64_tr_b16 v[122:123], v7 offset:23040
    v_mfma_f32_32x32x16_bf16 a[128:143], v[88:91], v[64:67], a[128:143]
    ds_read_b64_tr_b16 v[124:125], v8 offset:22528
    ds_read_b64_tr_b16 v[126:127], v8 offset:23040
    v_mfma_f32_32x32x16_bf16 a[144:159], v[88:91], v[68:71], a[144:159]
    v_mfma_f32_32x32x16_bf16 a[192:207], v[92:95], v[64:67], a[192:207]
    v_mfma_f32_32x32x16_bf16 a[208:223], v[92:95], v[68:71], a[208:223]
    s_waitcnt vmcnt(12) lgkmcnt(0)
    s_barrier
    v_mfma_f32_32x32x16_bf16 a[0:15], v[112:115], v[96:99], a[0:15]
    ds_read_b128 v[64:67], v3 offset:32768
    ds_read_b64_tr_b16 v[80:81], v7 offset:49152
    ds_read_b64_tr_b16 v[82:83], v7 offset:49664
    v_mfma_f32_32x32x16_bf16 a[16:31], v[112:115], v[100:103], a[16:31]
    ds_read_b128 v[68:71], v3 offset:34816
    ds_read_b64_tr_b16 v[84:85], v8 offset:49152
    ds_read_b64_tr_b16 v[86:87], v8 offset:49664
    v_mfma_f32_32x32x16_bf16 a[64:79], v[116:119], v[96:99], a[64:79]
    ds_read_b64_tr_b16 v[88:89], v7 offset:53248
    ds_read_b64_tr_b16 v[90:91], v7 offset:53760
    ds_read_b64_tr_b16 v[92:93], v8 offset:53248
    v_mfma_f32_32x32x16_bf16 a[80:95], v[116:119], v[100:103], a[80:95]
    ds_read_b64_tr_b16 v[94:95], v8 offset:53760
    v_mfma_f32_32x32x16_bf16 a[128:143], v[120:123], v[96:99], a[128:143]
    s_add_u32 m0, s40, 65536
    s_nop 0
    buffer_load_dwordx4 v9, s[16:19], s29 offen offset:0 lds
    buffer_load_dwordx4 v10, s[16:19], s29 offen offset:1024 lds
    v_mfma_f32_32x32x16_bf16 a[144:159], v[120:123], v[100:103], a[144:159]
    s_add_u32 m0, s41, 65536
    s_add_u32 s29, s29, 64
    buffer_load_dwordx4 v13, s[20:23], s30 offen offset:0 lds
    v_mfma_f32_32x32x16_bf16 a[192:207], v[124:127], v[96:99], a[192:207]
    buffer_load_dwordx4 v14, s[20:23], s30 offen offset:1024 lds
    buffer_load_dwordx4 v15, s[20:23], s30 offen offset:2048 lds
    v_mfma_f32_32x32x16_bf16 a[208:223], v[124:127], v[100:103], a[208:223]
    buffer_load_dwordx4 v16, s[20:23], s30 offen offset:3072 lds
    s_add_u32 s30, s30, s31
    s_sub_u32 s45, s45, 1
    s_cmp_eq_u32 s45, 0
    s_cselect_b32 s33, 1280, 0
    s_cselect_b32 s34, s42, 0
    s_sub_u32 s29, s29, s33
    s_sub_u32 s30, s30, s34
    s_waitcnt lgkmcnt(0)
    v_mfma_f32_32x32x16_bf16 a[0:15], v[80:83], v[64:67], a[0:15]
    ds_read_b128 v[96:99], v4 offset:32768
    ds_read_b64_tr_b16 v[112:113], v7 offset:51200
    v_mfma_f32_32x32x16_bf16 a[16:31], v[80:83], v[68:71], a[16:31]
    ds_read_b64_tr_b16 v[114:115], v7 offset:51712
    ds_read_b128 v[100:103], v4 offset:34816
    v_mfma_f32_32x32x16_bf16 a[64:79], v[84:87], v[64:67], a[64:79]
    ds_read_b64_tr_b16 v[116:117], v8 offset:51200
    ds_read_b64_tr_b16 v[118:119], v8 offset:51712
    v_mfma_f32_32x32x16_bf16 a[80:95], v[84:87], v[68:71], a[80:95]
    ds_read_b64_tr_b16 v[120:121], v7 offset:55296
    ds_read_b64_tr_b16 v[122:123], v7 offset:55808
    v_mfma_f32_32x32x16_bf16 a[128:143], v[88:91], v[64:67], a[128:143]
    ds_read_b64_tr_b16 v[124:125], v8 offset:55296
    ds_read_b64_tr_b16 v[126:127], v8 offset:55808
    v_mfma_f32_32x32x16_bf16 a[144:159], v[88:91], v[68:71], a[144:159]
    v_mfma_f32_32x32x16_bf16 a[192:207], v[92:95], v[64:67], a[192:207]
    v_mfma_f32_32x32x16_bf16 a[208:223], v[92:95], v[68:71], a[208:223]
    s_waitcnt vmcnt(12) lgkmcnt(0)
    s_barrier
    v_mfma_f32_32x32x16_bf16 a[0:15], v[112:115], v[96:99], a[0:15]
    ds_read_b128 v[64:67], v1 offset:0
    ds_read_b64_tr_b16 v[80:81], v5 offset:16384
    ds_read_b64_tr_b16 v[82:83], v5 offset:16896
    v_mfma_f32_32x32x16_bf16 a[16:31], v[112:115], v[100:103], a[16:31]
    ds_read_b128 v[68:71], v1 offset:2048
    ds_read_b64_tr_b16 v[84:85], v6 offset:16384
    ds_read_b64_tr_b16 v[86:87], v6 offset:16896
    v_mfma_f32_32x32x16_bf16 a[64:79], v[116:119], v[96:99], a[64:79]
    ds_read_b64_tr_b16 v[88:89], v5 offset:20480
    ds_read_b64_tr_b16 v[90:91], v5 offset:20992
    ds_read_b64_tr_b16 v[92:93], v6 offset:20480
    v_mfma_f32_32x32x16_bf16 a[80:95], v[116:119], v[100:103], a[80:95]
    ds_read_b64_tr_b16 v[94:95], v6 offset:20992
    v_mfma_f32_32x32x16_bf16 a[128:143], v[120:123], v[96:99], a[128:143]
    s_add_u32 m0, s40, 98304
    s_nop 0
    buffer_load_dwordx4 v9, s[16:19], s29 offen offset:0 lds
    buffer_load_dwordx4 v10, s[16:19], s29 offen offset:1024 lds
    v_mfma_f32_32x32x16_bf16 a[144:159], v[120:123], v[100:103], a[144:159]
    s_add_u32 m0, s41, 98304
    s_add_u32 s29, s29, 64
    buffer_load_dwordx4 v13, s[20:23], s30 offen offset:0 lds
    v_mfma_f32_32x32x16_bf16 a[192:207], v[124:127], v[96:99], a[192:207]
    buffer_load_dwordx4 v14, s[20:23], s30 offen offset:1024 lds
    buffer_load_dwordx4 v15, s[20:23], s30 offen offset:2048 lds
    v_mfma_f32_32x32x16_bf16 a[208:223], v[124:127], v[100:103], a[208:223]
    buffer_load_dwordx4 v16, s[20:23], s30 offen offset:3072 lds
    s_add_u32 s30, s30, s31
    s_sub_u32 s45, s45, 1
    s_cmp_eq_u32 s45, 0
    s_cselect_b32 s33, 1280, 0
    s_cselect_b32 s34, s42, 0
    s_sub_u32 s29, s29, s33
    s_sub_u32 s30, s30, s34
    s_add_u32 s32, s32, 1
    s_cmp_lt_u32 s32, 4
    s_cbranch_scc1 G2_LOOP_K_0
    s_waitcnt lgkmcnt(0)
    v_mfma_f32_32x32x16_bf16 a[0:15], v[80:83], v[64:67], a[0:15]
    ds_read_b128 v[96:99], v2 offset:0
    ds_read_b64_tr_b16 v[112:113], v5 offset:18432
    v_mfma_f32_32x32x16_bf16 a[16:31], v[80:83], v[68:71], a[16:31]
    ds_read_b64_tr_b16 v[114:115], v5 offset:18944
    ds_read_b128 v[100:103], v2 offset:2048
    v_mfma_f32_32x32x16_bf16 a[64:79], v[84:87], v[64:67], a[64:79]
    ds_read_b64_tr_b16 v[116:117], v6 offset:18432
    ds_read_b64_tr_b16 v[118:119], v6 offset:18944
    v_mfma_f32_32x32x16_bf16 a[80:95], v[84:87], v[68:71], a[80:95]
    ds_read_b64_tr_b16 v[120:121], v5 offset:22528
    ds_read_b64_tr_b16 v[122:123], v5 offset:23040
    v_mfma_f32_32x32x16_bf16 a[128:143], v[88:91], v[64:67], a[128:143]
    ds_read_b64_tr_b16 v[124:125], v6 offset:22528
    ds_read_b64_tr_b16 v[126:127], v6 offset:23040
    v_mfma_f32_32x32x16_bf16 a[144:159], v[88:91], v[68:71], a[144:159]
    v_mfma_f32_32x32x16_bf16 a[192:207], v[92:95], v[64:67], a[192:207]
    v_mfma_f32_32x32x16_bf16 a[208:223], v[92:95], v[68:71], a[208:223]
    s_waitcnt vmcnt(12) lgkmcnt(0)
    s_barrier
    v_mfma_f32_32x32x16_bf16 a[0:15], v[112:115], v[96:99], a[0:15]
    ds_read_b128 v[64:67], v1 offset:32768
    ds_read_b64_tr_b16 v[80:81], v5 offset:49152
    ds_read_b64_tr_b16 v[82:83], v5 offset:49664
    v_mfma_f32_32x32x16_bf16 a[16:31], v[112:115], v[100:103], a[16:31]
    ds_read_b128 v[68:71], v1 offset:34816
    ds_read_b64_tr_b16 v[84:85], v6 offset:49152
    ds_read_b64_tr_b16 v[86:87], v6 offset:49664
    v_mfma_f32_32x32x16_bf16 a[64:79], v[116:119], v[96:99], a[64:79]
    ds_read_b64_tr_b16 v[88:89], v5 offset:53248
    ds_read_b64_tr_b16 v[90:91], v5 offset:53760
    ds_read_b64_tr_b16 v[92:93], v6 offset:53248
    v_mfma_f32_32x32x16_bf16 a[80:95], v[116:119], v[100:103], a[80:95]
    ds_read_b64_tr_b16 v[94:95], v6 offset:53760
    v_mfma_f32_32x32x16_bf16 a[128:143], v[120:123], v[96:99], a[128:143]
    v_mfma_f32_32x32x16_bf16 a[144:159], v[120:123], v[100:103], a[144:159]
    v_mfma_f32_32x32x16_bf16 a[192:207], v[124:127], v[96:99], a[192:207]
    v_mfma_f32_32x32x16_bf16 a[208:223], v[124:127], v[100:103], a[208:223]
    s_waitcnt lgkmcnt(0)
    v_mfma_f32_32x32x16_bf16 a[0:15], v[80:83], v[64:67], a[0:15]
    ds_read_b128 v[96:99], v2 offset:32768
    ds_read_b64_tr_b16 v[112:113], v5 offset:51200
    v_mfma_f32_32x32x16_bf16 a[16:31], v[80:83], v[68:71], a[16:31]
    ds_read_b64_tr_b16 v[114:115], v5 offset:51712
    ds_read_b128 v[100:103], v2 offset:34816
    v_mfma_f32_32x32x16_bf16 a[64:79], v[84:87], v[64:67], a[64:79]
    ds_read_b64_tr_b16 v[116:117], v6 offset:51200
    ds_read_b64_tr_b16 v[118:119], v6 offset:51712
    v_mfma_f32_32x32x16_bf16 a[80:95], v[84:87], v[68:71], a[80:95]
    ds_read_b64_tr_b16 v[120:121], v5 offset:55296
    ds_read_b64_tr_b16 v[122:123], v5 offset:55808
    v_mfma_f32_32x32x16_bf16 a[128:143], v[88:91], v[64:67], a[128:143]
    ds_read_b64_tr_b16 v[124:125], v6 offset:55296
    ds_read_b64_tr_b16 v[126:127], v6 offset:55808
    v_mfma_f32_32x32x16_bf16 a[144:159], v[88:91], v[68:71], a[144:159]
    v_mfma_f32_32x32x16_bf16 a[192:207], v[92:95], v[64:67], a[192:207]
    v_mfma_f32_32x32x16_bf16 a[208:223], v[92:95], v[68:71], a[208:223]
    s_waitcnt vmcnt(6) lgkmcnt(0)
    s_barrier
    v_mfma_f32_32x32x16_bf16 a[0:15], v[112:115], v[96:99], a[0:15]
    ds_read_b128 v[64:67], v3 offset:0
    ds_read_b64_tr_b16 v[80:81], v7 offset:16384
    ds_read_b64_tr_b16 v[82:83], v7 offset:16896
    v_mfma_f32_32x32x16_bf16 a[16:31], v[112:115], v[100:103], a[16:31]
    ds_read_b128 v[68:71], v3 offset:2048
    ds_read_b64_tr_b16 v[84:85], v8 offset:16384
    ds_read_b64_tr_b16 v[86:87], v8 offset:16896
    v_mfma_f32_32x32x16_bf16 a[64:79], v[116:119], v[96:99], a[64:79]
    ds_read_b64_tr_b16 v[88:89], v7 offset:20480
    ds_read_b64_tr_b16 v[90:91], v7 offset:20992
    ds_read_b64_tr_b16 v[92:93], v8 offset:20480
    v_mfma_f32_32x32x16_bf16 a[80:95], v[116:119], v[100:103], a[80:95]
    ds_read_b64_tr_b16 v[94:95], v8 offset:20992
    v_mfma_f32_32x32x16_bf16 a[128:143], v[120:123], v[96:99], a[128:143]
    v_mfma_f32_32x32x16_bf16 a[144:159], v[120:123], v[100:103], a[144:159]
    v_mfma_f32_32x32x16_bf16 a[192:207], v[124:127], v[96:99], a[192:207]
    v_mfma_f32_32x32x16_bf16 a[208:223], v[124:127], v[100:103], a[208:223]
    s_waitcnt lgkmcnt(0)
    v_mfma_f32_32x32x16_bf16 a[0:15], v[80:83], v[64:67], a[0:15]
    ds_read_b128 v[96:99], v4 offset:0
    ds_read_b64_tr_b16 v[112:113], v7 offset:18432
    v_mfma_f32_32x32x16_bf16 a[16:31], v[80:83], v[68:71], a[16:31]
    ds_read_b64_tr_b16 v[114:115], v7 offset:18944
    ds_read_b128 v[100:103], v4 offset:2048
    v_mfma_f32_32x32x16_bf16 a[64:79], v[84:87], v[64:67], a[64:79]
    ds_read_b64_tr_b16 v[116:117], v8 offset:18432
    ds_read_b64_tr_b16 v[118:119], v8 offset:18944
    v_mfma_f32_32x32x16_bf16 a[80:95], v[84:87], v[68:71], a[80:95]
    ds_read_b64_tr_b16 v[120:121], v7 offset:22528
    ds_read_b64_tr_b16 v[122:123], v7 offset:23040
    v_mfma_f32_32x32x16_bf16 a[128:143], v[88:91], v[64:67], a[128:143]
    ds_read_b64_tr_b16 v[124:125], v8 offset:22528
    ds_read_b64_tr_b16 v[126:127], v8 offset:23040
    v_mfma_f32_32x32x16_bf16 a[144:159], v[88:91], v[68:71], a[144:159]
    v_mfma_f32_32x32x16_bf16 a[192:207], v[92:95], v[64:67], a[192:207]
    v_mfma_f32_32x32x16_bf16 a[208:223], v[92:95], v[68:71], a[208:223]
    s_waitcnt vmcnt(0) lgkmcnt(0)
    s_barrier
    v_mfma_f32_32x32x16_bf16 a[0:15], v[112:115], v[96:99], a[0:15]
    ds_read_b128 v[64:67], v3 offset:32768
    ds_read_b64_tr_b16 v[80:81], v7 offset:49152
    ds_read_b64_tr_b16 v[82:83], v7 offset:49664
    v_mfma_f32_32x32x16_bf16 a[16:31], v[112:115], v[100:103], a[16:31]
    ds_read_b128 v[68:71], v3 offset:34816
    ds_read_b64_tr_b16 v[84:85], v8 offset:49152
    ds_read_b64_tr_b16 v[86:87], v8 offset:49664
    v_mfma_f32_32x32x16_bf16 a[64:79], v[116:119], v[96:99], a[64:79]
    ds_read_b64_tr_b16 v[88:89], v7 offset:53248
    ds_read_b64_tr_b16 v[90:91], v7 offset:53760
    ds_read_b64_tr_b16 v[92:93], v8 offset:53248
    v_mfma_f32_32x32x16_bf16 a[80:95], v[116:119], v[100:103], a[80:95]
    ds_read_b64_tr_b16 v[94:95], v8 offset:53760
    v_mfma_f32_32x32x16_bf16 a[128:143], v[120:123], v[96:99], a[128:143]
    v_mfma_f32_32x32x16_bf16 a[144:159], v[120:123], v[100:103], a[144:159]
    v_mfma_f32_32x32x16_bf16 a[192:207], v[124:127], v[96:99], a[192:207]
    v_mfma_f32_32x32x16_bf16 a[208:223], v[124:127], v[100:103], a[208:223]
    s_waitcnt lgkmcnt(0)
    v_mfma_f32_32x32x16_bf16 a[0:15], v[80:83], v[64:67], a[0:15]
    ds_read_b128 v[96:99], v4 offset:32768
    ds_read_b64_tr_b16 v[112:113], v7 offset:51200
    v_mfma_f32_32x32x16_bf16 a[16:31], v[80:83], v[68:71], a[16:31]
    ds_read_b64_tr_b16 v[114:115], v7 offset:51712
    ds_read_b128 v[100:103], v4 offset:34816
    v_mfma_f32_32x32x16_bf16 a[64:79], v[84:87], v[64:67], a[64:79]
    ds_read_b64_tr_b16 v[116:117], v8 offset:51200
    ds_read_b64_tr_b16 v[118:119], v8 offset:51712
    v_mfma_f32_32x32x16_bf16 a[80:95], v[84:87], v[68:71], a[80:95]
    ds_read_b64_tr_b16 v[120:121], v7 offset:55296
    ds_read_b64_tr_b16 v[122:123], v7 offset:55808
    v_mfma_f32_32x32x16_bf16 a[128:143], v[88:91], v[64:67], a[128:143]
    ds_read_b64_tr_b16 v[124:125], v8 offset:55296
    ds_read_b64_tr_b16 v[126:127], v8 offset:55808
    v_mfma_f32_32x32x16_bf16 a[144:159], v[88:91], v[68:71], a[144:159]
    v_mfma_f32_32x32x16_bf16 a[192:207], v[92:95], v[64:67], a[192:207]
    v_mfma_f32_32x32x16_bf16 a[208:223], v[92:95], v[68:71], a[208:223]
    s_waitcnt lgkmcnt(0)
    s_barrier
    v_mfma_f32_32x32x16_bf16 a[0:15], v[112:115], v[96:99], a[0:15]
    v_mfma_f32_32x32x16_bf16 a[16:31], v[112:115], v[100:103], a[16:31]
    v_mfma_f32_32x32x16_bf16 a[64:79], v[116:119], v[96:99], a[64:79]
    v_mfma_f32_32x32x16_bf16 a[80:95], v[116:119], v[100:103], a[80:95]
    v_mfma_f32_32x32x16_bf16 a[128:143], v[120:123], v[96:99], a[128:143]
    v_mfma_f32_32x32x16_bf16 a[144:159], v[120:123], v[100:103], a[144:159]
    v_mfma_f32_32x32x16_bf16 a[192:207], v[124:127], v[96:99], a[192:207]
    v_mfma_f32_32x32x16_bf16 a[208:223], v[124:127], v[100:103], a[208:223]
    s_branch G_EPI
G2_LOOP_V:
    s_waitcnt lgkmcnt(0)
    v_mfma_f32_32x32x16_bf16 a[0:15], v[64:67], v[80:83], 0
    ds_read_b128 v[96:99], v2 offset:0
    ds_read_b64_tr_b16 v[112:113], v5 offset:18432
    v_mfma_f32_32x32x16_bf16 a[16:31], v[68:71], v[80:83], 0
    ds_read_b64_tr_b16 v[114:115], v5 offset:18944
    ds_read_b128 v[100:103], v2 offset:2048
    v_mfma_f32_32x32x16_bf16 a[64:79], v[64:67], v[84:87], 0
    ds_read_b64_tr_b16 v[116:117], v6 offset:18432
    ds_read_b64_tr_b16 v[118:119], v6 offset:18944
    v_mfma_f32_32x32x16_bf16 a[80:95], v[68:71], v[84:87], 0
    ds_read_b64_tr_b16 v[120:121], v5 offset:22528
    ds_read_b64_tr_b16 v[122:123], v5 offset:23040
    v_mfma_f32_32x32x16_bf16 a[128:143], v[64:67], v[88:91], 0
    ds_read_b64_tr_b16 v[124:125], v6 offset:22528
    ds_read_b64_tr_b16 v[126:127], v6 offset:23040
    v_mfma_f32_32x32x16_bf16 a[144:159], v[68:71], v[88:91], 0
    v_mfma_f32_32x32x16_bf16 a[192:207], v[64:67], v[92:95], 0
    v_mfma_f32_32x32x16_bf16 a[208:223], v[68:71], v[92:95], 0
    s_waitcnt vmcnt(12) lgkmcnt(0)
    s_barrier
    v_mfma_f32_32x32x16_bf16 a[0:15], v[96:99], v[112:115], a[0:15]
    ds_read_b128 v[64:67], v1 offset:32768
    ds_read_b64_tr_b16 v[80:81], v5 offset:49152
    ds_read_b64_tr_b16 v[82:83], v5 offset:49664
    v_mfma_f32_32x32x16_bf16 a[16:31], v[100:103], v[112:115], a[16:31]
    ds_read_b128 v[68:71], v1 offset:34816
    ds_read_b64_tr_b16 v[84:85], v6 offset:49152
    ds_read_b64_tr_b16 v[86:87], v6 offset:49664
    v_mfma_f32_32x32x16_bf16 a[64:79], v[96:99], v[116:119], a[64:79]
    ds_read_b64_tr_b16 v[88:89], v5 offset:53248
    ds_read_b64_tr_b16 v[90:91], v5 offset:53760
    ds_read_b64_tr_b16 v[92:93], v6 offset:53248
    v_mfma_f32_32x32x16_bf16 a[80:95], v[100:103], v[116:119], a[80:95]
    ds_read_b64_tr_b16 v[94:95], v6 offset:53760
    v_mfma_f32_32x32x16_bf16 a[128:143], v[96:99], v[120:123], a[128:143]
    s_add_u32 m0, s40, 0
    s_nop 0
    buffer_load_dwordx4 v9, s[16:19], s29 offen offset:0 lds
    buffer_load_dwordx4 v10, s[16:19], s29 offen offset:1024 lds
    v_mfma_f32_32x32x16_bf16 a[144:159], v[100:103], v[120:123], a[144:159]
    s_add_u32 m0, s41, 0
    s_add_u32 s29, s29, 64
    buffer_load_dwordx4 v13, s[20:23], s30 offen offset:0 lds
    v_mfma_f32_32x32x16_bf16 a[192:207], v[96:99], v[124:127], a[192:207]
    buffer_load_dwordx4 v14, s[20:23], s30 offen offset:1024 lds
    buffer_load_dwordx4 v15, s[20:23], s30 offen offset:2048 lds
    v_mfma_f32_32x32x16_bf16 a[208:223], v[100:103], v[124:127], a[208:223]
    buffer_load_dwordx4 v16, s[20:23], s30 offen offset:3072 lds
    s_add_u32 s30, s30, s31
    s_sub_u32 s45, s45, 1
    s_cmp_eq_u32 s45, 0
    s_cselect_b32 s33, 1280, 0
    s_cselect_b32 s34, s42, 0
    s_sub_u32 s29, s29, s33
    s_sub_u32 s30, s30, s34
    s_mov_b32 s32, 0
    s_branch G2_LOOP_V_1
G2_LOOP_V_0:
    s_waitcnt lgkmcnt(0)
    v_mfma_f32_32x32x16_bf16 a[0:15], v[64:67], v[80:83], a[0:15]
    ds_read_b128 v[96:99], v2 offset:0
    ds_read_b64_tr_b16 v[112:113], v5 offset:18432
    v_mfma_f32_32x32x16_bf16 a[16:31], v[68:71], v[80:83], a[16:31]
    ds_read_b64_tr_b16 v[114:115], v5 offset:18944
    ds_read_b128 v[100:103], v2 offset:2048
    v_mfma_f32_32x32x16_bf16 a[64:79], v[64:67], v[84:87], a[64:79]
    ds_read_b64_tr_b16 v[116:117], v6 offset:18432
    ds_read_b64_tr_b16 v[118:119], v6 offset:18944
    v_mfma_f32_32x32x16_bf16 a[80:95], v[68:71], v[84:87], a[80:95]
    ds_read_b64_tr_b16 v[120:121], v5 offset:22528
    ds_read_b64_tr_b16 v[122:123], v5 offset:23040
    v_mfma_f32_32x32x16_bf16 a[128:143], v[64:67], v[88:91], a[128:143]
    ds_read_b64_tr_b16 v[124:125], v6 offset:22528
    ds_read_b64_tr_b16 v[126:127], v6 offset:23040
    v_mfma_f32_32x32x16_bf16 a[144:159], v[68:71], v[88:91], a[144:159]
    v_mfma_f32_32x32x16_bf16 a[192:207], v[64:67], v[92:95], a[192:207]
    v_mfma_f32_32x32x16_bf16 a[208:223], v[68:71], v[92:95], a[208:223]
    s_waitcnt vmcnt(12) lgkmcnt(0)
    s_barrier
    v_mfma_f32_32x32x16_bf16 a[0:15], v[96:99], v[112:115], a[0:15]
    ds_read_b128 v[64:67], v1 offset:32768
    ds_read_b64_tr_b16 v[80:81], v5 offset:49152
    ds_read_b64_tr_b16 v[82:83], v5 offset:49664
    v_mfma_f32_32x32x16_bf16 a[16:31], v[100:103], v[112:115], a[16:31]
    ds_read_b128 v[68:71], v1 offset:34816
    ds_read_b64_tr_b16 v[84:85], v6 offset:49152
    ds_read_b64_tr_b16 v[86:87], v6 offset:49664
    v_mfma_f32_32x32x16_bf16 a[64:79], v[96:99], v[116:119], a[64:79]
    ds_read_b64_tr_b16 v[88:89], v5 offset:53248
    ds_read_b64_tr_b16 v[90:91], v5 offset:53760
    ds_read_b64_tr_b16 v[92:93], v6 offset:53248
    v_mfma_f32_32x32x16_bf16 a[80:95], v[100:103], v[116:119], a[80:95]
    ds_read_b64_tr_b16 v[94:95], v6 offset:53760
    v_mfma_f32_32x32x16_bf16 a[128:143], v[96:99], v[120:123], a[128:143]
    s_add_u32 m0, s40, 0
    s_nop 0
    buffer_load_dwordx4 v9, s[16:19], s29 offen offset:0 lds
    buffer_load_dwordx4 v10, s[16:19], s29 offen offset:1024 lds
    v_mfma_f32_32x32x16_bf16 a[144:159], v[100:103], v[120:123], a[144:159]
    s_add_u32 m0, s41, 0
    s_add_u32 s29, s29, 64
    buffer_load_dwordx4 v13, s[20:23], s30 offen offset:0 lds
    v_mfma_f32_32x32x16_bf16 a[192:207], v[96:99], v[124:127], a[192:207]
    buffer_load_dwordx4 v14, s[20:23], s30 offen offset:1024 lds
    buffer_load_dwordx4 v15, s[20:23], s30 offen offset:2048 lds
    v_mfma_f32_32x32x16_bf16 a[208:223], v[100:103], v[124:127], a[208:223]
    buffer_load_dwordx4 v16, s[20:23], s30 offen offset:3072 lds
    s_add_u32 s30, s30, s31
    s_sub_u32 s45, s45, 1
    s_cmp_eq_u32 s45, 0
    s_cselect_b32 s33, 1280, 0
    s_cselect_b32 s34, s42, 0
    s_sub_u32 s29, s29, s33
    s_sub_u32 s30, s30, s34
G2_LOOP_V_1:
    s_waitcnt lgkmcnt(0)
    v_mfma_f32_32x32x16_bf16 a[0:15], v[64:67], v[80:83], a[0:15]
    ds_read_b128 v[96:99], v2 offset:32768
    ds_read_b64_tr_b16 v[112:113], v5 offset:51200
    v_mfma_f32_32x32x16_bf16 a[16:31], v[68:71], v[80:83], a[16:31]
    ds_read_b64_tr_b16 v[114:115], v5 offset:51712
    ds_read_b128 v[100:103], v2 offset:34816
    v_mfma_f32_32x32x16_bf16 a[64:79], v[64:67], v[84:87], a[64:79]
    ds_read_b64_tr_b16 v[116:117], v6 offset:51200
    ds_read_b64_tr_b16 v[118:119], v6 offset:51712
    v_mfma_f32_32x32x16_bf16 a[80:95], v[68:71], v[84:87], a[80:95]
    ds_read_b64_tr_b16 v[120:121], v5 offset:55296
    ds_read_b64_tr_b16 v[122:123], v5 offset:55808
    v_mfma_f32_32x32x16_bf16 a[128:143], v[64:67], v[88:91], a[128:143]
    ds_read_b64_tr_b16 v[124:125], v6 offset:55296
    ds_read_b64_tr_b16 v[126:127], v6 offset:55808
    v_mfma_f32_32x32x16_bf16 a[144:159], v[68:71], v[88:91], a[144:159]
    v_mfma_f32_32x32x16_bf16 a[192:207], v[64:67], v[92:95], a[192:207]
    v_mfma_f32_32x32x16_bf16 a[208:223], v[68:71], v[92:95], a[208:223]
    s_waitcnt vmcnt(12) lgkmcnt(0)
    s_barrier
    v_mfma_f32_32x32x16_bf16 a[0:15], v[96:99], v[112:115], a[0:15]
    ds_read_b128 v[64:67], v3 offset:0
    ds_read_b64_tr_b16 v[80:81], v7 offset:16384
    ds_read_b64_tr_b16 v[82:83], v7 offset:16896
    v_mfma_f32_32x32x16_bf16 a[16:31], v[100:103], v[112:115], a[16:31]
    ds_read_b128 v[68:71], v3 offset:2048
    ds_read_b64_tr_b16 v[84:85], v8 offset:16384
    ds_read_b64_tr_b16 v[86:87], v8 offset:16896
    v_mfma_f32_32x32x16_bf16 a[64:79], v[96:99], v[116:119], a[64:79]
    ds_read_b64_tr_b16 v[88:89], v7 offset:20480
    ds_read_b64_tr_b16 v[90:91], v7 offset:20992
    ds_read_b64_tr_b16 v[92:93], v8 offset:20480
    v_mfma_f32_32x32x16_bf16 a[80:95], v[100:103], v[116:119], a[80:95]
    ds_read_b64_tr_b16 v[94:95], v8 offset:20992
    v_mfma_f32_32x32x16_bf16 a[128:143], v[96:99], v[120:123], a[128:143]
    s_add_u32 m0, s40, 32768
    s_nop 0
    buffer_load_dwordx4 v9, s[16:19], s29 offen offset:0 lds
    buffer_load_dwordx4 v10, s[16:19], s29 offen offset:1024 lds
    v_mfma_f32_32x32x16_bf16 a[144:159], v[100:103], v[120:123], a[144:159]
    s_add_u32 m0, s41, 32768
    s_add_u32 s29, s29, 64
    buffer_load_dwordx4 v13, s[20:23], s30 offen offset:0 lds
    v_mfma_f32_32x32x16_bf16 a[192:207], v[96:99], v[124:127], a[192:207]
    buffer_load_dwordx4 v14, s[20:23], s30 offen offset:1024 lds
    buffer_load_dwordx4 v15, s[20:23], s30 offen offset:2048 lds
    v_mfma_f32_32x32x16_bf16 a[208:223], v[100:103], v[124:127], a[208:223]
    buffer_load_dwordx4 v16, s[20:23], s30 offen offset:3072 lds
    s_add_u32 s30, s30, s31
    s_sub_u32 s45, s45, 1
    s_cmp_eq_u32 s45, 0
    s_cselect_b32 s33, 1280, 0
    s_cselect_b32 s34, s42, 0
    s_sub_u32 s29, s29, s33
    s_sub_u32 s30, s30, s34
    s_waitcnt lgkmcnt(0)
    v_mfma_f32_32x32x16_bf16 a[0:15], v[64:67], v[80:83], a[0:15]
    ds_read_b128 v[96:99], v4 offset:0
    ds_read_b64_tr_b16 v[112:113], v7 offset:18432
    v_mfma_f32_32x32x16_bf16 a[16:31], v[68:71], v[80:83], a[16:31]
    ds_read_b64_tr_b16 v[114:115], v7 offset:18944
    ds_read_b128 v[100:103], v4 offset:2048
    v_mfma_f32_32x32x16_bf16 a[64:79], v[64:67], v[84:87], a[64:79]
    ds_read_b64_tr_b16 v[116:117], v8 offset:18432
    ds_read_b64_tr_b16 v[118:119], v8 offset:18944
    v_mfma_f32_32x32x16_bf16 a[80:95], v[68:71], v[84:87], a[80:95]
    ds_read_b64_tr_b16 v[120:121], v7 offset:22528
    ds_read_b64_tr_b16 v[122:123], v7 offset:23040
    v_mfma_f32_32x32x16_bf16 a[128:143], v[64:67], v[88:91], a[128:143]
    ds_read_b64_tr_b16 v[124:125], v8 offset:22528
    ds_read_b64_tr_b16 v[126:127], v8 offset:23040
    v_mfma_f32_32x32x16_bf16 a[144:159], v[68:71], v[88:91], a[144:159]
    v_mfma_f32_32x32x16_bf16 a[192:207], v[64:67], v[92:95], a[192:207]
    v_mfma_f32_32x32x16_bf16 a[208:223], v[68:71], v[92:95], a[208:223]
    s_waitcnt vmcnt(12) lgkmcnt(0)
    s_barrier
    v_mfma_f32_32x32x16_bf16 a[0:15], v[96:99], v[112:115], a[0:15]
    ds_read_b128 v[64:67], v3 offset:32768
    ds_read_b64_tr_b16 v[80:81], v7 offset:49152
    ds_read_b64_tr_b16 v[82:83], v7 offset:49664
    v_mfma_f32_32x32x16_bf16 a[16:31], v[100:103], v[112:115], a[16:31]
    ds_read_b128 v[68:71], v3 offset:34816
    ds_read_b64_tr_b16 v[84:85], v8 offset:49152
    ds_read_b64_tr_b16 v[86:87], v8 offset:49664
    v_mfma_f32_32x32x16_bf16 a[64:79], v[96:99], v[116:119], a[64:79]
    ds_read_b64_tr_b16 v[88:89], v7 offset:53248
    ds_read_b64_tr_b16 v[90:91], v7 offset:53760
    ds_read_b64_tr_b16 v[92:93], v8 offset:53248
    v_mfma_f32_32x32x16_bf16 a[80:95], v[100:103], v[116:119], a[80:95]
    ds_read_b64_tr_b16 v[94:95], v8 offset:53760
    v_mfma_f32_32x32x16_bf16 a[128:143], v[96:99], v[120:123], a[128:143]
    s_add_u32 m0, s40, 65536
    s_nop 0
    buffer_load_dwordx4 v9, s[16:19], s29 offen offset:0 lds
    buffer_load_dwordx4 v10, s[16:19], s29 offen offset:1024 lds
    v_mfma_f32_32x32x16_bf16 a[144:159], v[100:103], v[120:123], a[144:159]
    s_add_u32 m0, s41, 65536
    s_add_u32 s29, s29, 64
    buffer_load_dwordx4 v13, s[20:23], s30 offen offset:0 lds
    v_mfma_f32_32x32x16_bf16 a[192:207], v[96:99], v[124:127], a[192:207]
    buffer_load_dwordx4 v14, s[20:23], s30 offen offset:1024 lds
    buffer_load_dwordx4 v15, s[20:23], s30 offen offset:2048 lds
    v_mfma_f32_32x32x16_bf16 a[208:223], v[100:103], v[124:127], a[208:223]
    buffer_load_dwordx4 v16, s[20:23], s30 offen offset:3072 lds
    s_add_u32 s30, s30, s31
    s_sub_u32 s45, s45, 1
    s_cmp_eq_u32 s45, 0
    s_cselect_b32 s33, 1280, 0
    s_cselect_b32 s34, s42, 0
    s_sub_u32 s29, s29, s33
    s_sub_u32 s30, s30, s34
    s_waitcnt lgkmcnt(0)
    v_mfma_f32_32x32x16_bf16 a[0:15], v[64:67], v[80:83], a[0:15]
    ds_read_b128 v[96:99], v4 offset:32768
    ds_read_b64_tr_b16 v[112:113], v7 offset:51200
    v_mfma_f32_32x32x16_bf16 a[16:31], v[68:71], v[80:83], a[16:31]
    ds_read_b64_tr_b16 v[114:115], v7 offset:51712
    ds_read_b128 v[100:103], v4 offset:34816
    v_mfma_f32_32x32x16_bf16 a[64:79], v[64:67], v[84:87], a[64:79]
    ds_read_b64_tr_b16 v[116:117], v8 offset:51200
    ds_read_b64_tr_b16 v[118:119], v8 offset:51712
    v_mfma_f32_32x32x16_bf16 a[80:95], v[68:71], v[84:87], a[80:95]
    ds_read_b64_tr_b16 v[120:121], v7 offset:55296
    ds_read_b64_tr_b16 v[122:123], v7 offset:55808
    v_mfma_f32_32x32x16_bf16 a[128:143], v[64:67], v[88:91], a[128:143]
    ds_read_b64_tr_b16 v[124:125], v8 offset:55296
    ds_read_b64_tr_b16 v[126:127], v8 offset:55808
    v_mfma_f32_32x32x16_bf16 a[144:159], v[68:71], v[88:91], a[144:159]
    v_mfma_f32_32x32x16_bf16 a[192:207], v[64:67], v[92:95], a[192:207]
    v_mfma_f32_32x32x16_bf16 a[208:223], v[68:71], v[92:95], a[208:223]
    s_waitcnt vmcnt(12) lgkmcnt(0)
    s_barrier
    v_mfma_f32_32x32x16_bf16 a[0:15], v[96:99], v[112:115], a[0:15]
    ds_read_b128 v[64:67], v1 offset:0
    ds_read_b64_tr_b16 v[80:81], v5 offset:16384
    ds_read_b64_tr_b16 v[82:83], v5 offset:16896
    v_mfma_f32_32x32x16_bf16 a[16:31], v[100:103], v[112:115], a[16:31]
    ds_read_b128 v[68:71], v1 offset:2048
    ds_read_b64_tr_b16 v[84:85], v6 offset:16384
    ds_read_b64_tr_b16 v[86:87], v6 offset:16896
    v_mfma_f32_32x32x16_bf16 a[64:79], v[96:99], v[116:119], a[64:79]
    ds_read_b64_tr_b16 v[88:89], v5 offset:20480
    ds_read_b64_tr_b16 v[90:91], v5 offset:20992
    ds_read_b64_tr_b16 v[92:93], v6 offset:20480
    v_mfma_f32_32x32x16_bf16 a[80:95], v[100:103], v[116:119], a[80:95]
    ds_read_b64_tr_b16 v[94:95], v6 offset:20992
    v_mfma_f32_32x32x16_bf16 a[128:143], v[96:99], v[120:123], a[128:143]
    s_add_u32 m0, s40, 98304
    s_nop 0
    buffer_load_dwordx4 v9, s[16:19], s29 offen offset:0 lds
    buffer_load_dwordx4 v10, s[16:19], s29 offen offset:1024 lds
    v_mfma_f32_32x32x16_bf16 a[144:159], v[100:103], v[120:123], a[144:159]
    s_add_u32 m0, s41, 98304
    s_add_u32 s29, s29, 64
    buffer_load_dwordx4 v13, s[20:23], s30 offen offset:0 lds
    v_mfma_f32_32x32x16_bf16 a[192:207], v[96:99], v[124:127], a[192:207]
    buffer_load_dwordx4 v14, s[20:23], s30 offen offset:1024 lds
    buffer_load_dwordx4 v15, s[20:23], s30 offen offset:2048 lds
    v_mfma_f32_32x32x16_bf16 a[208:223], v[100:103], v[124:127], a[208:223]
    buffer_load_dwordx4 v16, s[20:23], s30 offen offset:3072 lds
    s_add_u32 s30, s30, s31
    s_sub_u32 s45, s45, 1
    s_cmp_eq_u32 s45, 0
    s_cselect_b32 s33, 1280, 0
    s_cselect_b32 s34, s42, 0
    s_sub_u32 s29, s29, s33
    s_sub_u32 s30, s30, s34
    s_add_u32 s32, s32, 1
    s_cmp_lt_u32 s32, 4
    s_cbranch_scc1 G2_LOOP_V_0
    s_waitcnt lgkmcnt(0)
    v_mfma_f32_32x32x16_bf16 a[0:15], v[64:67], v[80:83], a[0:15]
    ds_read_b128 v[96:99], v2 offset:0
    ds_read_b64_tr_b16 v[112:113], v5 offset:18432
    v_mfma_f32_32x32x16_bf16 a[16:31], v[68:71], v[80:83], a[16:31]
    ds_read_b64_tr_b16 v[114:115], v5 offset:18944
    ds_read_b128 v[100:103], v2 offset:2048
    v_mfma_f32_32x32x16_bf16 a[64:79], v[64:67], v[84:87], a[64:79]
    ds_read_b64_tr_b16 v[116:117], v6 offset:18432
    ds_read_b64_tr_b16 v[118:119], v6 offset:18944
    v_mfma_f32_32x32x16_bf16 a[80:95], v[68:71], v[84:87], a[80:95]
    ds_read_b64_tr_b16 v[120:121], v5 offset:22528
    ds_read_b64_tr_b16 v[122:123], v5 offset:23040
    v_mfma_f32_32x32x16_bf16 a[128:143], v[64:67], v[88:91], a[128:143]
    ds_read_b64_tr_b16 v[124:125], v6 offset:22528
    ds_read_b64_tr_b16 v[126:127], v6 offset:23040
    v_mfma_f32_32x32x16_bf16 a[144:159], v[68:71], v[88:91], a[144:159]
    v_mfma_f32_32x32x16_bf16 a[192:207], v[64:67], v[92:95], a[192:207]
    v_mfma_f32_32x32x16_bf16 a[208:223], v[68:71], v[92:95], a[208:223]
    s_waitcnt vmcnt(12) lgkmcnt(0)
    s_barrier
    v_mfma_f32_32x32x16_bf16 a[0:15], v[96:99], v[112:115], a[0:15]
    ds_read_b128 v[64:67], v1 offset:32768
    ds_read_b64_tr_b16 v[80:81], v5 offset:49152
    ds_read_b64_tr_b16 v[82:83], v5 offset:49664
    v_mfma_f32_32x32x16_bf16 a[16:31], v[100:103], v[112:115], a[16:31]
    ds_read_b128 v[68:71], v1 offset:34816
    ds_read_b64_tr_b16 v[84:85], v6 offset:49152
    ds_read_b64_tr_b16 v[86:87], v6 offset:49664
    v_mfma_f32_32x32x16_bf16 a[64:79], v[96:99], v[116:119], a[64:79]
    ds_read_b64_tr_b16 v[88:89], v5 offset:53248
    ds_read_b64_tr_b16 v[90:91], v5 offset:53760
    ds_read_b64_tr_b16 v[92:93], v6 offset:53248
    v_mfma_f32_32x32x16_bf16 a[80:95], v[100:103], v[116:119], a[80:95]
    ds_read_b64_tr_b16 v[94:95], v6 offset:53760
    v_mfma_f32_32x32x16_bf16 a[128:143], v[96:99], v[120:123], a[128:143]
    v_mfma_f32_32x32x16_bf16 a[144:159], v[100:103], v[120:123], a[144:159]
    v_mfma_f32_32x32x16_bf16 a[192:207], v[96:99], v[124:127], a[192:207]
    v_mfma_f32_32x32x16_bf16 a[208:223], v[100:103], v[124:127], a[208:223]
    s_waitcnt lgkmcnt(0)
    v_mfma_f32_32x32x16_bf16 a[0:15], v[64:67], v[80:83], a[0:15]
    ds_read_b128 v[96:99], v2 offset:32768
    ds_read_b64_tr_b16 v[112:113], v5 offset:51200
    v_mfma_f32_32x32x16_bf16 a[16:31], v[68:71], v[80:83], a[16:31]
    ds_read_b64_tr_b16 v[114:115], v5 offset:51712
    ds_read_b128 v[100:103], v2 offset:34816
    v_mfma_f32_32x32x16_bf16 a[64:79], v[64:67], v[84:87], a[64:79]
    ds_read_b64_tr_b16 v[116:117], v6 offset:51200
    ds_read_b64_tr_b16 v[118:119], v6 offset:51712
    v_mfma_f32_32x32x16_bf16 a[80:95], v[68:71], v[84:87], a[80:95]
    ds_read_b64_tr_b16 v[120:121], v5 offset:55296
    ds_read_b64_tr_b16 v[122:123], v5 offset:55808
    v_mfma_f32_32x32x16_bf16 a[128:143], v[64:67], v[88:91], a[128:143]
    ds_read_b64_tr_b16 v[124:125], v6 offset:55296
    ds_read_b64_tr_b16 v[126:127], v6 offset:55808
    v_mfma_f32_32x32x16_bf16 a[144:159], v[68:71], v[88:91], a[144:159]
    v_mfma_f32_32x32x16_bf16 a[192:207], v[64:67], v[92:95], a[192:207]
    v_mfma_f32_32x32x16_bf16 a[208:223], v[68:71], v[92:95], a[208:223]
    s_waitcnt vmcnt(6) lgkmcnt(0)
    s_barrier
    v_mfma_f32_32x32x16_bf16 a[0:15], v[96:99], v[112:115], a[0:15]
    ds_read_b128 v[64:67], v3 offset:0
    ds_read_b64_tr_b16 v[80:81], v7 offset:16384
    ds_read_b64_tr_b16 v[82:83], v7 offset:16896
    v_mfma_f32_32x32x16_bf16 a[16:31], v[100:103], v[112:115], a[16:31]
    ds_read_b128 v[68:71], v3 offset:2048
    ds_read_b64_tr_b16 v[84:85], v8 offset:16384
    ds_read_b64_tr_b16 v[86:87], v8 offset:16896
    v_mfma_f32_32x32x16_bf16 a[64:79], v[96:99], v[116:119], a[64:79]
    ds_read_b64_tr_b16 v[88:89], v7 offset:20480
    ds_read_b64_tr_b16 v[90:91], v7 offset:20992
    ds_read_b64_tr_b16 v[92:93], v8 offset:20480
    v_mfma_f32_32x32x16_bf16 a[80:95], v[100:103], v[116:119], a[80:95]
    ds_read_b64_tr_b16 v[94:95], v8 offset:20992
    v_mfma_f32_32x32x16_bf16 a[128:143], v[96:99], v[120:123], a[128:143]
    v_mfma_f32_32x32x16_bf16 a[144:159], v[100:103], v[120:123], a[144:159]
    v_mfma_f32_32x32x16_bf16 a[192:207], v[96:99], v[124:127], a[192:207]
    v_mfma_f32_32x32x16_bf16 a[208:223], v[100:103], v[124:127], a[208:223]
    s_waitcnt lgkmcnt(0)
    v_mfma_f32_32x32x16_bf16 a[0:15], v[64:67], v[80:83], a[0:15]
    ds_read_b128 v[96:99], v4 offset:0
    ds_read_b64_tr_b16 v[112:113], v7 offset:18432
    v_mfma_f32_32x32x16_bf16 a[16:31], v[68:71], v[80:83], a[16:31]
    ds_read_b64_tr_b16 v[114:115], v7 offset:18944
    ds_read_b128 v[100:103], v4 offset:2048
    v_mfma_f32_32x32x16_bf16 a[64:79], v[64:67], v[84:87], a[64:79]
    ds_read_b64_tr_b16 v[116:117], v8 offset:18432
    ds_read_b64_tr_b16 v[118:119], v8 offset:18944
    v_mfma_f32_32x32x16_bf16 a[80:95], v[68:71], v[84:87], a[80:95]
    ds_read_b64_tr_b16 v[120:121], v7 offset:22528
    ds_read_b64_tr_b16 v[122:123], v7 offset:23040
    v_mfma_f32_32x32x16_bf16 a[128:143], v[64:67], v[88:91], a[128:143]
    ds_read_b64_tr_b16 v[124:125], v8 offset:22528
    ds_read_b64_tr_b16 v[126:127], v8 offset:23040
    v_mfma_f32_32x32x16_bf16 a[144:159], v[68:71], v[88:91], a[144:159]
    v_mfma_f32_32x32x16_bf16 a[192:207], v[64:67], v[92:95], a[192:207]
    v_mfma_f32_32x32x16_bf16 a[208:223], v[68:71], v[92:95], a[208:223]
    s_waitcnt vmcnt(0) lgkmcnt(0)
    s_barrier
    v_mfma_f32_32x32x16_bf16 a[0:15], v[96:99], v[112:115], a[0:15]
    ds_read_b128 v[64:67], v3 offset:32768
    ds_read_b64_tr_b16 v[80:81], v7 offset:49152
    ds_read_b64_tr_b16 v[82:83], v7 offset:49664
    v_mfma_f32_32x32x16_bf16 a[16:31], v[100:103], v[112:115], a[16:31]
    ds_read_b128 v[68:71], v3 offset:34816
    ds_read_b64_tr_b16 v[84:85], v8 offset:49152
    ds_read_b64_tr_b16 v[86:87], v8 offset:49664
    v_mfma_f32_32x32x16_bf16 a[64:79], v[96:99], v[116:119], a[64:79]
    ds_read_b64_tr_b16 v[88:89], v7 offset:53248
    ds_read_b64_tr_b16 v[90:91], v7 offset:53760
    ds_read_b64_tr_b16 v[92:93], v8 offset:53248
    v_mfma_f32_32x32x16_bf16 a[80:95], v[100:103], v[116:119], a[80:95]
    ds_read_b64_tr_b16 v[94:95], v8 offset:53760
    v_mfma_f32_32x32x16_bf16 a[128:143], v[96:99], v[120:123], a[128:143]
    v_mfma_f32_32x32x16_bf16 a[144:159], v[100:103], v[120:123], a[144:159]
    v_mfma_f32_32x32x16_bf16 a[192:207], v[96:99], v[124:127], a[192:207]
    v_mfma_f32_32x32x16_bf16 a[208:223], v[100:103], v[124:127], a[208:223]
    s_waitcnt lgkmcnt(0)
    v_mfma_f32_32x32x16_bf16 a[0:15], v[64:67], v[80:83], a[0:15]
    ds_read_b128 v[96:99], v4 offset:32768
    ds_read_b64_tr_b16 v[112:113], v7 offset:51200
    v_mfma_f32_32x32x16_bf16 a[16:31], v[68:71], v[80:83], a[16:31]
    ds_read_b64_tr_b16 v[114:115], v7 offset:51712
    ds_read_b128 v[100:103], v4 offset:34816
    v_mfma_f32_32x32x16_bf16 a[64:79], v[64:67], v[84:87], a[64:79]
    ds_read_b64_tr_b16 v[116:117], v8 offset:51200
    ds_read_b64_tr_b16 v[118:119], v8 offset:51712
    v_mfma_f32_32x32x16_bf16 a[80:95], v[68:71], v[84:87], a[80:95]
    ds_read_b64_tr_b16 v[120:121], v7 offset:55296
    ds_read_b64_tr_b16 v[122:123], v7 offset:55808
    v_mfma_f32_32x32x16_bf16 a[128:143], v[64:67], v[88:91], a[128:143]
    ds_read_b64_tr_b16 v[124:125], v8 offset:55296
    ds_read_b64_tr_b16 v[126:127], v8 offset:55808
    v_mfma_f32_32x32x16_bf16 a[144:159], v[68:71], v[88:91], a[144:159]
    v_mfma_f32_32x32x16_bf16 a[192:207], v[64:67], v[92:95], a[192:207]
    v_mfma_f32_32x32x16_bf16 a[208:223], v[68:71], v[92:95], a[208:223]
    s_waitcnt lgkmcnt(0)
    s_barrier
    v_mfma_f32_32x32x16_bf16 a[0:15], v[96:99], v[112:115], a[0:15]
    v_mfma_f32_32x32x16_bf16 a[16:31], v[100:103], v[112:115], a[16:31]
    v_mfma_f32_32x32x16_bf16 a[64:79], v[96:99], v[116:119], a[64:79]
    v_mfma_f32_32x32x16_bf16 a[80:95], v[100:103], v[116:119], a[80:95]
    v_mfma_f32_32x32x16_bf16 a[128:143], v[96:99], v[120:123], a[128:143]
    v_mfma_f32_32x32x16_bf16 a[144:159], v[100:103], v[120:123], a[144:159]
    v_mfma_f32_32x32x16_bf16 a[192:207], v[96:99], v[124:127], a[192:207]
    v_mfma_f32_32x32x16_bf16 a[208:223], v[100:103], v[124:127], a[208:223]
    s_branch G_EPI
G4_START:
    s_add_u32 m0, s40, 0
    s_nop 0
    buffer_load_dwordx4 v9, s[16:19], s29 offen offset:0 lds
    buffer_load_dwordx4 v10, s[16:19], s29 offen offset:1024 lds
    buffer_load_dwordx4 v11, s[16:19], s29 offen offset:2048 lds
    buffer_load_dwordx4 v12, s[16:19], s29 offen offset:3072 lds
    s_add_u32 m0, s41, 0
    s_add_u32 s29, s29, 64
    buffer_load_dwordx4 v13, s[20:23], s30 offen offset:0 lds
    buffer_load_dwordx4 v14, s[20:23], s30 offen offset:1024 lds
    buffer_load_dwordx4 v15, s[20:23], s30 offen offset:2048 lds
    buffer_load_dwordx4 v16, s[20:23], s30 offen offset:3072 lds
    s_add_u32 s30, s30, s31
    s_sub_u32 s45, s45, 1
    s_cmp_eq_u32 s45, 0
    s_cselect_b32 s33, 1280, 0
    s_cselect_b32 s34, s42, 0
    s_sub_u32 s29, s29, s33
    s_sub_u32 s30, s30, s34
    s_add_u32 m0, s40, 32768
    s_nop 0
    buffer_load_dwordx4 v9, s[16:19], s29 offen offset:0 lds
    buffer_load_dwordx4 v10, s[16:19], s29 offen offset:1024 lds
    buffer_load_dwordx4 v11, s[16:19], s29 offen offset:2048 lds
    buffer_load_dwordx4 v12, s[16:19], s29 offen offset:3072 lds
    s_add_u32 m0, s41, 32768
    s_add_u32 s29, s29, 64
    buffer_load_dwordx4 v13, s[20:23], s30 offen offset:0 lds
    buffer_load_dwordx4 v14, s[20:23], s30 offen offset:1024 lds
    buffer_load_dwordx4 v15, s[20:23], s30 offen offset:2048 lds
    buffer_load_dwordx4 v16, s[20:23], s30 offen offset:3072 lds
    s_add_u32 s30, s30, s31
    s_sub_u32 s45, s45, 1
    s_cmp_eq_u32 s45, 0
    s_cselect_b32 s33, 1280, 0
    s_cselect_b32 s34, s42, 0
    s_sub_u32 s29, s29, s33
    s_sub_u32 s30, s30, s34
    s_add_u32 m0, s40, 65536
    s_nop 0
    buffer_load_dwordx4 v9, s[16:19], s29 offen offset:0 lds
    buffer_load_dwordx4 v10, s[16:19], s29 offen offset:1024 lds
    buffer_load_dwordx4 v11, s[16:19], s29 offen offset:2048 lds
    buffer_load_dwordx4 v12, s[16:19], s29 offen offset:3072 lds
    s_add_u32 m0, s41, 65536
    s_add_u32 s29, s29, 64
    buffer_load_dwordx4 v13, s[20:23], s30 offen offset:0 lds
    buffer_load_dwordx4 v14, s[20:23], s30 offen offset:1024 lds
    buffer_load_dwordx4 v15, s[20:23], s30 offen offset:2048 lds
    buffer_load_dwordx4 v16, s[20:23], s30 offen offset:3072 lds
    s_add_u32 s30, s30, s31
    s_sub_u32 s45, s45, 1
    s_cmp_eq_u32 s45, 0
    s_cselect_b32 s33, 1280, 0
    s_cselect_b32 s34, s42, 0
    s_sub_u32 s29, s29, s33
    s_sub_u32 s30, s30, s34
    s_add_u32 m0, s40, 98304
    s_nop 0
    buffer_load_dwordx4 v9, s[16:19], s29 offen offset:0 lds
    buffer_load_dwordx4 v10, s[16:19], s29 offen offset:1024 lds
    buffer_load_dwordx4 v11, s[16:19], s29 offen offset:2048 lds
    buffer_load_dwordx4 v12, s[16:19], s29 offen offset:3072 lds
    s_add_u32 m0, s41, 98304
    s_add_u32 s29, s29, 64
    buffer_load_dwordx4 v13, s[20:23], s30 offen offset:0 lds
    buffer_load_dwordx4 v14, s[20:23], s30 offen offset:1024 lds
    buffer_load_dwordx4 v15, s[20:23], s30 offen offset:2048 lds
    buffer_load_dwordx4 v16, s[20:23], s30 offen offset:3072 lds
    s_add_u32 s30, s30, s31
    s_sub_u32 s45, s45, 1
    s_cmp_eq_u32 s45, 0
    s_cselect_b32 s33, 1280, 0
    s_cselect_b32 s34, s42, 0
    s_sub_u32 s29, s29, s33
    s_sub_u32 s30, s30, s34
    s_waitcnt vmcnt(24)
    s_barrier
    ds_read_b128 v[64:67], v1 offset:0
    ds_read_b64_tr_b16 v[80:81], v5 offset:16384
    ds_read_b64_tr_b16 v[82:83], v5 offset:16896
    ds_read_b128 v[68:71], v1 offset:2048
    ds_read_b128 v[72:75], v1 offset:4096
    ds_read_b128 v[76:79], v1 offset:6144
    ds_read_b64_tr_b16 v[84:85], v6 offset:16384
    ds_read_b64_tr_b16 v[86:87], v6 offset:16896
    ds_read_b64_tr_b16 v[88:89], v5 offset:20480
    ds_read_b64_tr_b16 v[90:91], v5 offset:20992
    ds_read_b64_tr_b16 v[92:93], v6 offset:20480
    ds_read_b64_tr_b16 v[94:95], v6 offset:20992
    s_cmp_eq_u32 s25, 1
    s_cbranch_scc1 G4_LOOP_V
G4_LOOP_K:
    s_waitcnt lgkmcnt(0)
    v_mfma_f32_32x32x16_bf16 a[0:15], v[80:83], v[64:67], 0
    ds_read_b128 v[96:99], v2 offset:0
    s_cmp_eq_u32 s46, 0
    s_cselect_b32 s49, 9, s5
    v_mfma_f32_32x32x16_bf16 a[16:31], v[80:83], v[68:71], 0
    ds_read_b64_tr_b16 v[112:113], v5 offset:18432
    s_cmp_eq_u32 s49, 0
    s_cbranch_scc0 DS_1
    buffer_store_dwordx4 v[128:131], v21, s[8:11], s47 offen offset:0 sc1
DS_1:
    v_mfma_f32_32x32x16_bf16 a[32:47], v[80:83], v[72:75], 0
    ds_read_b64_tr_b16 v[114:115], v5 offset:18944
    v_mfma_f32_32x32x16_bf16 a[48:63], v[80:83], v[76:79], 0
    ds_read_b128 v[100:103], v2 offset:2048
    v_mfma_f32_32x32x16_bf16 a[64:79], v[84:87], v[64:67], 0
    ds_read_b128 v[104:107], v2 offset:4096
    v_mfma_f32_32x32x16_bf16 a[80:95], v[84:87], v[68:71], 0
    ds_read_b128 v[108:111], v2 offset:6144
    s_cmp_eq_u32 s49, 1
    s_cbranch_scc0 DS_2
    buffer_store_dwordx4 v[128:131], v21, s[8:11], s47 offen offset:0 sc1
DS_2:
    v_mfma_f32_32x32x16_bf16 a[96:111], v[84:87], v[72:75], 0
    ds_read_b64_tr_b16 v[116:117], v6 offset:18432
    v_mfma_f32_32x32x16_bf16 a[112:127], v[84:87], v[76:79], 0
    ds_read_b64_tr_b16 v[118:119], v6 offset:18944
    v_mfma_f32_32x32x16_bf16 a[128:143], v[88:91], v[64:67], 0
    ds_read_b64_tr_b16 v[120:121], v5 offset:22528
    v_mfma_f32_32x32x16_bf16 a[144:159], v[88:91], v[68:71], 0
    ds_read_b64_tr_b16 v[122:123], v5 offset:23040
    s_cmp_eq_u32 s49, 2
    s_cbranch_scc0 DS_3
    buffer_store_dwordx4 v[128:131], v21, s[8:11], s47 offen offset:0 sc1
DS_3:
    v_mfma_f32_32x32x16_bf16 a[160:175], v[88:91], v[72:75], 0
    ds_read_b64_tr_b16 v[124:125], v6 offset:22528
    v_mfma_f32_32x32x16_bf16 a[176:191], v[88:91], v[76:79], 0
    ds_read_b64_tr_b16 v[126:127], v6 offset:23040
    v_mfma_f32_32x32x16_bf16 a[192:207], v[92:95], v[64:67], 0
    v_mfma_f32_32x32x16_bf16 a[208:223], v[92:95], v[68:71], 0
    s_cmp_eq_u32 s49, 3
    s_cbranch_scc0 DS_4
    buffer_store_dwordx4 v[128:131], v21, s[8:11], s47 offen offset:0 sc1
DS_4:
    v_mfma_f32_32x32x16_bf16 a[224:239], v[92:95], v[72:75], 0
    v_mfma_f32_32x32x16_bf16 a[240:255], v[92:95], v[76:79], 0
    s_waitcnt vmcnt(16) lgkmcnt(0)
    s_barrier
    v_mfma_f32_32x32x16_bf16 a[0:15], v[112:115], v[96:99], a[0:15]
    ds_read_b128 v[64:67], v1 offset:32768
    ds_read_b64_tr_b16 v[80:81], v5 offset:49152
    s_cmp_eq_u32 s49, 0
    s_cbranch_scc0 DS_5
    buffer_store_dwordx4 v[132:135], v21, s[8:11], s47 offen offset:1024 sc1
DS_5:
    v_mfma_f32_32x32x16_bf16 a[16:31], v[112:115], v[100:103], a[16:31]
    ds_read_b64_tr_b16 v[82:83], v5 offset:49664
    ds_read_b128 v[68:71], v1 offset:34816
    v_mfma_f32_32x32x16_bf16 a[32:47], v[112:115], v[104:107], a[32:47]
    ds_read_b128 v[72:75], v1 offset:36864
    ds_read_b128 v[76:79], v1 offset:38912
    v_mfma_f32_32x32x16_bf16 a[48:63], v[112:115], v[108:111], a[48:63]
    ds_read_b64_tr_b16 v[84:85], v6 offset:49152
    ds_read_b64_tr_b16 v[86:87], v6 offset:49664
    v_mfma_f32_32x32x16_bf16 a[64:79], v[116:119], v[96:99], a[64:79]
    ds_read_b64_tr_b16 v[88:89], v5 offset:53248
    ds_read_b64_tr_b16 v[90:91], v5 offset:53760
    s_cmp_eq_u32 s49, 1
    s_cbranch_scc0 DS_6
    buffer_store_dwordx4 v[132:135], v21, s[8:11], s47 offen offset:1024 sc1
DS_6:
    v_mfma_f32_32x32x16_bf16 a[80:95], v[116:119], v[100:103], a[80:95]
    ds_read_b64_tr_b16 v[92:93], v6 offset:53248
    ds_read_b64_tr_b16 v[94:95], v6 offset:53760
    v_mfma_f32_32x32x16_bf16 a[96:111], v[116:119], v[104:107], a[96:111]
    s_add_u32 m0, s40, 0
    s_nop 0
    buffer_load_dwordx4 v9, s[16:19], s29 offen offset:0 lds
    v_mfma_f32_32x32x16_bf16 a[112:127], v[116:119], v[108:111], a[112:127]
    buffer_load_dwordx4 v10, s[16:19], s29 offen offset:1024 lds
    v_mfma_f32_32x32x16_bf16 a[128:143], v[120:123], v[96:99], a[128:143]
    buffer_load_dwordx4 v11, s[16:19], s29 offen offset:2048 lds
    s_cmp_eq_u32 s49, 2
    s_cbranch_scc0 DS_7
    buffer_store_dwordx4 v[132:135], v21, s[8:11], s47 offen offset:1024 sc1
DS_7:
    v_mfma_f32_32x32x16_bf16 a[144:159], v[120:123], v[100:103], a[144:159]
    buffer_load_dwordx4 v12, s[16:19], s29 offen offset:3072 lds
    v_mfma_f32_32x32x16_bf16 a[160:175], v[120:123], v[104:107], a[160:175]
    s_add_u32 m0, s41, 0
    s_add_u32 s29, s29, 64
    buffer_load_dwordx4 v13, s[20:23], s30 offen offset:0 lds
    v_mfma_f32_32x32x16_bf16 a[176:191], v[120:123], v[108:111], a[176:191]
    buffer_load_dwordx4 v14, s[20:23], s30 offen offset:1024 lds
    v_mfma_f32_32x32x16_bf16 a[192:207], v[124:127], v[96:99], a[192:207]
    buffer_load_dwordx4 v15, s[20:23], s30 offen offset:2048 lds
    s_cmp_eq_u32 s49, 3
    s_cbranch_scc0 DS_8
    buffer_store_dwordx4 v[132:135], v21, s[8:11], s47 offen offset:1024 sc1
DS_8:
    v_mfma_f32_32x32x16_bf16 a[208:223], v[124:127], v[100:103], a[208:223]
    buffer_load_dwordx4 v16, s[20:23], s30 offen offset:3072 lds
    s_add_u32 s30, s30, s31
    s_sub_u32 s45, s45, 1
    s_cmp_eq_u32 s45, 0
    s_cselect_b32 s33, 1280, 0
    s_cselect_b32 s34, s42, 0
    s_sub_u32 s29, s29, s33
    s_sub_u32 s30, s30, s34
    v_mov_b64 v[128:129], v[160:161]
    v_mov_b64 v[130:131], v[162:163]
    v_mov_b64 v[132:133], v[164:165]
    v_mov_b64 v[134:135], v[166:167]
    v_mfma_f32_32x32x16_bf16 a[224:239], v[124:127], v[104:107], a[224:239]
    v_mov_b64 v[160:161], v[192:193]
    v_mov_b64 v[162:163], v[194:195]
    v_mov_b64 v[164:165], v[196:197]
    v_mov_b64 v[166:167], v[198:199]
    v_mfma_f32_32x32x16_bf16 a[240:255], v[124:127], v[108:111], a[240:255]
    v_mov_b64 v[192:193], v[224:225]
    v_mov_b64 v[194:195], v[226:227]
    v_mov_b64 v[196:197], v[228:229]
    v_mov_b64 v[198:199], v[230:231]
    s_add_u32 s47, s47, 2048
    s_mov_b32 s32, 0
    s_branch G4_LOOP_K_1
G4_LOOP_K_0:
    s_waitcnt lgkmcnt(0)
    v_mfma_f32_32x32x16_bf16 a[0:15], v[80:83], v[64:67], a[0:15]
    ds_read_b128 v[96:99], v2 offset:0
    s_cmp_eq_u32 s46, 0
    s_cselect_b32 s49, 9, s5
    v_mfma_f32_32x32x16_bf16 a[16:31], v[80:83], v[68:71], a[16:31]
    ds_read_b64_tr_b16 v[112:113], v5 offset:18432
    s_cmp_eq_u32 s49, 0
    s_cbranch_scc0 DS_9
    buffer_store_dwordx4 v[128:131], v21, s[8:11], s47 offen offset:0 sc1
DS_9:
    v_mfma_f32_32x32x16_bf16 a[32:47], v[80:83], v[72:75], a[32:47]
    ds_read_b64_tr_b16 v[114:115], v5 offset:18944
    v_mfma_f32_32x32x16_bf16 a[48:63], v[80:83], v[76:79], a[48:63]
    ds_read_b128 v[100:103], v2 offset:2048
    v_mfma_f32_32x32x16_bf16 a[64:79], v[84:87], v[64:67], a[64:79]
    ds_read_b128 v[104:107], v2 offset:4096
    v_mfma_f32_32x32x16_bf16 a[80:95], v[84:87], v[68:71], a[80:95]
    ds_read_b128 v[108:111], v2 offset:6144
    s_cmp_eq_u32 s49, 1
    s_cbranch_scc0 DS_10
    buffer_store_dwordx4 v[128:131], v21, s[8:11], s47 offen offset:0 sc1
DS_10:
    v_mfma_f32_32x32x16_bf16 a[96:111], v[84:87], v[72:75], a[96:111]
    ds_read_b64_tr_b16 v[116:117], v6 offset:18432
    v_mfma_f32_32x32x16_bf16 a[112:127], v[84:87], v[76:79], a[112:127]
    ds_read_b64_tr_b16 v[118:119], v6 offset:18944
    v_mfma_f32_32x32x16_bf16 a[128:143], v[88:91], v[64:67], a[128:143]
    ds_read_b64_tr_b16 v[120:121], v5 offset:22528
    v_mfma_f32_32x32x16_bf16 a[144:159], v[88:91], v[68:71], a[144:159]
    ds_read_b64_tr_b16 v[122:123], v5 offset:23040
    s_cmp_eq_u32 s49, 2
    s_cbranch_scc0 DS_11
    buffer_store_dwordx4 v[128:131], v21, s[8:11], s47 offen offset:0 sc1
DS_11:
    v_mfma_f32_32x32x16_bf16 a[160:175], v[88:91], v[72:75], a[160:175]
    ds_read_b64_tr_b16 v[124:125], v6 offset:22528
    v_mfma_f32_32x32x16_bf16 a[176:191], v[88:91], v[76:79], a[176:191]
    ds_read_b64_tr_b16 v[126:127], v6 offset:23040
    v_mfma_f32_32x32x16_bf16 a[192:207], v[92:95], v[64:67], a[192:207]
    v_mfma_f32_32x32x16_bf16 a[208:223], v[92:95], v[68:71], a[208:223]
    s_cmp_eq_u32 s49, 3
    s_cbranch_scc0 DS_12
    buffer_store_dwordx4 v[128:131], v21, s[8:11], s47 offen offset:0 sc1
DS_12:
    v_mfma_f32_32x32x16_bf16 a[224:239], v[92:95], v[72:75], a[224:239]
    v_mfma_f32_32x32x16_bf16 a[240:255], v[92:95], v[76:79], a[240:255]
    s_waitcnt vmcnt(16) lgkmcnt(0)
    s_barrier
    v_mfma_f32_32x32x16_bf16 a[0:15], v[112:115], v[96:99], a[0:15]
    ds_read_b128 v[64:67], v1 offset:32768
    ds_read_b64_tr_b16 v[80:81], v5 offset:49152
    s_cmp_eq_u32 s49, 0
    s_cbranch_scc0 DS_13
    buffer_store_dwordx4 v[132:135], v21, s[8:11], s47 offen offset:1024 sc1
DS_13:
    v_mfma_f32_32x32x16_bf16 a[16:31], v[112:115], v[100:103], a[16:31]
    ds_read_b64_tr_b16 v[82:83], v5 offset:49664
    ds_read_b128 v[68:71], v1 offset:34816
    v_mfma_f32_32x32x16_bf16 a[32:47], v[112:115], v[104:107], a[32:47]
    ds_read_b128 v[72:75], v1 offset:36864
    ds_read_b128 v[76:79], v1 offset:38912
    v_mfma_f32_32x32x16_bf16 a[48:63], v[112:115], v[108:111], a[48:63]
    ds_read_b64_tr_b16 v[84:85], v6 offset:49152
    ds_read_b64_tr_b16 v[86:87], v6 offset:49664
    v_mfma_f32_32x32x16_bf16 a[64:79], v[116:119], v[96:99], a[64:79]
    ds_read_b64_tr_b16 v[88:89], v5 offset:53248
    ds_read_b64_tr_b16 v[90:91], v5 offset:53760
    s_cmp_eq_u32 s49, 1
    s_cbranch_scc0 DS_14
    buffer_store_dwordx4 v[132:135], v21, s[8:11], s47 offen offset:1024 sc1
DS_14:
    v_mfma_f32_32x32x16_bf16 a[80:95], v[116:119], v[100:103], a[80:95]
    ds_read_b64_tr_b16 v[92:93], v6 offset:53248
    ds_read_b64_tr_b16 v[94:95], v6 offset:53760
    v_mfma_f32_32x32x16_bf16 a[96:111], v[116:119], v[104:107], a[96:111]
    s_add_u32 m0, s40, 0
    s_nop 0
    buffer_load_dwordx4 v9, s[16:19], s29 offen offset:0 lds
    v_mfma_f32_32x32x16_bf16 a[112:127], v[116:119], v[108:111], a[112:127]
    buffer_load_dwordx4 v10, s[16:19], s29 offen offset:1024 lds
    v_mfma_f32_32x32x16_bf16 a[128:143], v[120:123], v[96:99], a[128:143]
    buffer_load_dwordx4 v11, s[16:19], s29 offen offset:2048 lds
    s_cmp_eq_u32 s49, 2
    s_cbranch_scc0 DS_15
    buffer_store_dwordx4 v[132:135], v21, s[8:11], s47 offen offset:1024 sc1
DS_15:
    v_mfma_f32_32x32x16_bf16 a[144:159], v[120:123], v[100:103], a[144:159]
    buffer_load_dwordx4 v12, s[16:19], s29 offen offset:3072 lds
    v_mfma_f32_32x32x16_bf16 a[160:175], v[120:123], v[104:107], a[160:175]
    s_add_u32 m0, s41, 0
    s_add_u32 s29, s29, 64
    buffer_load_dwordx4 v13, s[20:23], s30 offen offset:0 lds
    v_mfma_f32_32x32x16_bf16 a[176:191], v[120:123], v[108:111], a[176:191]
    buffer_load_dwordx4 v14, s[20:23], s30 offen offset:1024 lds
    v_mfma_f32_32x32x16_bf16 a[192:207], v[124:127], v[96:99], a[192:207]
    buffer_load_dwordx4 v15, s[20:23], s30 offen offset:2048 lds
    s_cmp_eq_u32 s49, 3
    s_cbranch_scc0 DS_16
    buffer_store_dwordx4 v[132:135], v21, s[8:11], s47 offen offset:1024 sc1
DS_16:
    v_mfma_f32_32x32x16_bf16 a[208:223], v[124:127], v[100:103], a[208:223]
    buffer_load_dwordx4 v16, s[20:23], s30 offen offset:3072 lds
    s_add_u32 s30, s30, s31
    s_sub_u32 s45, s45, 1
    s_cmp_eq_u32 s45, 0
    s_cselect_b32 s33, 1280, 0
    s_cselect_b32 s34, s42, 0
    s_sub_u32 s29, s29, s33
    s_sub_u32 s30, s30, s34
    v_mov_b64 v[128:129], v[160:161]
    v_mov_b64 v[130:131], v[162:163]
    v_mov_b64 v[132:133], v[164:165]
    v_mov_b64 v[134:135], v[166:167]
    v_mfma_f32_32x32x16_bf16 a[224:239], v[124:127], v[104:107], a[224:239]
    v_mov_b64 v[160:161], v[192:193]
    v_mov_b64 v[162:163], v[194:195]
    v_mov_b64 v[164:165], v[196:197]
    v_mov_b64 v[166:167], v[198:199]
    v_mfma_f32_32x32x16_bf16 a[240:255], v[124:127], v[108:111], a[240:255]
    v_mov_b64 v[192:193], v[224:225]
    v_mov_b64 v[194:195], v[226:227]
    v_mov_b64 v[196:197], v[228:229]
    v_mov_b64 v[198:199], v[230:231]
    s_add_u32 s47, s47, 2048
G4_LOOP_K_1:
    s_waitcnt lgkmcnt(0)
    v_mfma_f32_32x32x16_bf16 a[0:15], v[80:83], v[64:67], a[0:15]
    ds_read_b128 v[96:99], v2 offset:32768
    s_cmp_eq_u32 s46, 0
    s_cselect_b32 s49, 9, s5
    v_mfma_f32_32x32x16_bf16 a[16:31], v[80:83], v[68:71], a[16:31]
    ds_read_b64_tr_b16 v[112:113], v5 offset:51200
    s_cmp_eq_u32 s49, 0
    s_cbranch_scc0 DS_17
    buffer_store_dwordx4 v[136:139], v21, s[8:11], s47 offen offset:0 sc1
DS_17:
    v_mfma_f32_32x32x16_bf16 a[32:47], v[80:83], v[72:75], a[32:47]
    ds_read_b64_tr_b16 v[114:115], v5 offset:51712
    v_mfma_f32_32x32x16_bf16 a[48:63], v[80:83], v[76:79], a[48:63]
    ds_read_b128 v[100:103], v2 offset:34816
    v_mfma_f32_32x32x16_bf16 a[64:79], v[84:87], v[64:67], a[64:79]
    ds_read_b128 v[104:107], v2 offset:36864
    v_mfma_f32_32x32x16_bf16 a[80:95], v[84:87], v[68:71], a[80:95]
    ds_read_b128 v[108:111], v2 offset:38912
    s_cmp_eq_u32 s49, 1
    s_cbranch_scc0 DS_18
    buffer_store_dwordx4 v[136:139], v21, s[8:11], s47 offen offset:0 sc1
DS_18:
    v_mfma_f32_32x32x16_bf16 a[96:111], v[84:87], v[72:75], a[96:111]
    ds_read_b64_tr_b16 v[116:117], v6 offset:51200
    v_mfma_f32_32x32x16_bf16 a[112:127], v[84:87], v[76:79], a[112:127]
    ds_read_b64_tr_b16 v[118:119], v6 offset:51712
    v_mfma_f32_32x32x16_bf16 a[128:143], v[88:91], v[64:67], a[128:143]
    ds_read_b64_tr_b16 v[120:121], v5 offset:55296
    v_mfma_f32_32x32x16_bf16 a[144:159], v[88:91], v[68:71], a[144:159]
    ds_read_b64_tr_b16 v[122:123], v5 offset:55808
    s_cmp_eq_u32 s49, 2
    s_cbranch_scc0 DS_19
    buffer_store_dwordx4 v[136:139], v21, s[8:11], s47 offen offset:0 sc1
DS_19:
    v_mfma_f32_32x32x16_bf16 a[160:175], v[88:91], v[72:75], a[160:175]
    ds_read_b64_tr_b16 v[124:125], v6 offset:55296
    v_mfma_f32_32x32x16_bf16 a[176:191], v[88:91], v[76:79], a[176:191]
    ds_read_b64_tr_b16 v[126:127], v6 offset:55808
    v_mfma_f32_32x32x16_bf16 a[192:207], v[92:95], v[64:67], a[192:207]
    v_mfma_f32_32x32x16_bf16 a[208:223], v[92:95], v[68:71], a[208:223]
    s_cmp_eq_u32 s49, 3
    s_cbranch_scc0 DS_20
    buffer_store_dwordx4 v[136:139], v21, s[8:11], s47 offen offset:0 sc1
DS_20:
    v_mfma_f32_32x32x16_bf16 a[224:239], v[92:95], v[72:75], a[224:239]
    v_mfma_f32_32x32x16_bf16 a[240:255], v[92:95], v[76:79], a[240:255]
    s_waitcnt vmcnt(16) lgkmcnt(0)
    s_barrier
    v_mfma_f32_32x32x16_bf16 a[0:15], v[112:115], v[96:99], a[0:15]
    ds_read_b128 v[64:67], v3 offset:0
    ds_read_b64_tr_b16 v[80:81], v7 offset:16384
    s_cmp_eq_u32 s49, 0
    s_cbranch_scc0 DS_21
    buffer_store_dwordx4 v[140:143], v21, s[8:11], s47 offen offset:1024 sc1
DS_21:
    v_mfma_f32_32x32x16_bf16 a[16:31], v[112:115], v[100:103], a[16:31]
    ds_read_b64_tr_b16 v[82:83], v7 offset:16896
    ds_read_b128 v[68:71], v3 offset:2048
    v_mfma_f32_32x32x16_bf16 a[32:47], v[112:115], v[104:107], a[32:47]
    ds_read_b128 v[72:75], v3 offset:4096
    ds_read_b128 v[76:79], v3 offset:6144
    v_mfma_f32_32x32x16_bf16 a[48:63], v[112:115], v[108:111], a[48:63]
    ds_read_b64_tr_b16 v[84:85], v8 offset:16384
    ds_read_b64_tr_b16 v[86:87], v8 offset:16896
    v_mfma_f32_32x32x16_bf16 a[64:79], v[116:119], v[96:99], a[64:79]
    ds_read_b64_tr_b16 v[88:89], v7 offset:20480
    ds_read_b64_tr_b16 v[90:91], v7 offset:20992
    s_cmp_eq_u32 s49, 1
    s_cbranch_scc0 DS_22
    buffer_store_dwordx4 v[140:143], v21, s[8:11], s47 offen offset:1024 sc1
DS_22:
    v_mfma_f32_32x32x16_bf16 a[80:95], v[116:119], v[100:103], a[80:95]
    ds_read_b64_tr_b16 v[92:93], v8 offset:20480
    ds_read_b64_tr_b16 v[94:95], v8 offset:20992
    v_mfma_f32_32x32x16_bf16 a[96:111], v[116:119], v[104:107], a[96:111]
    s_add_u32 m0, s40, 32768
    s_nop 0
    buffer_load_dwordx4 v9, s[16:19], s29 offen offset:0 lds
    v_mfma_f32_32x32x16_bf16 a[112:127], v[116:119], v[108:111], a[112:127]
    buffer_load_dwordx4 v10, s[16:19], s29 offen offset:1024 lds
    v_mfma_f32_32x32x16_bf16 a[128:143], v[120:123], v[96:99], a[128:143]
    buffer_load_dwordx4 v11, s[16:19], s29 offen offset:2048 lds
    s_cmp_eq_u32 s49, 2
    s_cbranch_scc0 DS_23
    buffer_store_dwordx4 v[140:143], v21, s[8:11], s47 offen offset:1024 sc1
DS_23:
    v_mfma_f32_32x32x16_bf16 a[144:159], v[120:123], v[100:103], a[144:159]
    buffer_load_dwordx4 v12, s[16:19], s29 offen offset:3072 lds
    v_mfma_f32_32x32x16_bf16 a[160:175], v[120:123], v[104:107], a[160:175]
    s_add_u32 m0, s41, 32768
    s_add_u32 s29, s29, 64
    buffer_load_dwordx4 v13, s[20:23], s30 offen offset:0 lds
    v_mfma_f32_32x32x16_bf16 a[176:191], v[120:123], v[108:111], a[176:191]
    buffer_load_dwordx4 v14, s[20:23], s30 offen offset:1024 lds
    v_mfma_f32_32x32x16_bf16 a[192:207], v[124:127], v[96:99], a[192:207]
    buffer_load_dwordx4 v15, s[20:23], s30 offen offset:2048 lds
    s_cmp_eq_u32 s49, 3
    s_cbranch_scc0 DS_24
    buffer_store_dwordx4 v[140:143], v21, s[8:11], s47 offen offset:1024 sc1
DS_24:
    v_mfma_f32_32x32x16_bf16 a[208:223], v[124:127], v[100:103], a[208:223]
    buffer_load_dwordx4 v16, s[20:23], s30 offen offset:3072 lds
    s_add_u32 s30, s30, s31
    s_sub_u32 s45, s45, 1
    s_cmp_eq_u32 s45, 0
    s_cselect_b32 s33, 1280, 0
    s_cselect_b32 s34, s42, 0
    s_sub_u32 s29, s29, s33
    s_sub_u32 s30, s30, s34
    v_mov_b64 v[136:137], v[168:169]
    v_mov_b64 v[138:139], v[170:171]
    v_mov_b64 v[140:141], v[172:173]
    v_mov_b64 v[142:143], v[174:175]
    v_mfma_f32_32x32x16_bf16 a[224:239], v[124:127], v[104:107], a[224:239]
    v_mov_b64 v[168:169], v[200:201]
    v_mov_b64 v[170:171], v[202:203]
    v_mov_b64 v[172:173], v[204:205]
    v_mov_b64 v[174:175], v[206:207]
    v_mfma_f32_32x32x16_bf16 a[240:255], v[124:127], v[108:111], a[240:255]
    v_mov_b64 v[200:201], v[232:233]
    v_mov_b64 v[202:203], v[234:235]
    v_mov_b64 v[204:205], v[236:237]
    v_mov_b64 v[206:207], v[238:239]
    s_add_u32 s47, s47, 2048
    s_waitcnt lgkmcnt(0)
    v_mfma_f32_32x32x16_bf16 a[0:15], v[80:83], v[64:67], a[0:15]
    ds_read_b128 v[96:99], v4 offset:0
    s_cmp_eq_u32 s46, 0
    s_cselect_b32 s49, 9, s5
    v_mfma_f32_32x32x16_bf16 a[16:31], v[80:83], v[68:71], a[16:31]
    ds_read_b64_tr_b16 v[112:113], v7 offset:18432
    s_cmp_eq_u32 s49, 0
    s_cbranch_scc0 DS_25
    buffer_store_dwordx4 v[144:147], v21, s[8:11], s47 offen offset:0 sc1
DS_25:
    v_mfma_f32_32x32x16_bf16 a[32:47], v[80:83], v[72:75], a[32:47]
    ds_read_b64_tr_b16 v[114:115], v7 offset:18944
    v_mfma_f32_32x32x16_bf16 a[48:63], v[80:83], v[76:79], a[48:63]
    ds_read_b128 v[100:103], v4 offset:2048
    v_mfma_f32_32x32x16_bf16 a[64:79], v[84:87], v[64:67], a[64:79]
    ds_read_b128 v[104:107], v4 offset:4096
    v_mfma_f32_32x32x16_bf16 a[80:95], v[84:87], v[68:71], a[80:95]
    ds_read_b128 v[108:111], v4 offset:6144
    s_cmp_eq_u32 s49, 1
    s_cbranch_scc0 DS_26
    buffer_store_dwordx4 v[144:147], v21, s[8:11], s47 offen offset:0 sc1
DS_26:
    v_mfma_f32_32x32x16_bf16 a[96:111], v[84:87], v[72:75], a[96:111]
    ds_read_b64_tr_b16 v[116:117], v8 offset:18432
    v_mfma_f32_32x32x16_bf16 a[112:127], v[84:87], v[76:79], a[112:127]
    ds_read_b64_tr_b16 v[118:119], v8 offset:18944
    v_mfma_f32_32x32x16_bf16 a[128:143], v[88:91], v[64:67], a[128:143]
    ds_read_b64_tr_b16 v[120:121], v7 offset:22528
    v_mfma_f32_32x32x16_bf16 a[144:159], v[88:91], v[68:71], a[144:159]
    ds_read_b64_tr_b16 v[122:123], v7 offset:23040
    s_cmp_eq_u32 s49, 2
    s_cbranch_scc0 DS_27
    buffer_store_dwordx4 v[144:147], v21, s[8:11], s47 offen offset:0 sc1
DS_27:
    v_mfma_f32_32x32x16_bf16 a[160:175], v[88:91], v[72:75], a[160:175]
    ds_read_b64_tr_b16 v[124:125], v8 offset:22528
    v_mfma_f32_32x32x16_bf16 a[176:191], v[88:91], v[76:79], a[176:191]
    ds_read_b64_tr_b16 v[126:127], v8 offset:23040
    v_mfma_f32_32x32x16_bf16 a[192:207], v[92:95], v[64:67], a[192:207]
    v_mfma_f32_32x32x16_bf16 a[208:223], v[92:95], v[68:71], a[208:223]
    s_cmp_eq_u32 s49, 3
    s_cbranch_scc0 DS_28
    buffer_store_dwordx4 v[144:147], v21, s[8:11], s47 offen offset:0 sc1
DS_28:
    v_mfma_f32_32x32x16_bf16 a[224:239], v[92:95], v[72:75], a[224:239]
    v_mfma_f32_32x32x16_bf16 a[240:255], v[92:95], v[76:79], a[240:255]
    s_waitcnt vmcnt(16) lgkmcnt(0)
    s_barrier
    v_mfma_f32_32x32x16_bf16 a[0:15], v[112:115], v[96:99], a[0:15]
    ds_read_b128 v[64:67], v3 offset:32768
    ds_read_b64_tr_b16 v[80:81], v7 offset:49152
    s_cmp_eq_u32 s49, 0
    s_cbranch_scc0 DS_29
    buffer_store_dwordx4 v[148:151], v21, s[8:11], s47 offen offset:1024 sc1
DS_29:
    v_mfma_f32_32x32x16_bf16 a[16:31], v[112:115], v[100:103], a[16:31]
    ds_read_b64_tr_b16 v[82:83], v7 offset:49664
    ds_read_b128 v[68:71], v3 offset:34816
    v_mfma_f32_32x32x16_bf16 a[32:47], v[112:115], v[104:107], a[32:47]
    ds_read_b128 v[72:75], v3 offset:36864
    ds_read_b128 v[76:79], v3 offset:38912
    v_mfma_f32_32x32x16_bf16 a[48:63], v[112:115], v[108:111], a[48:63]
    ds_read_b64_tr_b16 v[84:85], v8 offset:49152
    ds_read_b64_tr_b16 v[86:87], v8 offset:49664
    v_mfma_f32_32x32x16_bf16 a[64:79], v[116:119], v[96:99], a[64:79]
    ds_read_b64_tr_b16 v[88:89], v7 offset:53248
    ds_read_b64_tr_b16 v[90:91], v7 offset:53760
    s_cmp_eq_u32 s49, 1
    s_cbranch_scc0 DS_30
    buffer_store_dwordx4 v[148:151], v21, s[8:11], s47 offen offset:1024 sc1
DS_30:
    v_mfma_f32_32x32x16_bf16 a[80:95], v[116:119], v[100:103], a[80:95]
    ds_read_b64_tr_b16 v[92:93], v8 offset:53248
    ds_read_b64_tr_b16 v[94:95], v8 offset:53760
    v_mfma_f32_32x32x16_bf16 a[96:111], v[116:119], v[104:107], a[96:111]
    s_add_u32 m0, s40, 65536
    s_nop 0
    buffer_load_dwordx4 v9, s[16:19], s29 offen offset:0 lds
    v_mfma_f32_32x32x16_bf16 a[112:127], v[116:119], v[108:111], a[112:127]
    buffer_load_dwordx4 v10, s[16:19], s29 offen offset:1024 lds
    v_mfma_f32_32x32x16_bf16 a[128:143], v[120:123], v[96:99], a[128:143]
    buffer_load_dwordx4 v11, s[16:19], s29 offen offset:2048 lds
    s_cmp_eq_u32 s49, 2
    s_cbranch_scc0 DS_31
    buffer_store_dwordx4 v[148:151], v21, s[8:11], s47 offen offset:1024 sc1
DS_31:
    v_mfma_f32_32x32x16_bf16 a[144:159], v[120:123], v[100:103], a[144:159]
    buffer_load_dwordx4 v12, s[16:19], s29 offen offset:3072 lds
    v_mfma_f32_32x32x16_bf16 a[160:175], v[120:123], v[104:107], a[160:175]
    s_add_u32 m0, s41, 65536
    s_add_u32 s29, s29, 64
    buffer_load_dwordx4 v13, s[20:23], s30 offen offset:0 lds
    v_mfma_f32_32x32x16_bf16 a[176:191], v[120:123], v[108:111], a[176:191]
    buffer_load_dwordx4 v14, s[20:23], s30 offen offset:1024 lds
    v_mfma_f32_32x32x16_bf16 a[192:207], v[124:127], v[96:99], a[192:207]
    buffer_load_dwordx4 v15, s[20:23], s30 offen offset:2048 lds
    s_cmp_eq_u32 s49, 3
    s_cbranch_scc0 DS_32
    buffer_store_dwordx4 v[148:151], v21, s[8:11], s47 offen offset:1024 sc1
DS_32:
    v_mfma_f32_32x32x16_bf16 a[208:223], v[124:127], v[100:103], a[208:223]
    buffer_load_dwordx4 v16, s[20:23], s30 offen offset:3072 lds
    s_add_u32 s30, s30, s31
    s_sub_u32 s45, s45, 1
    s_cmp_eq_u32 s45, 0
    s_cselect_b32 s33, 1280, 0
    s_cselect_b32 s34, s42, 0
    s_sub_u32 s29, s29, s33
    s_sub_u32 s30, s30, s34
    v_mov_b64 v[144:145], v[176:177]
    v_mov_b64 v[146:147], v[178:179]
    v_mov_b64 v[148:149], v[180:181]
    v_mov_b64 v[150:151], v[182:183]
    v_mfma_f32_32x32x16_bf16 a[224:239], v[124:127], v[104:107], a[224:239]
    v_mov_b64 v[176:177], v[208:209]
    v_mov_b64 v[178:179], v[210:211]
    v_mov_b64 v[180:181], v[212:213]
    v_mov_b64 v[182:183], v[214:215]
    v_mfma_f32_32x32x16_bf16 a[240:255], v[124:127], v[108:111], a[240:255]
    v_mov_b64 v[208:209], v[240:241]
    v_mov_b64 v[210:211], v[242:243]
    v_mov_b64 v[212:213], v[244:245]
    v_mov_b64 v[214:215], v[246:247]
    s_add_u32 s47, s47, 2048
    s_waitcnt lgkmcnt(0)
    v_mfma_f32_32x32x16_bf16 a[0:15], v[80:83], v[64:67], a[0:15]
    ds_read_b128 v[96:99], v4 offset:32768
    s_cmp_eq_u32 s46, 0
    s_cselect_b32 s49, 9, s5
    v_mfma_f32_32x32x16_bf16 a[16:31], v[80:83], v[68:71], a[16:31]
    ds_read_b64_tr_b16 v[112:113], v7 offset:51200
    s_cmp_eq_u32 s49, 0
    s_cbranch_scc0 DS_33
    buffer_store_dwordx4 v[152:155], v21, s[8:11], s47 offen offset:0 sc1
DS_33:
    v_mfma_f32_32x32x16_bf16 a[32:47], v[80:83], v[72:75], a[32:47]
    ds_read_b64_tr_b16 v[114:115], v7 offset:51712
    v_mfma_f32_32x32x16_bf16 a[48:63], v[80:83], v[76:79], a[48:63]
    ds_read_b128 v[100:103], v4 offset:34816
    v_mfma_f32_32x32x16_bf16 a[64:79], v[84:87], v[64:67], a[64:79]
    ds_read_b128 v[104:107], v4 offset:36864
    v_mfma_f32_32x32x16_bf16 a[80:95], v[84:87], v[68:71], a[80:95]
    ds_read_b128 v[108:111], v4 offset:38912
    s_cmp_eq_u32 s49, 1
    s_cbranch_scc0 DS_34
    buffer_store_dwordx4 v[152:155], v21, s[8:11], s47 offen offset:0 sc1
DS_34:
    v_mfma_f32_32x32x16_bf16 a[96:111], v[84:87], v[72:75], a[96:111]
    ds_read_b64_tr_b16 v[116:117], v8 offset:51200
    v_mfma_f32_32x32x16_bf16 a[112:127], v[84:87], v[76:79], a[112:127]
    ds_read_b64_tr_b16 v[118:119], v8 offset:51712
    v_mfma_f32_32x32x16_bf16 a[128:143], v[88:91], v[64:67], a[128:143]
    ds_read_b64_tr_b16 v[120:121], v7 offset:55296
    v_mfma_f32_32x32x16_bf16 a[144:159], v[88:91], v[68:71], a[144:159]
    ds_read_b64_tr_b16 v[122:123], v7 offset:55808
    s_cmp_eq_u32 s49, 2
    s_cbranch_scc0 DS_35
    buffer_store_dwordx4 v[152:155], v21, s[8:11], s47 offen offset:0 sc1
DS_35:
    v_mfma_f32_32x32x16_bf16 a[160:175], v[88:91], v[72:75], a[160:175]
    ds_read_b64_tr_b16 v[124:125], v8 offset:55296
    v_mfma_f32_32x32x16_bf16 a[176:191], v[88:91], v[76:79], a[176:191]
    ds_read_b64_tr_b16 v[126:127], v8 offset:55808
    v_mfma_f32_32x32x16_bf16 a[192:207], v[92:95], v[64:67], a[192:207]
    v_mfma_f32_32x32x16_bf16 a[208:223], v[92:95], v[68:71], a[208:223]
    s_cmp_eq_u32 s49, 3
    s_cbranch_scc0 DS_36
    buffer_store_dwordx4 v[152:155], v21, s[8:11], s47 offen offset:0 sc1
DS_36:
    v_mfma_f32_32x32x16_bf16 a[224:239], v[92:95], v[72:75], a[224:239]
    v_mfma_f32_32x32x16_bf16 a[240:255], v[92:95], v[76:79], a[240:255]
    s_waitcnt vmcnt(16) lgkmcnt(0)
    s_barrier
    v_mfma_f32_32x32x16_bf16 a[0:15], v[112:115], v[96:99], a[0:15]
    ds_read_b128 v[64:67], v1 offset:0
    ds_read_b64_tr_b16 v[80:81], v5 offset:16384
    s_cmp_eq_u32 s49, 0
    s_cbranch_scc0 DS_37
    buffer_store_dwordx4 v[156:159], v21, s[8:11], s47 offen offset:1024 sc1
DS_37:
    v_mfma_f32_32x32x16_bf16 a[16:31], v[112:115], v[100:103], a[16:31]
    ds_read_b64_tr_b16 v[82:83], v5 offset:16896
    ds_read_b128 v[68:71], v1 offset:2048
    v_mfma_f32_32x32x16_bf16 a[32:47], v[112:115], v[104:107], a[32:47]
    ds_read_b128 v[72:75], v1 offset:4096
    ds_read_b128 v[76:79], v1 offset:6144
    v_mfma_f32_32x32x16_bf16 a[48:63], v[112:115], v[108:111], a[48:63]
    ds_read_b64_tr_b16 v[84:85], v6 offset:16384
    ds_read_b64_tr_b16 v[86:87], v6 offset:16896
    v_mfma_f32_32x32x16_bf16 a[64:79], v[116:119], v[96:99], a[64:79]
    ds_read_b64_tr_b16 v[88:89], v5 offset:20480
    ds_read_b64_tr_b16 v[90:91], v5 offset:20992
    s_cmp_eq_u32 s49, 1
    s_cbranch_scc0 DS_38
    buffer_store_dwordx4 v[156:159], v21, s[8:11], s47 offen offset:1024 sc1
DS_38:
    v_mfma_f32_32x32x16_bf16 a[80:95], v[116:119], v[100:103], a[80:95]
    ds_read_b64_tr_b16 v[92:93], v6 offset:20480
    ds_read_b64_tr_b16 v[94:95], v6 offset:20992
    v_mfma_f32_32x32x16_bf16 a[96:111], v[116:119], v[104:107], a[96:111]
    s_add_u32 m0, s40, 98304
    s_nop 0
    buffer_load_dwordx4 v9, s[16:19], s29 offen offset:0 lds
    v_mfma_f32_32x32x16_bf16 a[112:127], v[116:119], v[108:111], a[112:127]
    buffer_load_dwordx4 v10, s[16:19], s29 offen offset:1024 lds
    v_mfma_f32_32x32x16_bf16 a[128:143], v[120:123], v[96:99], a[128:143]
    buffer_load_dwordx4 v11, s[16:19], s29 offen offset:2048 lds
    s_cmp_eq_u32 s49, 2
    s_cbranch_scc0 DS_39
    buffer_store_dwordx4 v[156:159], v21, s[8:11], s47 offen offset:1024 sc1
DS_39:
    v_mfma_f32_32x32x16_bf16 a[144:159], v[120:123], v[100:103], a[144:159]
    buffer_load_dwordx4 v12, s[16:19], s29 offen offset:3072 lds
    v_mfma_f32_32x32x16_bf16 a[160:175], v[120:123], v[104:107], a[160:175]
    s_add_u32 m0, s41, 98304
    s_add_u32 s29, s29, 64
    buffer_load_dwordx4 v13, s[20:23], s30 offen offset:0 lds
    v_mfma_f32_32x32x16_bf16 a[176:191], v[120:123], v[108:111], a[176:191]
    buffer_load_dwordx4 v14, s[20:23], s30 offen offset:1024 lds
    v_mfma_f32_32x32x16_bf16 a[192:207], v[124:127], v[96:99], a[192:207]
    buffer_load_dwordx4 v15, s[20:23], s30 offen offset:2048 lds
    s_cmp_eq_u32 s49, 3
    s_cbranch_scc0 DS_40
    buffer_store_dwordx4 v[156:159], v21, s[8:11], s47 offen offset:1024 sc1
DS_40:
    v_mfma_f32_32x32x16_bf16 a[208:223], v[124:127], v[100:103], a[208:223]
    buffer_load_dwordx4 v16, s[20:23], s30 offen offset:3072 lds
    s_add_u32 s30, s30, s31
    s_sub_u32 s45, s45, 1
    s_cmp_eq_u32 s45, 0
    s_cselect_b32 s33, 1280, 0
    s_cselect_b32 s34, s42, 0
    s_sub_u32 s29, s29, s33
    s_sub_u32 s30, s30, s34
    v_mov_b64 v[152:153], v[184:185]
    v_mov_b64 v[154:155], v[186:187]
    v_mov_b64 v[156:157], v[188:189]
    v_mov_b64 v[158:159], v[190:191]
    v_mfma_f32_32x32x16_bf16 a[224:239], v[124:127], v[104:107], a[224:239]
    v_mov_b64 v[184:185], v[216:217]
    v_mov_b64 v[186:187], v[218:219]
    v_mov_b64 v[188:189], v[220:221]
    v_mov_b64 v[190:191], v[222:223]
    v_mfma_f32_32x32x16_bf16 a[240:255], v[124:127], v[108:111], a[240:255]
    v_mov_b64 v[216:217], v[248:249]
    v_mov_b64 v[218:219], v[250:251]
    v_mov_b64 v[220:221], v[252:253]
    v_mov_b64 v[222:223], v[254:255]
    s_add_u32 s47, s47, 518144
    s_sub_u32 s46, s46, 1
    s_cbranch_scc0 G4_LOOP_K_2
    s_mov_b32 s46, 0
    s_cmp_eq_u32 s48, 0
    s_cbranch_scc1 G4_LOOP_K_2
    buffer_store_dword v25, v24, s[8:11], s48 offen sc1
    s_mov_b32 s48, 0
G4_LOOP_K_2:
    s_add_u32 s32, s32, 1
    s_cmp_lt_u32 s32, 4
    s_cbranch_scc1 G4_LOOP_K_0
    s_waitcnt lgkmcnt(0)
    v_mfma_f32_32x32x16_bf16 a[0:15], v[80:83], v[64:67], a[0:15]
    ds_read_b128 v[96:99], v2 offset:0
    v_mfma_f32_32x32x16_bf16 a[16:31], v[80:83], v[68:71], a[16:31]
    ds_read_b64_tr_b16 v[112:113], v5 offset:18432
    v_mfma_f32_32x32x16_bf16 a[32:47], v[80:83], v[72:75], a[32:47]
    ds_read_b64_tr_b16 v[114:115], v5 offset:18944
    v_mfma_f32_32x32x16_bf16 a[48:63], v[80:83], v[76:79], a[48:63]
    ds_read_b128 v[100:103], v2 offset:2048
    v_mfma_f32_32x32x16_bf16 a[64:79], v[84:87], v[64:67], a[64:79]
    ds_read_b128 v[104:107], v2 offset:4096
    v_mfma_f32_32x32x16_bf16 a[80:95], v[84:87], v[68:71], a[80:95]
    ds_read_b128 v[108:111], v2 offset:6144
    v_mfma_f32_32x32x16_bf16 a[96:111], v[84:87], v[72:75], a[96:111]
    ds_read_b64_tr_b16 v[116:117], v6 offset:18432
    v_mfma_f32_32x32x16_bf16 a[112:127], v[84:87], v[76:79], a[112:127]
    ds_read_b64_tr_b16 v[118:119], v6 offset:18944
    v_mfma_f32_32x32x16_bf16 a[128:143], v[88:91], v[64:67], a[128:143]
    ds_read_b64_tr_b16 v[120:121], v5 offset:22528
    v_mfma_f32_32x32x16_bf16 a[144:159], v[88:91], v[68:71], a[144:159]
    ds_read_b64_tr_b16 v[122:123], v5 offset:23040
    v_mfma_f32_32x32x16_bf16 a[160:175], v[88:91], v[72:75], a[160:175]
    ds_read_b64_tr_b16 v[124:125], v6 offset:22528
    v_mfma_f32_32x32x16_bf16 a[176:191], v[88:91], v[76:79], a[176:191]
    ds_read_b64_tr_b16 v[126:127], v6 offset:23040
    v_mfma_f32_32x32x16_bf16 a[192:207], v[92:95], v[64:67], a[192:207]
    v_mfma_f32_32x32x16_bf16 a[208:223], v[92:95], v[68:71], a[208:223]
    v_mfma_f32_32x32x16_bf16 a[224:239], v[92:95], v[72:75], a[224:239]
    v_mfma_f32_32x32x16_bf16 a[240:255], v[92:95], v[76:79], a[240:255]
    s_waitcnt vmcnt(16) lgkmcnt(0)
    s_barrier
    v_mfma_f32_32x32x16_bf16 a[0:15], v[112:115], v[96:99], a[0:15]
    ds_read_b128 v[64:67], v1 offset:32768
    ds_read_b64_tr_b16 v[80:81], v5 offset:49152
    v_mfma_f32_32x32x16_bf16 a[16:31], v[112:115], v[100:103], a[16:31]
    ds_read_b64_tr_b16 v[82:83], v5 offset:49664
    ds_read_b128 v[68:71], v1 offset:34816
    v_mfma_f32_32x32x16_bf16 a[32:47], v[112:115], v[104:107], a[32:47]
    ds_read_b128 v[72:75], v1 offset:36864
    ds_read_b128 v[76:79], v1 offset:38912
    v_mfma_f32_32x32x16_bf16 a[48:63], v[112:115], v[108:111], a[48:63]
    ds_read_b64_tr_b16 v[84:85], v6 offset:49152
    ds_read_b64_tr_b16 v[86:87], v6 offset:49664
    v_mfma_f32_32x32x16_bf16 a[64:79], v[116:119], v[96:99], a[64:79]
    ds_read_b64_tr_b16 v[88:89], v5 offset:53248
    ds_read_b64_tr_b16 v[90:91], v5 offset:53760
    v_mfma_f32_32x32x16_bf16 a[80:95], v[116:119], v[100:103], a[80:95]
    ds_read_b64_tr_b16 v[92:93], v6 offset:53248
    ds_read_b64_tr_b16 v[94:95], v6 offset:53760
    v_mfma_f32_32x32x16_bf16 a[96:111], v[116:119], v[104:107], a[96:111]
    v_mfma_f32_32x32x16_bf16 a[112:127], v[116:119], v[108:111], a[112:127]
    v_mfma_f32_32x32x16_bf16 a[128:143], v[120:123], v[96:99], a[128:143]
    v_mfma_f32_32x32x16_bf16 a[144:159], v[120:123], v[100:103], a[144:159]
    v_mfma_f32_32x32x16_bf16 a[160:175], v[120:123], v[104:107], a[160:175]
    v_mfma_f32_32x32x16_bf16 a[176:191], v[120:123], v[108:111], a[176:191]
    v_mfma_f32_32x32x16_bf16 a[192:207], v[124:127], v[96:99], a[192:207]
    v_mfma_f32_32x32x16_bf16 a[208:223], v[124:127], v[100:103], a[208:223]
    v_mfma_f32_32x32x16_bf16 a[224:239], v[124:127], v[104:107], a[224:239]
    v_mfma_f32_32x32x16_bf16 a[240:255], v[124:127], v[108:111], a[240:255]
    s_waitcnt lgkmcnt(0)
    v_mfma_f32_32x32x16_bf16 a[0:15], v[80:83], v[64:67], a[0:15]
    ds_read_b128 v[96:99], v2 offset:32768
    v_mfma_f32_32x32x16_bf16 a[16:31], v[80:83], v[68:71], a[16:31]
    ds_read_b64_tr_b16 v[112:113], v5 offset:51200
    v_mfma_f32_32x32x16_bf16 a[32:47], v[80:83], v[72:75], a[32:47]
    ds_read_b64_tr_b16 v[114:115], v5 offset:51712
    v_mfma_f32_32x32x16_bf16 a[48:63], v[80:83], v[76:79], a[48:63]
    ds_read_b128 v[100:103], v2 offset:34816
    v_mfma_f32_32x32x16_bf16 a[64:79], v[84:87], v[64:67], a[64:79]
    ds_read_b128 v[104:107], v2 offset:36864
    v_mfma_f32_32x32x16_bf16 a[80:95], v[84:87], v[68:71], a[80:95]
    ds_read_b128 v[108:111], v2 offset:38912
    v_mfma_f32_32x32x16_bf16 a[96:111], v[84:87], v[72:75], a[96:111]
    ds_read_b64_tr_b16 v[116:117], v6 offset:51200
    v_mfma_f32_32x32x16_bf16 a[112:127], v[84:87], v[76:79], a[112:127]
    ds_read_b64_tr_b16 v[118:119], v6 offset:51712
    v_mfma_f32_32x32x16_bf16 a[128:143], v[88:91], v[64:67], a[128:143]
    ds_read_b64_tr_b16 v[120:121], v5 offset:55296
    v_mfma_f32_32x32x16_bf16 a[144:159], v[88:91], v[68:71], a[144:159]
    ds_read_b64_tr_b16 v[122:123], v5 offset:55808
    v_mfma_f32_32x32x16_bf16 a[160:175], v[88:91], v[72:75], a[160:175]
    ds_read_b64_tr_b16 v[124:125], v6 offset:55296
    v_mfma_f32_32x32x16_bf16 a[176:191], v[88:91], v[76:79], a[176:191]
    ds_read_b64_tr_b16 v[126:127], v6 offset:55808
    v_mfma_f32_32x32x16_bf16 a[192:207], v[92:95], v[64:67], a[192:207]
    v_mfma_f32_32x32x16_bf16 a[208:223], v[92:95], v[68:71], a[208:223]
    v_mfma_f32_32x32x16_bf16 a[224:239], v[92:95], v[72:75], a[224:239]
    v_mfma_f32_32x32x16_bf16 a[240:255], v[92:95], v[76:79], a[240:255]
    s_waitcnt vmcnt(8) lgkmcnt(0)
    s_barrier
    v_mfma_f32_32x32x16_bf16 a[0:15], v[112:115], v[96:99], a[0:15]
    ds_read_b128 v[64:67], v3 offset:0
    ds_read_b64_tr_b16 v[80:81], v7 offset:16384
    v_mfma_f32_32x32x16_bf16 a[16:31], v[112:115], v[100:103], a[16:31]
    ds_read_b64_tr_b16 v[82:83], v7 offset:16896
    ds_read_b128 v[68:71], v3 offset:2048
    v_mfma_f32_32x32x16_bf16 a[32:47], v[112:115], v[104:107], a[32:47]
    ds_read_b128 v[72:75], v3 offset:4096
    ds_read_b128 v[76:79], v3 offset:6144
    v_mfma_f32_32x32x16_bf16 a[48:63], v[112:115], v[108:111], a[48:63]
    ds_read_b64_tr_b16 v[84:85], v8 offset:16384
    ds_read_b64_tr_b16 v[86:87], v8 offset:16896
    v_mfma_f32_32x32x16_bf16 a[64:79], v[116:119], v[96:99], a[64:79]
    ds_read_b64_tr_b16 v[88:89], v7 offset:20480
    ds_read_b64_tr_b16 v[90:91], v7 offset:20992
    v_mfma_f32_32x32x16_bf16 a[80:95], v[116:119], v[100:103], a[80:95]
    ds_read_b64_tr_b16 v[92:93], v8 offset:20480
    ds_read_b64_tr_b16 v[94:95], v8 offset:20992
    v_mfma_f32_32x32x16_bf16 a[96:111], v[116:119], v[104:107], a[96:111]
    v_mfma_f32_32x32x16_bf16 a[112:127], v[116:119], v[108:111], a[112:127]
    v_mfma_f32_32x32x16_bf16 a[128:143], v[120:123], v[96:99], a[128:143]
    v_mfma_f32_32x32x16_bf16 a[144:159], v[120:123], v[100:103], a[144:159]
    v_mfma_f32_32x32x16_bf16 a[160:175], v[120:123], v[104:107], a[160:175]
    v_mfma_f32_32x32x16_bf16 a[176:191], v[120:123], v[108:111], a[176:191]
    v_mfma_f32_32x32x16_bf16 a[192:207], v[124:127], v[96:99], a[192:207]
    v_mfma_f32_32x32x16_bf16 a[208:223], v[124:127], v[100:103], a[208:223]
    v_mfma_f32_32x32x16_bf16 a[224:239], v[124:127], v[104:107], a[224:239]
    v_mfma_f32_32x32x16_bf16 a[240:255], v[124:127], v[108:111], a[240:255]
    s_waitcnt lgkmcnt(0)
    v_mfma_f32_32x32x16_bf16 a[0:15], v[80:83], v[64:67], a[0:15]
    ds_read_b128 v[96:99], v4 offset:0
    v_mfma_f32_32x32x16_bf16 a[16:31], v[80:83], v[68:71], a[16:31]
    ds_read_b64_tr_b16 v[112:113], v7 offset:18432
    v_mfma_f32_32x32x16_bf16 a[32:47], v[80:83], v[72:75], a[32:47]
    ds_read_b64_tr_b16 v[114:115], v7 offset:18944
    v_mfma_f32_32x32x16_bf16 a[48:63], v[80:83], v[76:79], a[48:63]
    ds_read_b128 v[100:103], v4 offset:2048
    v_mfma_f32_32x32x16_bf16 a[64:79], v[84:87], v[64:67], a[64:79]
    ds_read_b128 v[104:107], v4 offset:4096
    v_mfma_f32_32x32x16_bf16 a[80:95], v[84:87], v[68:71], a[80:95]
    ds_read_b128 v[108:111], v4 offset:6144
    v_mfma_f32_32x32x16_bf16 a[96:111], v[84:87], v[72:75], a[96:111]
    ds_read_b64_tr_b16 v[116:117], v8 offset:18432
    v_mfma_f32_32x32x16_bf16 a[112:127], v[84:87], v[76:79], a[112:127]
    ds_read_b64_tr_b16 v[118:119], v8 offset:18944
    v_mfma_f32_32x32x16_bf16 a[128:143], v[88:91], v[64:67], a[128:143]
    ds_read_b64_tr_b16 v[120:121], v7 offset:22528
    v_mfma_f32_32x32x16_bf16 a[144:159], v[88:91], v[68:71], a[144:159]
    ds_read_b64_tr_b16 v[122:123], v7 offset:23040
    v_mfma_f32_32x32x16_bf16 a[160:175], v[88:91], v[72:75], a[160:175]
    ds_read_b64_tr_b16 v[124:125], v8 offset:22528
    v_mfma_f32_32x32x16_bf16 a[176:191], v[88:91], v[76:79], a[176:191]
    ds_read_b64_tr_b16 v[126:127], v8 offset:23040
    v_mfma_f32_32x32x16_bf16 a[192:207], v[92:95], v[64:67], a[192:207]
    v_mfma_f32_32x32x16_bf16 a[208:223], v[92:95], v[68:71], a[208:223]
    v_mfma_f32_32x32x16_bf16 a[224:239], v[92:95], v[72:75], a[224:239]
    v_mfma_f32_32x32x16_bf16 a[240:255], v[92:95], v[76:79], a[240:255]
    s_waitcnt vmcnt(0) lgkmcnt(0)
    s_barrier
    v_mfma_f32_32x32x16_bf16 a[0:15], v[112:115], v[96:99], a[0:15]
    ds_read_b128 v[64:67], v3 offset:32768
    ds_read_b64_tr_b16 v[80:81], v7 offset:49152
    v_mfma_f32_32x32x16_bf16 a[16:31], v[112:115], v[100:103], a[16:31]
    ds_read_b64_tr_b16 v[82:83], v7 offset:49664
    ds_read_b128 v[68:71], v3 offset:34816
    v_mfma_f32_32x32x16_bf16 a[32:47], v[112:115], v[104:107], a[32:47]
    ds_read_b128 v[72:75], v3 offset:36864
    ds_read_b128 v[76:79], v3 offset:38912
    v_mfma_f32_32x32x16_bf16 a[48:63], v[112:115], v[108:111], a[48:63]
    ds_read_b64_tr_b16 v[84:85], v8 offset:49152
    ds_read_b64_tr_b16 v[86:87], v8 offset:49664
    v_mfma_f32_32x32x16_bf16 a[64:79], v[116:119], v[96:99], a[64:79]
    ds_read_b64_tr_b16 v[88:89], v7 offset:53248
    ds_read_b64_tr_b16 v[90:91], v7 offset:53760
    v_mfma_f32_32x32x16_bf16 a[80:95], v[116:119], v[100:103], a[80:95]
    ds_read_b64_tr_b16 v[92:93], v8 offset:53248
    ds_read_b64_tr_b16 v[94:95], v8 offset:53760
    v_mfma_f32_32x32x16_bf16 a[96:111], v[116:119], v[104:107], a[96:111]
    v_mfma_f32_32x32x16_bf16 a[112:127], v[116:119], v[108:111], a[112:127]
    v_mfma_f32_32x32x16_bf16 a[128:143], v[120:123], v[96:99], a[128:143]
    v_mfma_f32_32x32x16_bf16 a[144:159], v[120:123], v[100:103], a[144:159]
    v_mfma_f32_32x32x16_bf16 a[160:175], v[120:123], v[104:107], a[160:175]
    v_mfma_f32_32x32x16_bf16 a[176:191], v[120:123], v[108:111], a[176:191]
    v_mfma_f32_32x32x16_bf16 a[192:207], v[124:127], v[96:99], a[192:207]
    v_mfma_f32_32x32x16_bf16 a[208:223], v[124:127], v[100:103], a[208:223]
    v_mfma_f32_32x32x16_bf16 a[224:239], v[124:127], v[104:107], a[224:239]
    v_mfma_f32_32x32x16_bf16 a[240:255], v[124:127], v[108:111], a[240:255]
    s_waitcnt lgkmcnt(0)
    v_mfma_f32_32x32x16_bf16 a[0:15], v[80:83], v[64:67], a[0:15]
    ds_read_b128 v[96:99], v4 offset:32768
    v_mfma_f32_32x32x16_bf16 a[16:31], v[80:83], v[68:71], a[16:31]
    ds_read_b64_tr_b16 v[112:113], v7 offset:51200
    v_mfma_f32_32x32x16_bf16 a[32:47], v[80:83], v[72:75], a[32:47]
    ds_read_b64_tr_b16 v[114:115], v7 offset:51712
    v_mfma_f32_32x32x16_bf16 a[48:63], v[80:83], v[76:79], a[48:63]
    ds_read_b128 v[100:103], v4 offset:34816
    v_mfma_f32_32x32x16_bf16 a[64:79], v[84:87], v[64:67], a[64:79]
    ds_read_b128 v[104:107], v4 offset:36864
    v_mfma_f32_32x32x16_bf16 a[80:95], v[84:87], v[68:71], a[80:95]
    ds_read_b128 v[108:111], v4 offset:38912
    v_mfma_f32_32x32x16_bf16 a[96:111], v[84:87], v[72:75], a[96:111]
    ds_read_b64_tr_b16 v[116:117], v8 offset:51200
    v_mfma_f32_32x32x16_bf16 a[112:127], v[84:87], v[76:79], a[112:127]
    ds_read_b64_tr_b16 v[118:119], v8 offset:51712
    v_mfma_f32_32x32x16_bf16 a[128:143], v[88:91], v[64:67], a[128:143]
    ds_read_b64_tr_b16 v[120:121], v7 offset:55296
    v_mfma_f32_32x32x16_bf16 a[144:159], v[88:91], v[68:71], a[144:159]
    ds_read_b64_tr_b16 v[122:123], v7 offset:55808
    v_mfma_f32_32x32x16_bf16 a[160:175], v[88:91], v[72:75], a[160:175]
    ds_read_b64_tr_b16 v[124:125], v8 offset:55296
    v_mfma_f32_32x32x16_bf16 a[176:191], v[88:91], v[76:79], a[176:191]
    ds_read_b64_tr_b16 v[126:127], v8 offset:55808
    v_mfma_f32_32x32x16_bf16 a[192:207], v[92:95], v[64:67], a[192:207]
    v_mfma_f32_32x32x16_bf16 a[208:223], v[92:95], v[68:71], a[208:223]
    v_mfma_f32_32x32x16_bf16 a[224:239], v[92:95], v[72:75], a[224:239]
    v_mfma_f32_32x32x16_bf16 a[240:255], v[92:95], v[76:79], a[240:255]
    s_waitcnt lgkmcnt(0)
    s_barrier
    v_mfma_f32_32x32x16_bf16 a[0:15], v[112:115], v[96:99], a[0:15]
    v_mfma_f32_32x32x16_bf16 a[16:31], v[112:115], v[100:103], a[16:31]
    v_mfma_f32_32x32x16_bf16 a[32:47], v[112:115], v[104:107], a[32:47]
    v_mfma_f32_32x32x16_bf16 a[48:63], v[112:115], v[108:111], a[48:63]
    v_mfma_f32_32x32x16_bf16 a[64:79], v[116:119], v[96:99], a[64:79]
    v_mfma_f32_32x32x16_bf16 a[80:95], v[116:119], v[100:103], a[80:95]
    v_mfma_f32_32x32x16_bf16 a[96:111], v[116:119], v[104:107], a[96:111]
    v_mfma_f32_32x32x16_bf16 a[112:127], v[116:119], v[108:111], a[112:127]
    v_mfma_f32_32x32x16_bf16 a[128:143], v[120:123], v[96:99], a[128:143]
    v_mfma_f32_32x32x16_bf16 a[144:159], v[120:123], v[100:103], a[144:159]
    v_mfma_f32_32x32x16_bf16 a[160:175], v[120:123], v[104:107], a[160:175]
    v_mfma_f32_32x32x16_bf16 a[176:191], v[120:123], v[108:111], a[176:191]
    v_mfma_f32_32x32x16_bf16 a[192:207], v[124:127], v[96:99], a[192:207]
    v_mfma_f32_32x32x16_bf16 a[208:223], v[124:127], v[100:103], a[208:223]
    v_mfma_f32_32x32x16_bf16 a[224:239], v[124:127], v[104:107], a[224:239]
    v_mfma_f32_32x32x16_bf16 a[240:255], v[124:127], v[108:111], a[240:255]
    s_branch G_EPI
G4_LOOP_V:
    s_waitcnt lgkmcnt(0)
    v_mfma_f32_32x32x16_bf16 a[0:15], v[64:67], v[80:83], 0
    ds_read_b128 v[96:99], v2 offset:0
    s_cmp_eq_u32 s46, 0
    s_cselect_b32 s49, 9, s5
    v_mfma_f32_32x32x16_bf16 a[16:31], v[68:71], v[80:83], 0
    ds_read_b64_tr_b16 v[112:113], v5 offset:18432
    s_cmp_eq_u32 s49, 0
    s_cbranch_scc0 DS_41
    buffer_store_dwordx4 v[128:131], v21, s[8:11], s47 offen offset:0 sc1
DS_41:
    v_mfma_f32_32x32x16_bf16 a[32:47], v[72:75], v[80:83], 0
    ds_read_b64_tr_b16 v[114:115], v5 offset:18944
    v_mfma_f32_32x32x16_bf16 a[48:63], v[76:79], v[80:83], 0
    ds_read_b128 v[100:103], v2 offset:2048
    v_mfma_f32_32x32x16_bf16 a[64:79], v[64:67], v[84:87], 0
    ds_read_b128 v[104:107], v2 offset:4096
    v_mfma_f32_32x32x16_bf16 a[80:95], v[68:71], v[84:87], 0
    ds_read_b128 v[108:111], v2 offset:6144
    s_cmp_eq_u32 s49, 1
    s_cbranch_scc0 DS_42
    buffer_store_dwordx4 v[128:131], v21, s[8:11], s47 offen offset:0 sc1
DS_42:
    v_mfma_f32_32x32x16_bf16 a[96:111], v[72:75], v[84:87], 0
    ds_read_b64_tr_b16 v[116:117], v6 offset:18432
    v_mfma_f32_32x32x16_bf16 a[112:127], v[76:79], v[84:87], 0
    ds_read_b64_tr_b16 v[118:119], v6 offset:18944
    v_mfma_f32_32x32x16_bf16 a[128:143], v[64:67], v[88:91], 0
    ds_read_b64_tr_b16 v[120:121], v5 offset:22528
    v_mfma_f32_32x32x16_bf16 a[144:159], v[68:71], v[88:91], 0
    ds_read_b64_tr_b16 v[122:123], v5 offset:23040
    s_cmp_eq_u32 s49, 2
    s_cbranch_scc0 DS_43
    buffer_store_dwordx4 v[128:131], v21, s[8:11], s47 offen offset:0 sc1
DS_43:
    v_mfma_f32_32x32x16_bf16 a[160:175], v[72:75], v[88:91], 0
    ds_read_b64_tr_b16 v[124:125], v6 offset:22528
    v_mfma_f32_32x32x16_bf16 a[176:191], v[76:79], v[88:91], 0
    ds_read_b64_tr_b16 v[126:127], v6 offset:23040
    v_mfma_f32_32x32x16_bf16 a[192:207], v[64:67], v[92:95], 0
    v_mfma_f32_32x32x16_bf16 a[208:223], v[68:71], v[92:95], 0
    s_cmp_eq_u32 s49, 3
    s_cbranch_scc0 DS_44
    buffer_store_dwordx4 v[128:131], v21, s[8:11], s47 offen offset:0 sc1
DS_44:
    v_mfma_f32_32x32x16_bf16 a[224:239], v[72:75], v[92:95], 0
    v_mfma_f32_32x32x16_bf16 a[240:255], v[76:79], v[92:95], 0
    s_waitcnt vmcnt(16) lgkmcnt(0)
    s_barrier
    v_mfma_f32_32x32x16_bf16 a[0:15], v[96:99], v[112:115], a[0:15]
    ds_read_b128 v[64:67], v1 offset:32768
    ds_read_b64_tr_b16 v[80:81], v5 offset:49152
    s_cmp_eq_u32 s49, 0
    s_cbranch_scc0 DS_45
    buffer_store_dwordx4 v[132:135], v21, s[8:11], s47 offen offset:1024 sc1
DS_45:
    v_mfma_f32_32x32x16_bf16 a[16:31], v[100:103], v[112:115], a[16:31]
    ds_read_b64_tr_b16 v[82:83], v5 offset:49664
    ds_read_b128 v[68:71], v1 offset:34816
    v_mfma_f32_32x32x16_bf16 a[32:47], v[104:107], v[112:115], a[32:47]
    ds_read_b128 v[72:75], v1 offset:36864
    ds_read_b128 v[76:79], v1 offset:38912
    v_mfma_f32_32x32x16_bf16 a[48:63], v[108:111], v[112:115], a[48:63]
    ds_read_b64_tr_b16 v[84:85], v6 offset:49152
    ds_read_b64_tr_b16 v[86:87], v6 offset:49664
    v_mfma_f32_32x32x16_bf16 a[64:79], v[96:99], v[116:119], a[64:79]
    ds_read_b64_tr_b16 v[88:89], v5 offset:53248
    ds_read_b64_tr_b16 v[90:91], v5 offset:53760
    s_cmp_eq_u32 s49, 1
    s_cbranch_scc0 DS_46
    buffer_store_dwordx4 v[132:135], v21, s[8:11], s47 offen offset:1024 sc1
DS_46:
    v_mfma_f32_32x32x16_bf16 a[80:95], v[100:103], v[116:119], a[80:95]
    ds_read_b64_tr_b16 v[92:93], v6 offset:53248
    ds_read_b64_tr_b16 v[94:95], v6 offset:53760
    v_mfma_f32_32x32x16_bf16 a[96:111], v[104:107], v[116:119], a[96:111]
    s_add_u32 m0, s40, 0
    s_nop 0
    buffer_load_dwordx4 v9, s[16:19], s29 offen offset:0 lds
    v_mfma_f32_32x32x16_bf16 a[112:127], v[108:111], v[116:119], a[112:127]
    buffer_load_dwordx4 v10, s[16:19], s29 offen offset:1024 lds
    v_mfma_f32_32x32x16_bf16 a[128:143], v[96:99], v[120:123], a[128:143]
    buffer_load_dwordx4 v11, s[16:19], s29 offen offset:2048 lds
    s_cmp_eq_u32 s49, 2
    s_cbranch_scc0 DS_47
    buffer_store_dwordx4 v[132:135], v21, s[8:11], s47 offen offset:1024 sc1
DS_47:
    v_mfma_f32_32x32x16_bf16 a[144:159], v[100:103], v[120:123], a[144:159]
    buffer_load_dwordx4 v12, s[16:19], s29 offen offset:3072 lds
    v_mfma_f32_32x32x16_bf16 a[160:175], v[104:107], v[120:123], a[160:175]
    s_add_u32 m0, s41, 0
    s_add_u32 s29, s29, 64
    buffer_load_dwordx4 v13, s[20:23], s30 offen offset:0 lds
    v_mfma_f32_32x32x16_bf16 a[176:191], v[108:111], v[120:123], a[176:191]
    buffer_load_dwordx4 v14, s[20:23], s30 offen offset:1024 lds
    v_mfma_f32_32x32x16_bf16 a[192:207], v[96:99], v[124:127], a[192:207]
    buffer_load_dwordx4 v15, s[20:23], s30 offen offset:2048 lds
    s_cmp_eq_u32 s49, 3
    s_cbranch_scc0 DS_48
    buffer_store_dwordx4 v[132:135], v21, s[8:11], s47 offen offset:1024 sc1
DS_48:
    v_mfma_f32_32x32x16_bf16 a[208:223], v[100:103], v[124:127], a[208:223]
    buffer_load_dwordx4 v16, s[20:23], s30 offen offset:3072 lds
    s_add_u32 s30, s30, s31
    s_sub_u32 s45, s45, 1
    s_cmp_eq_u32 s45, 0
    s_cselect_b32 s33, 1280, 0
    s_cselect_b32 s34, s42, 0
    s_sub_u32 s29, s29, s33
    s_sub_u32 s30, s30, s34
    v_mov_b64 v[128:129], v[160:161]
    v_mov_b64 v[130:131], v[162:163]
    v_mov_b64 v[132:133], v[164:165]
    v_mov_b64 v[134:135], v[166:167]
    v_mfma_f32_32x32x16_bf16 a[224:239], v[104:107], v[124:127], a[224:239]
    v_mov_b64 v[160:161], v[192:193]
    v_mov_b64 v[162:163], v[194:195]
    v_mov_b64 v[164:165], v[196:197]
    v_mov_b64 v[166:167], v[198:199]
    v_mfma_f32_32x32x16_bf16 a[240:255], v[108:111], v[124:127], a[240:255]
    v_mov_b64 v[192:193], v[224:225]
    v_mov_b64 v[194:195], v[226:227]
    v_mov_b64 v[196:197], v[228:229]
    v_mov_b64 v[198:199], v[230:231]
    s_add_u32 s47, s47, 2048
    s_mov_b32 s32, 0
    s_branch G4_LOOP_V_1
G4_LOOP_V_0:
    s_waitcnt lgkmcnt(0)
    v_mfma_f32_32x32x16_bf16 a[0:15], v[64:67], v[80:83], a[0:15]
    ds_read_b128 v[96:99], v2 offset:0
    s_cmp_eq_u32 s46, 0
    s_cselect_b32 s49, 9, s5
    v_mfma_f32_32x32x16_bf16 a[16:31], v[68:71], v[80:83], a[16:31]
    ds_read_b64_tr_b16 v[112:113], v5 offset:18432
    s_cmp_eq_u32 s49, 0
    s_cbranch_scc0 DS_49
    buffer_store_dwordx4 v[128:131], v21, s[8:11], s47 offen offset:0 sc1
DS_49:
    v_mfma_f32_32x32x16_bf16 a[32:47], v[72:75], v[80:83], a[32:47]
    ds_read_b64_tr_b16 v[114:115], v5 offset:18944
    v_mfma_f32_32x32x16_bf16 a[48:63], v[76:79], v[80:83], a[48:63]
    ds_read_b128 v[100:103], v2 offset:2048
    v_mfma_f32_32x32x16_bf16 a[64:79], v[64:67], v[84:87], a[64:79]
    ds_read_b128 v[104:107], v2 offset:4096
    v_mfma_f32_32x32x16_bf16 a[80:95], v[68:71], v[84:87], a[80:95]
    ds_read_b128 v[108:111], v2 offset:6144
    s_cmp_eq_u32 s49, 1
    s_cbranch_scc0 DS_50
    buffer_store_dwordx4 v[128:131], v21, s[8:11], s47 offen offset:0 sc1
DS_50:
    v_mfma_f32_32x32x16_bf16 a[96:111], v[72:75], v[84:87], a[96:111]
    ds_read_b64_tr_b16 v[116:117], v6 offset:18432
    v_mfma_f32_32x32x16_bf16 a[112:127], v[76:79], v[84:87], a[112:127]
    ds_read_b64_tr_b16 v[118:119], v6 offset:18944
    v_mfma_f32_32x32x16_bf16 a[128:143], v[64:67], v[88:91], a[128:143]
    ds_read_b64_tr_b16 v[120:121], v5 offset:22528
    v_mfma_f32_32x32x16_bf16 a[144:159], v[68:71], v[88:91], a[144:159]
    ds_read_b64_tr_b16 v[122:123], v5 offset:23040
    s_cmp_eq_u32 s49, 2
    s_cbranch_scc0 DS_51
    buffer_store_dwordx4 v[128:131], v21, s[8:11], s47 offen offset:0 sc1
DS_51:
    v_mfma_f32_32x32x16_bf16 a[160:175], v[72:75], v[88:91], a[160:175]
    ds_read_b64_tr_b16 v[124:125], v6 offset:22528
    v_mfma_f32_32x32x16_bf16 a[176:191], v[76:79], v[88:91], a[176:191]
    ds_read_b64_tr_b16 v[126:127], v6 offset:23040
    v_mfma_f32_32x32x16_bf16 a[192:207], v[64:67], v[92:95], a[192:207]
    v_mfma_f32_32x32x16_bf16 a[208:223], v[68:71], v[92:95], a[208:223]
    s_cmp_eq_u32 s49, 3
    s_cbranch_scc0 DS_52
    buffer_store_dwordx4 v[128:131], v21, s[8:11], s47 offen offset:0 sc1
DS_52:
    v_mfma_f32_32x32x16_bf16 a[224:239], v[72:75], v[92:95], a[224:239]
    v_mfma_f32_32x32x16_bf16 a[240:255], v[76:79], v[92:95], a[240:255]
    s_waitcnt vmcnt(16) lgkmcnt(0)
    s_barrier
    v_mfma_f32_32x32x16_bf16 a[0:15], v[96:99], v[112:115], a[0:15]
    ds_read_b128 v[64:67], v1 offset:32768
    ds_read_b64_tr_b16 v[80:81], v5 offset:49152
    s_cmp_eq_u32 s49, 0
    s_cbranch_scc0 DS_53
    buffer_store_dwordx4 v[132:135], v21, s[8:11], s47 offen offset:1024 sc1
DS_53:
    v_mfma_f32_32x32x16_bf16 a[16:31], v[100:103], v[112:115], a[16:31]
    ds_read_b64_tr_b16 v[82:83], v5 offset:49664
    ds_read_b128 v[68:71], v1 offset:34816
    v_mfma_f32_32x32x16_bf16 a[32:47], v[104:107], v[112:115], a[32:47]
    ds_read_b128 v[72:75], v1 offset:36864
    ds_read_b128 v[76:79], v1 offset:38912
    v_mfma_f32_32x32x16_bf16 a[48:63], v[108:111], v[112:115], a[48:63]
    ds_read_b64_tr_b16 v[84:85], v6 offset:49152
    ds_read_b64_tr_b16 v[86:87], v6 offset:49664
    v_mfma_f32_32x32x16_bf16 a[64:79], v[96:99], v[116:119], a[64:79]
    ds_read_b64_tr_b16 v[88:89], v5 offset:53248
    ds_read_b64_tr_b16 v[90:91], v5 offset:53760
    s_cmp_eq_u32 s49, 1
    s_cbranch_scc0 DS_54
    buffer_store_dwordx4 v[132:135], v21, s[8:11], s47 offen offset:1024 sc1
DS_54:
    v_mfma_f32_32x32x16_bf16 a[80:95], v[100:103], v[116:119], a[80:95]
    ds_read_b64_tr_b16 v[92:93], v6 offset:53248
    ds_read_b64_tr_b16 v[94:95], v6 offset:53760
    v_mfma_f32_32x32x16_bf16 a[96:111], v[104:107], v[116:119], a[96:111]
    s_add_u32 m0, s40, 0
    s_nop 0
    buffer_load_dwordx4 v9, s[16:19], s29 offen offset:0 lds
    v_mfma_f32_32x32x16_bf16 a[112:127], v[108:111], v[116:119], a[112:127]
    buffer_load_dwordx4 v10, s[16:19], s29 offen offset:1024 lds
    v_mfma_f32_32x32x16_bf16 a[128:143], v[96:99], v[120:123], a[128:143]
    buffer_load_dwordx4 v11, s[16:19], s29 offen offset:2048 lds
    s_cmp_eq_u32 s49, 2
    s_cbranch_scc0 DS_55
    buffer_store_dwordx4 v[132:135], v21, s[8:11], s47 offen offset:1024 sc1
DS_55:
    v_mfma_f32_32x32x16_bf16 a[144:159], v[100:103], v[120:123], a[144:159]
    buffer_load_dwordx4 v12, s[16:19], s29 offen offset:3072 lds
    v_mfma_f32_32x32x16_bf16 a[160:175], v[104:107], v[120:123], a[160:175]
    s_add_u32 m0, s41, 0
    s_add_u32 s29, s29, 64
    buffer_load_dwordx4 v13, s[20:23], s30 offen offset:0 lds
    v_mfma_f32_32x32x16_bf16 a[176:191], v[108:111], v[120:123], a[176:191]
    buffer_load_dwordx4 v14, s[20:23], s30 offen offset:1024 lds
    v_mfma_f32_32x32x16_bf16 a[192:207], v[96:99], v[124:127], a[192:207]
    buffer_load_dwordx4 v15, s[20:23], s30 offen offset:2048 lds
    s_cmp_eq_u32 s49, 3
    s_cbranch_scc0 DS_56
    buffer_store_dwordx4 v[132:135], v21, s[8:11], s47 offen offset:1024 sc1
DS_56:
    v_mfma_f32_32x32x16_bf16 a[208:223], v[100:103], v[124:127], a[208:223]
    buffer_load_dwordx4 v16, s[20:23], s30 offen offset:3072 lds
    s_add_u32 s30, s30, s31
    s_sub_u32 s45, s45, 1
    s_cmp_eq_u32 s45, 0
    s_cselect_b32 s33, 1280, 0
    s_cselect_b32 s34, s42, 0
    s_sub_u32 s29, s29, s33
    s_sub_u32 s30, s30, s34
    v_mov_b64 v[128:129], v[160:161]
    v_mov_b64 v[130:131], v[162:163]
    v_mov_b64 v[132:133], v[164:165]
    v_mov_b64 v[134:135], v[166:167]
    v_mfma_f32_32x32x16_bf16 a[224:239], v[104:107], v[124:127], a[224:239]
    v_mov_b64 v[160:161], v[192:193]
    v_mov_b64 v[162:163], v[194:195]
    v_mov_b64 v[164:165], v[196:197]
    v_mov_b64 v[166:167], v[198:199]
    v_mfma_f32_32x32x16_bf16 a[240:255], v[108:111], v[124:127], a[240:255]
    v_mov_b64 v[192:193], v[224:225]
    v_mov_b64 v[194:195], v[226:227]
    v_mov_b64 v[196:197], v[228:229]
    v_mov_b64 v[198:199], v[230:231]
    s_add_u32 s47, s47, 2048
G4_LOOP_V_1:
    s_waitcnt lgkmcnt(0)
    v_mfma_f32_32x32x16_bf16 a[0:15], v[64:67], v[80:83], a[0:15]
    ds_read_b128 v[96:99], v2 offset:32768
    s_cmp_eq_u32 s46, 0
    s_cselect_b32 s49, 9, s5
    v_mfma_f32_32x32x16_bf16 a[16:31], v[68:71], v[80:83], a[16:31]
    ds_read_b64_tr_b16 v[112:113], v5 offset:51200
    s_cmp_eq_u32 s49, 0
    s_cbranch_scc0 DS_57
    buffer_store_dwordx4 v[136:139], v21, s[8:11], s47 offen offset:0 sc1
DS_57:
    v_mfma_f32_32x32x16_bf16 a[32:47], v[72:75], v[80:83], a[32:47]
    ds_read_b64_tr_b16 v[114:115], v5 offset:51712
    v_mfma_f32_32x32x16_bf16 a[48:63], v[76:79], v[80:83], a[48:63]
    ds_read_b128 v[100:103], v2 offset:34816
    v_mfma_f32_32x32x16_bf16 a[64:79], v[64:67], v[84:87], a[64:79]
    ds_read_b128 v[104:107], v2 offset:36864
    v_mfma_f32_32x32x16_bf16 a[80:95], v[68:71], v[84:87], a[80:95]
    ds_read_b128 v[108:111], v2 offset:38912
    s_cmp_eq_u32 s49, 1
    s_cbranch_scc0 DS_58
    buffer_store_dwordx4 v[136:139], v21, s[8:11], s47 offen offset:0 sc1
DS_58:
    v_mfma_f32_32x32x16_bf16 a[96:111], v[72:75], v[84:87], a[96:111]
    ds_read_b64_tr_b16 v[116:117], v6 offset:51200
    v_mfma_f32_32x32x16_bf16 a[112:127], v[76:79], v[84:87], a[112:127]
    ds_read_b64_tr_b16 v[118:119], v6 offset:51712
    v_mfma_f32_32x32x16_bf16 a[128:143], v[64:67], v[88:91], a[128:143]
    ds_read_b64_tr_b16 v[120:121], v5 offset:55296
    v_mfma_f32_32x32x16_bf16 a[144:159], v[68:71], v[88:91], a[144:159]
    ds_read_b64_tr_b16 v[122:123], v5 offset:55808
    s_cmp_eq_u32 s49, 2
    s_cbranch_scc0 DS_59
    buffer_store_dwordx4 v[136:139], v21, s[8:11], s47 offen offset:0 sc1
DS_59:
    v_mfma_f32_32x32x16_bf16 a[160:175], v[72:75], v[88:91], a[160:175]
    ds_read_b64_tr_b16 v[124:125], v6 offset:55296
    v_mfma_f32_32x32x16_bf16 a[176:191], v[76:79], v[88:91], a[176:191]
    ds_read_b64_tr_b16 v[126:127], v6 offset:55808
    v_mfma_f32_32x32x16_bf16 a[192:207], v[64:67], v[92:95], a[192:207]
    v_mfma_f32_32x32x16_bf16 a[208:223], v[68:71], v[92:95], a[208:223]
    s_cmp_eq_u32 s49, 3
    s_cbranch_scc0 DS_60
    buffer_store_dwordx4 v[136:139], v21, s[8:11], s47 offen offset:0 sc1
DS_60:
    v_mfma_f32_32x32x16_bf16 a[224:239], v[72:75], v[92:95], a[224:239]
    v_mfma_f32_32x32x16_bf16 a[240:255], v[76:79], v[92:95], a[240:255]
    s_waitcnt vmcnt(16) lgkmcnt(0)
    s_barrier
    v_mfma_f32_32x32x16_bf16 a[0:15], v[96:99], v[112:115], a[0:15]
    ds_read_b128 v[64:67], v3 offset:0
    ds_read_b64_tr_b16 v[80:81], v7 offset:16384
    s_cmp_eq_u32 s49, 0
    s_cbranch_scc0 DS_61
    buffer_store_dwordx4 v[140:143], v21, s[8:11], s47 offen offset:1024 sc1
DS_61:
    v_mfma_f32_32x32x16_bf16 a[16:31], v[100:103], v[112:115], a[16:31]
    ds_read_b64_tr_b16 v[82:83], v7 offset:16896
    ds_read_b128 v[68:71], v3 offset:2048
    v_mfma_f32_32x32x16_bf16 a[32:47], v[104:107], v[112:115], a[32:47]
    ds_read_b128 v[72:75], v3 offset:4096
    ds_read_b128 v[76:79], v3 offset:6144
    v_mfma_f32_32x32x16_bf16 a[48:63], v[108:111], v[112:115], a[48:63]
    ds_read_b64_tr_b16 v[84:85], v8 offset:16384
    ds_read_b64_tr_b16 v[86:87], v8 offset:16896
    v_mfma_f32_32x32x16_bf16 a[64:79], v[96:99], v[116:119], a[64:79]
    ds_read_b64_tr_b16 v[88:89], v7 offset:20480
    ds_read_b64_tr_b16 v[90:91], v7 offset:20992
    s_cmp_eq_u32 s49, 1
    s_cbranch_scc0 DS_62
    buffer_store_dwordx4 v[140:143], v21, s[8:11], s47 offen offset:1024 sc1
DS_62:
    v_mfma_f32_32x32x16_bf16 a[80:95], v[100:103], v[116:119], a[80:95]
    ds_read_b64_tr_b16 v[92:93], v8 offset:20480
    ds_read_b64_tr_b16 v[94:95], v8 offset:20992
    v_mfma_f32_32x32x16_bf16 a[96:111], v[104:107], v[116:119], a[96:111]
    s_add_u32 m0, s40, 32768
    s_nop 0
    buffer_load_dwordx4 v9, s[16:19], s29 offen offset:0 lds
    v_mfma_f32_32x32x16_bf16 a[112:127], v[108:111], v[116:119], a[112:127]
    buffer_load_dwordx4 v10, s[16:19], s29 offen offset:1024 lds
    v_mfma_f32_32x32x16_bf16 a[128:143], v[96:99], v[120:123], a[128:143]
    buffer_load_dwordx4 v11, s[16:19], s29 offen offset:2048 lds
    s_cmp_eq_u32 s49, 2
    s_cbranch_scc0 DS_63
    buffer_store_dwordx4 v[140:143], v21, s[8:11], s47 offen offset:1024 sc1
DS_63:
    v_mfma_f32_32x32x16_bf16 a[144:159], v[100:103], v[120:123], a[144:159]
    buffer_load_dwordx4 v12, s[16:19], s29 offen offset:3072 lds
    v_mfma_f32_32x32x16_bf16 a[160:175], v[104:107], v[120:123], a[160:175]
    s_add_u32 m0, s41, 32768
    s_add_u32 s29, s29, 64
    buffer_load_dwordx4 v13, s[20:23], s30 offen offset:0 lds
    v_mfma_f32_32x32x16_bf16 a[176:191], v[108:111], v[120:123], a[176:191]
    buffer_load_dwordx4 v14, s[20:23], s30 offen offset:1024 lds
    v_mfma_f32_32x32x16_bf16 a[192:207], v[96:99], v[124:127], a[192:207]
    buffer_load_dwordx4 v15, s[20:23], s30 offen offset:2048 lds
    s_cmp_eq_u32 s49, 3
    s_cbranch_scc0 DS_64
    buffer_store_dwordx4 v[140:143], v21, s[8:11], s47 offen offset:1024 sc1
DS_64:
    v_mfma_f32_32x32x16_bf16 a[208:223], v[100:103], v[124:127], a[208:223]
    buffer_load_dwordx4 v16, s[20:23], s30 offen offset:3072 lds
    s_add_u32 s30, s30, s31
    s_sub_u32 s45, s45, 1
    s_cmp_eq_u32 s45, 0
    s_cselect_b32 s33, 1280, 0
    s_cselect_b32 s34, s42, 0
    s_sub_u32 s29, s29, s33
    s_sub_u32 s30, s30, s34
    v_mov_b64 v[136:137], v[168:169]
    v_mov_b64 v[138:139], v[170:171]
    v_mov_b64 v[140:141], v[172:173]
    v_mov_b64 v[142:143], v[174:175]
    v_mfma_f32_32x32x16_bf16 a[224:239], v[104:107], v[124:127], a[224:239]
    v_mov_b64 v[168:169], v[200:201]
    v_mov_b64 v[170:171], v[202:203]
    v_mov_b64 v[172:173], v[204:205]
    v_mov_b64 v[174:175], v[206:207]
    v_mfma_f32_32x32x16_bf16 a[240:255], v[108:111], v[124:127], a[240:255]
    v_mov_b64 v[200:201], v[232:233]
    v_mov_b64 v[202:203], v[234:235]
    v_mov_b64 v[204:205], v[236:237]
    v_mov_b64 v[206:207], v[238:239]
    s_add_u32 s47, s47, 2048
    s_waitcnt lgkmcnt(0)
    v_mfma_f32_32x32x16_bf16 a[0:15], v[64:67], v[80:83], a[0:15]
    ds_read_b128 v[96:99], v4 offset:0
    s_cmp_eq_u32 s46, 0
    s_cselect_b32 s49, 9, s5
    v_mfma_f32_32x32x16_bf16 a[16:31], v[68:71], v[80:83], a[16:31]
    ds_read_b64_tr_b16 v[112:113], v7 offset:18432
    s_cmp_eq_u32 s49, 0
    s_cbranch_scc0 DS_65
    buffer_store_dwordx4 v[144:147], v21, s[8:11], s47 offen offset:0 sc1
DS_65:
    v_mfma_f32_32x32x16_bf16 a[32:47], v[72:75], v[80:83], a[32:47]
    ds_read_b64_tr_b16 v[114:115], v7 offset:18944
    v_mfma_f32_32x32x16_bf16 a[48:63], v[76:79], v[80:83], a[48:63]
    ds_read_b128 v[100:103], v4 offset:2048
    v_mfma_f32_32x32x16_bf16 a[64:79], v[64:67], v[84:87], a[64:79]
    ds_read_b128 v[104:107], v4 offset:4096
    v_mfma_f32_32x32x16_bf16 a[80:95], v[68:71], v[84:87], a[80:95]
    ds_read_b128 v[108:111], v4 offset:6144
    s_cmp_eq_u32 s49, 1
    s_cbranch_scc0 DS_66
    buffer_store_dwordx4 v[144:147], v21, s[8:11], s47 offen offset:0 sc1
DS_66:
    v_mfma_f32_32x32x16_bf16 a[96:111], v[72:75], v[84:87], a[96:111]
    ds_read_b64_tr_b16 v[116:117], v8 offset:18432
    v_mfma_f32_32x32x16_bf16 a[112:127], v[76:79], v[84:87], a[112:127]
    ds_read_b64_tr_b16 v[118:119], v8 offset:18944
    v_mfma_f32_32x32x16_bf16 a[128:143], v[64:67], v[88:91], a[128:143]
    ds_read_b64_tr_b16 v[120:121], v7 offset:22528
    v_mfma_f32_32x32x16_bf16 a[144:159], v[68:71], v[88:91], a[144:159]
    ds_read_b64_tr_b16 v[122:123], v7 offset:23040
    s_cmp_eq_u32 s49, 2
    s_cbranch_scc0 DS_67
    buffer_store_dwordx4 v[144:147], v21, s[8:11], s47 offen offset:0 sc1
DS_67:
    v_mfma_f32_32x32x16_bf16 a[160:175], v[72:75], v[88:91], a[160:175]
    ds_read_b64_tr_b16 v[124:125], v8 offset:22528
    v_mfma_f32_32x32x16_bf16 a[176:191], v[76:79], v[88:91], a[176:191]
    ds_read_b64_tr_b16 v[126:127], v8 offset:23040
    v_mfma_f32_32x32x16_bf16 a[192:207], v[64:67], v[92:95], a[192:207]
    v_mfma_f32_32x32x16_bf16 a[208:223], v[68:71], v[92:95], a[208:223]
    s_cmp_eq_u32 s49, 3
    s_cbranch_scc0 DS_68
    buffer_store_dwordx4 v[144:147], v21, s[8:11], s47 offen offset:0 sc1
DS_68:
    v_mfma_f32_32x32x16_bf16 a[224:239], v[72:75], v[92:95], a[224:239]
    v_mfma_f32_32x32x16_bf16 a[240:255], v[76:79], v[92:95], a[240:255]
    s_waitcnt vmcnt(16) lgkmcnt(0)
    s_barrier
    v_mfma_f32_32x32x16_bf16 a[0:15], v[96:99], v[112:115], a[0:15]
    ds_read_b128 v[64:67], v3 offset:32768
    ds_read_b64_tr_b16 v[80:81], v7 offset:49152
    s_cmp_eq_u32 s49, 0
    s_cbranch_scc0 DS_69
    buffer_store_dwordx4 v[148:151], v21, s[8:11], s47 offen offset:1024 sc1
DS_69:
    v_mfma_f32_32x32x16_bf16 a[16:31], v[100:103], v[112:115], a[16:31]
    ds_read_b64_tr_b16 v[82:83], v7 offset:49664
    ds_read_b128 v[68:71], v3 offset:34816
    v_mfma_f32_32x32x16_bf16 a[32:47], v[104:107], v[112:115], a[32:47]
    ds_read_b128 v[72:75], v3 offset:36864
    ds_read_b128 v[76:79], v3 offset:38912
    v_mfma_f32_32x32x16_bf16 a[48:63], v[108:111], v[112:115], a[48:63]
    ds_read_b64_tr_b16 v[84:85], v8 offset:49152
    ds_read_b64_tr_b16 v[86:87], v8 offset:49664
    v_mfma_f32_32x32x16_bf16 a[64:79], v[96:99], v[116:119], a[64:79]
    ds_read_b64_tr_b16 v[88:89], v7 offset:53248
    ds_read_b64_tr_b16 v[90:91], v7 offset:53760
    s_cmp_eq_u32 s49, 1
    s_cbranch_scc0 DS_70
    buffer_store_dwordx4 v[148:151], v21, s[8:11], s47 offen offset:1024 sc1
DS_70:
    v_mfma_f32_32x32x16_bf16 a[80:95], v[100:103], v[116:119], a[80:95]
    ds_read_b64_tr_b16 v[92:93], v8 offset:53248
    ds_read_b64_tr_b16 v[94:95], v8 offset:53760
    v_mfma_f32_32x32x16_bf16 a[96:111], v[104:107], v[116:119], a[96:111]
    s_add_u32 m0, s40, 65536
    s_nop 0
    buffer_load_dwordx4 v9, s[16:19], s29 offen offset:0 lds
    v_mfma_f32_32x32x16_bf16 a[112:127], v[108:111], v[116:119], a[112:127]
    buffer_load_dwordx4 v10, s[16:19], s29 offen offset:1024 lds
    v_mfma_f32_32x32x16_bf16 a[128:143], v[96:99], v[120:123], a[128:143]
    buffer_load_dwordx4 v11, s[16:19], s29 offen offset:2048 lds
    s_cmp_eq_u32 s49, 2
    s_cbranch_scc0 DS_71
    buffer_store_dwordx4 v[148:151], v21, s[8:11], s47 offen offset:1024 sc1
DS_71:
    v_mfma_f32_32x32x16_bf16 a[144:159], v[100:103], v[120:123], a[144:159]
    buffer_load_dwordx4 v12, s[16:19], s29 offen offset:3072 lds
    v_mfma_f32_32x32x16_bf16 a[160:175], v[104:107], v[120:123], a[160:175]
    s_add_u32 m0, s41, 65536
    s_add_u32 s29, s29, 64
    buffer_load_dwordx4 v13, s[20:23], s30 offen offset:0 lds
    v_mfma_f32_32x32x16_bf16 a[176:191], v[108:111], v[120:123], a[176:191]
    buffer_load_dwordx4 v14, s[20:23], s30 offen offset:1024 lds
    v_mfma_f32_32x32x16_bf16 a[192:207], v[96:99], v[124:127], a[192:207]
    buffer_load_dwordx4 v15, s[20:23], s30 offen offset:2048 lds
    s_cmp_eq_u32 s49, 3
    s_cbranch_scc0 DS_72
    buffer_store_dwordx4 v[148:151], v21, s[8:11], s47 offen offset:1024 sc1
DS_72:
    v_mfma_f32_32x32x16_bf16 a[208:223], v[100:103], v[124:127], a[208:223]
    buffer_load_dwordx4 v16, s[20:23], s30 offen offset:3072 lds
    s_add_u32 s30, s30, s31
    s_sub_u32 s45, s45, 1
    s_cmp_eq_u32 s45, 0
    s_cselect_b32 s33, 1280, 0
    s_cselect_b32 s34, s42, 0
    s_sub_u32 s29, s29, s33
    s_sub_u32 s30, s30, s34
    v_mov_b64 v[144:145], v[176:177]
    v_mov_b64 v[146:147], v[178:179]
    v_mov_b64 v[148:149], v[180:181]
    v_mov_b64 v[150:151], v[182:183]
    v_mfma_f32_32x32x16_bf16 a[224:239], v[104:107], v[124:127], a[224:239]
    v_mov_b64 v[176:177], v[208:209]
    v_mov_b64 v[178:179], v[210:211]
    v_mov_b64 v[180:181], v[212:213]
    v_mov_b64 v[182:183], v[214:215]
    v_mfma_f32_32x32x16_bf16 a[240:255], v[108:111], v[124:127], a[240:255]
    v_mov_b64 v[208:209], v[240:241]
    v_mov_b64 v[210:211], v[242:243]
    v_mov_b64 v[212:213], v[244:245]
    v_mov_b64 v[214:215], v[246:247]
    s_add_u32 s47, s47, 2048
    s_waitcnt lgkmcnt(0)
    v_mfma_f32_32x32x16_bf16 a[0:15], v[64:67], v[80:83], a[0:15]
    ds_read_b128 v[96:99], v4 offset:32768
    s_cmp_eq_u32 s46, 0
    s_cselect_b32 s49, 9, s5
    v_mfma_f32_32x32x16_bf16 a[16:31], v[68:71], v[80:83], a[16:31]
    ds_read_b64_tr_b16 v[112:113], v7 offset:51200
    s_cmp_eq_u32 s49, 0
    s_cbranch_scc0 DS_73
    buffer_store_dwordx4 v[152:155], v21, s[8:11], s47 offen offset:0 sc1
DS_73:
    v_mfma_f32_32x32x16_bf16 a[32:47], v[72:75], v[80:83], a[32:47]
    ds_read_b64_tr_b16 v[114:115], v7 offset:51712
    v_mfma_f32_32x32x16_bf16 a[48:63], v[76:79], v[80:83], a[48:63]
    ds_read_b128 v[100:103], v4 offset:34816
    v_mfma_f32_32x32x16_bf16 a[64:79], v[64:67], v[84:87], a[64:79]
    ds_read_b128 v[104:107], v4 offset:36864
    v_mfma_f32_32x32x16_bf16 a[80:95], v[68:71], v[84:87], a[80:95]
    ds_read_b128 v[108:111], v4 offset:38912
    s_cmp_eq_u32 s49, 1
    s_cbranch_scc0 DS_74
    buffer_store_dwordx4 v[152:155], v21, s[8:11], s47 offen offset:0 sc1
DS_74:
    v_mfma_f32_32x32x16_bf16 a[96:111], v[72:75], v[84:87], a[96:111]
    ds_read_b64_tr_b16 v[116:117], v8 offset:51200
    v_mfma_f32_32x32x16_bf16 a[112:127], v[76:79], v[84:87], a[112:127]
    ds_read_b64_tr_b16 v[118:119], v8 offset:51712
    v_mfma_f32_32x32x16_bf16 a[128:143], v[64:67], v[88:91], a[128:143]
    ds_read_b64_tr_b16 v[120:121], v7 offset:55296
    v_mfma_f32_32x32x16_bf16 a[144:159], v[68:71], v[88:91], a[144:159]
    ds_read_b64_tr_b16 v[122:123], v7 offset:55808
    s_cmp_eq_u32 s49, 2
    s_cbranch_scc0 DS_75
    buffer_store_dwordx4 v[152:155], v21, s[8:11], s47 offen offset:0 sc1
DS_75:
    v_mfma_f32_32x32x16_bf16 a[160:175], v[72:75], v[88:91], a[160:175]
    ds_read_b64_tr_b16 v[124:125], v8 offset:55296
    v_mfma_f32_32x32x16_bf16 a[176:191], v[76:79], v[88:91], a[176:191]
    ds_read_b64_tr_b16 v[126:127], v8 offset:55808
    v_mfma_f32_32x32x16_bf16 a[192:207], v[64:67], v[92:95], a[192:207]
    v_mfma_f32_32x32x16_bf16 a[208:223], v[68:71], v[92:95], a[208:223]
    s_cmp_eq_u32 s49, 3
    s_cbranch_scc0 DS_76
    buffer_store_dwordx4 v[152:155], v21, s[8:11], s47 offen offset:0 sc1
DS_76:
    v_mfma_f32_32x32x16_bf16 a[224:239], v[72:75], v[92:95], a[224:239]
    v_mfma_f32_32x32x16_bf16 a[240:255], v[76:79], v[92:95], a[240:255]
    s_waitcnt vmcnt(16) lgkmcnt(0)
    s_barrier
    v_mfma_f32_32x32x16_bf16 a[0:15], v[96:99], v[112:115], a[0:15]
    ds_read_b128 v[64:67], v1 offset:0
    ds_read_b64_tr_b16 v[80:81], v5 offset:16384
    s_cmp_eq_u32 s49, 0
    s_cbranch_scc0 DS_77
    buffer_store_dwordx4 v[156:159], v21, s[8:11], s47 offen offset:1024 sc1
DS_77:
    v_mfma_f32_32x32x16_bf16 a[16:31], v[100:103], v[112:115], a[16:31]
    ds_read_b64_tr_b16 v[82:83], v5 offset:16896
    ds_read_b128 v[68:71], v1 offset:2048
    v_mfma_f32_32x32x16_bf16 a[32:47], v[104:107], v[112:115], a[32:47]
    ds_read_b128 v[72:75], v1 offset:4096
    ds_read_b128 v[76:79], v1 offset:6144
    v_mfma_f32_32x32x16_bf16 a[48:63], v[108:111], v[112:115], a[48:63]
    ds_read_b64_tr_b16 v[84:85], v6 offset:16384
    ds_read_b64_tr_b16 v[86:87], v6 offset:16896
    v_mfma_f32_32x32x16_bf16 a[64:79], v[96:99], v[116:119], a[64:79]
    ds_read_b64_tr_b16 v[88:89], v5 offset:20480
    ds_read_b64_tr_b16 v[90:91], v5 offset:20992
    s_cmp_eq_u32 s49, 1
    s_cbranch_scc0 DS_78
    buffer_store_dwordx4 v[156:159], v21, s[8:11], s47 offen offset:1024 sc1
DS_78:
    v_mfma_f32_32x32x16_bf16 a[80:95], v[100:103], v[116:119], a[80:95]
    ds_read_b64_tr_b16 v[92:93], v6 offset:20480
    ds_read_b64_tr_b16 v[94:95], v6 offset:20992
    v_mfma_f32_32x32x16_bf16 a[96:111], v[104:107], v[116:119], a[96:111]
    s_add_u32 m0, s40, 98304
    s_nop 0
    buffer_load_dwordx4 v9, s[16:19], s29 offen offset:0 lds
    v_mfma_f32_32x32x16_bf16 a[112:127], v[108:111], v[116:119], a[112:127]
    buffer_load_dwordx4 v10, s[16:19], s29 offen offset:1024 lds
    v_mfma_f32_32x32x16_bf16 a[128:143], v[96:99], v[120:123], a[128:143]
    buffer_load_dwordx4 v11, s[16:19], s29 offen offset:2048 lds
    s_cmp_eq_u32 s49, 2
    s_cbranch_scc0 DS_79
    buffer_store_dwordx4 v[156:159], v21, s[8:11], s47 offen offset:1024 sc1
DS_79:
    v_mfma_f32_32x32x16_bf16 a[144:159], v[100:103], v[120:123], a[144:159]
    buffer_load_dwordx4 v12, s[16:19], s29 offen offset:3072 lds
    v_mfma_f32_32x32x16_bf16 a[160:175], v[104:107], v[120:123], a[160:175]
    s_add_u32 m0, s41, 98304
    s_add_u32 s29, s29, 64
    buffer_load_dwordx4 v13, s[20:23], s30 offen offset:0 lds
    v_mfma_f32_32x32x16_bf16 a[176:191], v[108:111], v[120:123], a[176:191]
    buffer_load_dwordx4 v14, s[20:23], s30 offen offset:1024 lds
    v_mfma_f32_32x32x16_bf16 a[192:207], v[96:99], v[124:127], a[192:207]
    buffer_load_dwordx4 v15, s[20:23], s30 offen offset:2048 lds
    s_cmp_eq_u32 s49, 3
    s_cbranch_scc0 DS_80
    buffer_store_dwordx4 v[156:159], v21, s[8:11], s47 offen offset:1024 sc1
DS_80:
    v_mfma_f32_32x32x16_bf16 a[208:223], v[100:103], v[124:127], a[208:223]
    buffer_load_dwordx4 v16, s[20:23], s30 offen offset:3072 lds
    s_add_u32 s30, s30, s31
    s_sub_u32 s45, s45, 1
    s_cmp_eq_u32 s45, 0
    s_cselect_b32 s33, 1280, 0
    s_cselect_b32 s34, s42, 0
    s_sub_u32 s29, s29, s33
    s_sub_u32 s30, s30, s34
    v_mov_b64 v[152:153], v[184:185]
    v_mov_b64 v[154:155], v[186:187]
    v_mov_b64 v[156:157], v[188:189]
    v_mov_b64 v[158:159], v[190:191]
    v_mfma_f32_32x32x16_bf16 a[224:239], v[104:107], v[124:127], a[224:239]
    v_mov_b64 v[184:185], v[216:217]
    v_mov_b64 v[186:187], v[218:219]
    v_mov_b64 v[188:189], v[220:221]
    v_mov_b64 v[190:191], v[222:223]
    v_mfma_f32_32x32x16_bf16 a[240:255], v[108:111], v[124:127], a[240:255]
    v_mov_b64 v[216:217], v[248:249]
    v_mov_b64 v[218:219], v[250:251]
    v_mov_b64 v[220:221], v[252:253]
    v_mov_b64 v[222:223], v[254:255]
    s_add_u32 s47, s47, 518144
    s_sub_u32 s46, s46, 1
    s_cbranch_scc0 G4_LOOP_V_2
    s_mov_b32 s46, 0
    s_cmp_eq_u32 s48, 0
    s_cbranch_scc1 G4_LOOP_V_2
    buffer_store_dword v25, v24, s[8:11], s48 offen sc1
    s_mov_b32 s48, 0
G4_LOOP_V_2:
    s_add_u32 s32, s32, 1
    s_cmp_lt_u32 s32, 4
    s_cbranch_scc1 G4_LOOP_V_0
    s_waitcnt lgkmcnt(0)
    v_mfma_f32_32x32x16_bf16 a[0:15], v[64:67], v[80:83], a[0:15]
    ds_read_b128 v[96:99], v2 offset:0
    v_mfma_f32_32x32x16_bf16 a[16:31], v[68:71], v[80:83], a[16:31]
    ds_read_b64_tr_b16 v[112:113], v5 offset:18432
    v_mfma_f32_32x32x16_bf16 a[32:47], v[72:75], v[80:83], a[32:47]
    ds_read_b64_tr_b16 v[114:115], v5 offset:18944
    v_mfma_f32_32x32x16_bf16 a[48:63], v[76:79], v[80:83], a[48:63]
    ds_read_b128 v[100:103], v2 offset:2048
    v_mfma_f32_32x32x16_bf16 a[64:79], v[64:67], v[84:87], a[64:79]
    ds_read_b128 v[104:107], v2 offset:4096
    v_mfma_f32_32x32x16_bf16 a[80:95], v[68:71], v[84:87], a[80:95]
    ds_read_b128 v[108:111], v2 offset:6144
    v_mfma_f32_32x32x16_bf16 a[96:111], v[72:75], v[84:87], a[96:111]
    ds_read_b64_tr_b16 v[116:117], v6 offset:18432
    v_mfma_f32_32x32x16_bf16 a[112:127], v[76:79], v[84:87], a[112:127]
    ds_read_b64_tr_b16 v[118:119], v6 offset:18944
    v_mfma_f32_32x32x16_bf16 a[128:143], v[64:67], v[88:91], a[128:143]
    ds_read_b64_tr_b16 v[120:121], v5 offset:22528
    v_mfma_f32_32x32x16_bf16 a[144:159], v[68:71], v[88:91], a[144:159]
    ds_read_b64_tr_b16 v[122:123], v5 offset:23040
    v_mfma_f32_32x32x16_bf16 a[160:175], v[72:75], v[88:91], a[160:175]
    ds_read_b64_tr_b16 v[124:125], v6 offset:22528
    v_mfma_f32_32x32x16_bf16 a[176:191], v[76:79], v[88:91], a[176:191]
    ds_read_b64_tr_b16 v[126:127], v6 offset:23040
    v_mfma_f32_32x32x16_bf16 a[192:207], v[64:67], v[92:95], a[192:207]
    v_mfma_f32_32x32x16_bf16 a[208:223], v[68:71], v[92:95], a[208:223]
    v_mfma_f32_32x32x16_bf16 a[224:239], v[72:75], v[92:95], a[224:239]
    v_mfma_f32_32x32x16_bf16 a[240:255], v[76:79], v[92:95], a[240:255]
    s_waitcnt vmcnt(16) lgkmcnt(0)
    s_barrier
    v_mfma_f32_32x32x16_bf16 a[0:15], v[96:99], v[112:115], a[0:15]
    ds_read_b128 v[64:67], v1 offset:32768
    ds_read_b64_tr_b16 v[80:81], v5 offset:49152
    v_mfma_f32_32x32x16_bf16 a[16:31], v[100:103], v[112:115], a[16:31]
    ds_read_b64_tr_b16 v[82:83], v5 offset:49664
    ds_read_b128 v[68:71], v1 offset:34816
    v_mfma_f32_32x32x16_bf16 a[32:47], v[104:107], v[112:115], a[32:47]
    ds_read_b128 v[72:75], v1 offset:36864
    ds_read_b128 v[76:79], v1 offset:38912
    v_mfma_f32_32x32x16_bf16 a[48:63], v[108:111], v[112:115], a[48:63]
    ds_read_b64_tr_b16 v[84:85], v6 offset:49152
    ds_read_b64_tr_b16 v[86:87], v6 offset:49664
    v_mfma_f32_32x32x16_bf16 a[64:79], v[96:99], v[116:119], a[64:79]
    ds_read_b64_tr_b16 v[88:89], v5 offset:53248
    ds_read_b64_tr_b16 v[90:91], v5 offset:53760
    v_mfma_f32_32x32x16_bf16 a[80:95], v[100:103], v[116:119], a[80:95]
    ds_read_b64_tr_b16 v[92:93], v6 offset:53248
    ds_read_b64_tr_b16 v[94:95], v6 offset:53760
    v_mfma_f32_32x32x16_bf16 a[96:111], v[104:107], v[116:119], a[96:111]
    v_mfma_f32_32x32x16_bf16 a[112:127], v[108:111], v[116:119], a[112:127]
    v_mfma_f32_32x32x16_bf16 a[128:143], v[96:99], v[120:123], a[128:143]
    v_mfma_f32_32x32x16_bf16 a[144:159], v[100:103], v[120:123], a[144:159]
    v_mfma_f32_32x32x16_bf16 a[160:175], v[104:107], v[120:123], a[160:175]
    v_mfma_f32_32x32x16_bf16 a[176:191], v[108:111], v[120:123], a[176:191]
    v_mfma_f32_32x32x16_bf16 a[192:207], v[96:99], v[124:127], a[192:207]
    v_mfma_f32_32x32x16_bf16 a[208:223], v[100:103], v[124:127], a[208:223]
    v_mfma_f32_32x32x16_bf16 a[224:239], v[104:107], v[124:127], a[224:239]
    v_mfma_f32_32x32x16_bf16 a[240:255], v[108:111], v[124:127], a[240:255]
    s_waitcnt lgkmcnt(0)
    v_mfma_f32_32x32x16_bf16 a[0:15], v[64:67], v[80:83], a[0:15]
    ds_read_b128 v[96:99], v2 offset:32768
    v_mfma_f32_32x32x16_bf16 a[16:31], v[68:71], v[80:83], a[16:31]
    ds_read_b64_tr_b16 v[112:113], v5 offset:51200
    v_mfma_f32_32x32x16_bf16 a[32:47], v[72:75], v[80:83], a[32:47]
    ds_read_b64_tr_b16 v[114:115], v5 offset:51712
    v_mfma_f32_32x32x16_bf16 a[48:63], v[76:79], v[80:83], a[48:63]
    ds_read_b128 v[100:103], v2 offset:34816
    v_mfma_f32_32x32x16_bf16 a[64:79], v[64:67], v[84:87], a[64:79]
    ds_read_b128 v[104:107], v2 offset:36864
    v_mfma_f32_32x32x16_bf16 a[80:95], v[68:71], v[84:87], a[80:95]
    ds_read_b128 v[108:111], v2 offset:38912
    v_mfma_f32_32x32x16_bf16 a[96:111], v[72:75], v[84:87], a[96:111]
    ds_read_b64_tr_b16 v[116:117], v6 offset:51200
    v_mfma_f32_32x32x16_bf16 a[112:127], v[76:79], v[84:87], a[112:127]
    ds_read_b64_tr_b16 v[118:119], v6 offset:51712
    v_mfma_f32_32x32x16_bf16 a[128:143], v[64:67], v[88:91], a[128:143]
    ds_read_b64_tr_b16 v[120:121], v5 offset:55296
    v_mfma_f32_32x32x16_bf16 a[144:159], v[68:71], v[88:91], a[144:159]
    ds_read_b64_tr_b16 v[122:123], v5 offset:55808
    v_mfma_f32_32x32x16_bf16 a[160:175], v[72:75], v[88:91], a[160:175]
    ds_read_b64_tr_b16 v[124:125], v6 offset:55296
    v_mfma_f32_32x32x16_bf16 a[176:191], v[76:79], v[88:91], a[176:191]
    ds_read_b64_tr_b16 v[126:127], v6 offset:55808
    v_mfma_f32_32x32x16_bf16 a[192:207], v[64:67], v[92:95], a[192:207]
    v_mfma_f32_32x32x16_bf16 a[208:223], v[68:71], v[92:95], a[208:223]
    v_mfma_f32_32x32x16_bf16 a[224:239], v[72:75], v[92:95], a[224:239]
    v_mfma_f32_32x32x16_bf16 a[240:255], v[76:79], v[92:95], a[240:255]
    s_waitcnt vmcnt(8) lgkmcnt(0)
    s_barrier
    v_mfma_f32_32x32x16_bf16 a[0:15], v[96:99], v[112:115], a[0:15]
    ds_read_b128 v[64:67], v3 offset:0
    ds_read_b64_tr_b16 v[80:81], v7 offset:16384
    v_mfma_f32_32x32x16_bf16 a[16:31], v[100:103], v[112:115], a[16:31]
    ds_read_b64_tr_b16 v[82:83], v7 offset:16896
    ds_read_b128 v[68:71], v3 offset:2048
    v_mfma_f32_32x32x16_bf16 a[32:47], v[104:107], v[112:115], a[32:47]
    ds_read_b128 v[72:75], v3 offset:4096
    ds_read_b128 v[76:79], v3 offset:6144
    v_mfma_f32_32x32x16_bf16 a[48:63], v[108:111], v[112:115], a[48:63]
    ds_read_b64_tr_b16 v[84:85], v8 offset:16384
    ds_read_b64_tr_b16 v[86:87], v8 offset:16896
    v_mfma_f32_32x32x16_bf16 a[64:79], v[96:99], v[116:119], a[64:79]
    ds_read_b64_tr_b16 v[88:89], v7 offset:20480
    ds_read_b64_tr_b16 v[90:91], v7 offset:20992
    v_mfma_f32_32x32x16_bf16 a[80:95], v[100:103], v[116:119], a[80:95]
    ds_read_b64_tr_b16 v[92:93], v8 offset:20480
    ds_read_b64_tr_b16 v[94:95], v8 offset:20992
    v_mfma_f32_32x32x16_bf16 a[96:111], v[104:107], v[116:119], a[96:111]
    v_mfma_f32_32x32x16_bf16 a[112:127], v[108:111], v[116:119], a[112:127]
    v_mfma_f32_32x32x16_bf16 a[128:143], v[96:99], v[120:123], a[128:143]
    v_mfma_f32_32x32x16_bf16 a[144:159], v[100:103], v[120:123], a[144:159]
    v_mfma_f32_32x32x16_bf16 a[160:175], v[104:107], v[120:123], a[160:175]
    v_mfma_f32_32x32x16_bf16 a[176:191], v[108:111], v[120:123], a[176:191]
    v_mfma_f32_32x32x16_bf16 a[192:207], v[96:99], v[124:127], a[192:207]
    v_mfma_f32_32x32x16_bf16 a[208:223], v[100:103], v[124:127], a[208:223]
    v_mfma_f32_32x32x16_bf16 a[224:239], v[104:107], v[124:127], a[224:239]
    v_mfma_f32_32x32x16_bf16 a[240:255], v[108:111], v[124:127], a[240:255]
    s_waitcnt lgkmcnt(0)
    v_mfma_f32_32x32x16_bf16 a[0:15], v[64:67], v[80:83], a[0:15]
    ds_read_b128 v[96:99], v4 offset:0
    v_mfma_f32_32x32x16_bf16 a[16:31], v[68:71], v[80:83], a[16:31]
    ds_read_b64_tr_b16 v[112:113], v7 offset:18432
    v_mfma_f32_32x32x16_bf16 a[32:47], v[72:75], v[80:83], a[32:47]
    ds_read_b64_tr_b16 v[114:115], v7 offset:18944
    v_mfma_f32_32x32x16_bf16 a[48:63], v[76:79], v[80:83], a[48:63]
    ds_read_b128 v[100:103], v4 offset:2048
    v_mfma_f32_32x32x16_bf16 a[64:79], v[64:67], v[84:87], a[64:79]
    ds_read_b128 v[104:107], v4 offset:4096
    v_mfma_f32_32x32x16_bf16 a[80:95], v[68:71], v[84:87], a[80:95]
    ds_read_b128 v[108:111], v4 offset:6144
    v_mfma_f32_32x32x16_bf16 a[96:111], v[72:75], v[84:87], a[96:111]
    ds_read_b64_tr_b16 v[116:117], v8 offset:18432
    v_mfma_f32_32x32x16_bf16 a[112:127], v[76:79], v[84:87], a[112:127]
    ds_read_b64_tr_b16 v[118:119], v8 offset:18944
    v_mfma_f32_32x32x16_bf16 a[128:143], v[64:67], v[88:91], a[128:143]
    ds_read_b64_tr_b16 v[120:121], v7 offset:22528
    v_mfma_f32_32x32x16_bf16 a[144:159], v[68:71], v[88:91], a[144:159]
    ds_read_b64_tr_b16 v[122:123], v7 offset:23040
    v_mfma_f32_32x32x16_bf16 a[160:175], v[72:75], v[88:91], a[160:175]
    ds_read_b64_tr_b16 v[124:125], v8 offset:22528
    v_mfma_f32_32x32x16_bf16 a[176:191], v[76:79], v[88:91], a[176:191]
    ds_read_b64_tr_b16 v[126:127], v8 offset:23040
    v_mfma_f32_32x32x16_bf16 a[192:207], v[64:67], v[92:95], a[192:207]
    v_mfma_f32_32x32x16_bf16 a[208:223], v[68:71], v[92:95], a[208:223]
    v_mfma_f32_32x32x16_bf16 a[224:239], v[72:75], v[92:95], a[224:239]
    v_mfma_f32_32x32x16_bf16 a[240:255], v[76:79], v[92:95], a[240:255]
    s_waitcnt vmcnt(0) lgkmcnt(0)
    s_barrier
    v_mfma_f32_32x32x16_bf16 a[0:15], v[96:99], v[112:115], a[0:15]
    ds_read_b128 v[64:67], v3 offset:32768
    ds_read_b64_tr_b16 v[80:81], v7 offset:49152
    v_mfma_f32_32x32x16_bf16 a[16:31], v[100:103], v[112:115], a[16:31]
    ds_read_b64_tr_b16 v[82:83], v7 offset:49664
    ds_read_b128 v[68:71], v3 offset:34816
    v_mfma_f32_32x32x16_bf16 a[32:47], v[104:107], v[112:115], a[32:47]
    ds_read_b128 v[72:75], v3 offset:36864
    ds_read_b128 v[76:79], v3 offset:38912
    v_mfma_f32_32x32x16_bf16 a[48:63], v[108:111], v[112:115], a[48:63]
    ds_read_b64_tr_b16 v[84:85], v8 offset:49152
    ds_read_b64_tr_b16 v[86:87], v8 offset:49664
    v_mfma_f32_32x32x16_bf16 a[64:79], v[96:99], v[116:119], a[64:79]
    ds_read_b64_tr_b16 v[88:89], v7 offset:53248
    ds_read_b64_tr_b16 v[90:91], v7 offset:53760
    v_mfma_f32_32x32x16_bf16 a[80:95], v[100:103], v[116:119], a[80:95]
    ds_read_b64_tr_b16 v[92:93], v8 offset:53248
    ds_read_b64_tr_b16 v[94:95], v8 offset:53760
    v_mfma_f32_32x32x16_bf16 a[96:111], v[104:107], v[116:119], a[96:111]
    v_mfma_f32_32x32x16_bf16 a[112:127], v[108:111], v[116:119], a[112:127]
    v_mfma_f32_32x32x16_bf16 a[128:143], v[96:99], v[120:123], a[128:143]
    v_mfma_f32_32x32x16_bf16 a[144:159], v[100:103], v[120:123], a[144:159]
    v_mfma_f32_32x32x16_bf16 a[160:175], v[104:107], v[120:123], a[160:175]
    v_mfma_f32_32x32x16_bf16 a[176:191], v[108:111], v[120:123], a[176:191]
    v_mfma_f32_32x32x16_bf16 a[192:207], v[96:99], v[124:127], a[192:207]
    v_mfma_f32_32x32x16_bf16 a[208:223], v[100:103], v[124:127], a[208:223]
    v_mfma_f32_32x32x16_bf16 a[224:239], v[104:107], v[124:127], a[224:239]
    v_mfma_f32_32x32x16_bf16 a[240:255], v[108:111], v[124:127], a[240:255]
    s_waitcnt lgkmcnt(0)
    v_mfma_f32_32x32x16_bf16 a[0:15], v[64:67], v[80:83], a[0:15]
    ds_read_b128 v[96:99], v4 offset:32768
    v_mfma_f32_32x32x16_bf16 a[16:31], v[68:71], v[80:83], a[16:31]
    ds_read_b64_tr_b16 v[112:113], v7 offset:51200
    v_mfma_f32_32x32x16_bf16 a[32:47], v[72:75], v[80:83], a[32:47]
    ds_read_b64_tr_b16 v[114:115], v7 offset:51712
    v_mfma_f32_32x32x16_bf16 a[48:63], v[76:79], v[80:83], a[48:63]
    ds_read_b128 v[100:103], v4 offset:34816
    v_mfma_f32_32x32x16_bf16 a[64:79], v[64:67], v[84:87], a[64:79]
    ds_read_b128 v[104:107], v4 offset:36864
    v_mfma_f32_32x32x16_bf16 a[80:95], v[68:71], v[84:87], a[80:95]
    ds_read_b128 v[108:111], v4 offset:38912
    v_mfma_f32_32x32x16_bf16 a[96:111], v[72:75], v[84:87], a[96:111]
    ds_read_b64_tr_b16 v[116:117], v8 offset:51200
    v_mfma_f32_32x32x16_bf16 a[112:127], v[76:79], v[84:87], a[112:127]
    ds_read_b64_tr_b16 v[118:119], v8 offset:51712
    v_mfma_f32_32x32x16_bf16 a[128:143], v[64:67], v[88:91], a[128:143]
    ds_read_b64_tr_b16 v[120:121], v7 offset:55296
    v_mfma_f32_32x32x16_bf16 a[144:159], v[68:71], v[88:91], a[144:159]
    ds_read_b64_tr_b16 v[122:123], v7 offset:55808
    v_mfma_f32_32x32x16_bf16 a[160:175], v[72:75], v[88:91], a[160:175]
    ds_read_b64_tr_b16 v[124:125], v8 offset:55296
    v_mfma_f32_32x32x16_bf16 a[176:191], v[76:79], v[88:91], a[176:191]
    ds_read_b64_tr_b16 v[126:127], v8 offset:55808
    v_mfma_f32_32x32x16_bf16 a[192:207], v[64:67], v[92:95], a[192:207]
    v_mfma_f32_32x32x16_bf16 a[208:223], v[68:71], v[92:95], a[208:223]
    v_mfma_f32_32x32x16_bf16 a[224:239], v[72:75], v[92:95], a[224:239]
    v_mfma_f32_32x32x16_bf16 a[240:255], v[76:79], v[92:95], a[240:255]
    s_waitcnt lgkmcnt(0)
    s_barrier
    v_mfma_f32_32x32x16_bf16 a[0:15], v[96:99], v[112:115], a[0:15]
    v_mfma_f32_32x32x16_bf16 a[16:31], v[100:103], v[112:115], a[16:31]
    v_mfma_f32_32x32x16_bf16 a[32:47], v[104:107], v[112:115], a[32:47]
    v_mfma_f32_32x32x16_bf16 a[48:63], v[108:111], v[112:115], a[48:63]
    v_mfma_f32_32x32x16_bf16 a[64:79], v[96:99], v[116:119], a[64:79]
    v_mfma_f32_32x32x16_bf16 a[80:95], v[100:103], v[116:119], a[80:95]
    v_mfma_f32_32x32x16_bf16 a[96:111], v[104:107], v[116:119], a[96:111]
    v_mfma_f32_32x32x16_bf16 a[112:127], v[108:111], v[116:119], a[112:127]
    v_mfma_f32_32x32x16_bf16 a[128:143], v[96:99], v[120:123], a[128:143]
    v_mfma_f32_32x32x16_bf16 a[144:159], v[100:103], v[120:123], a[144:159]
    v_mfma_f32_32x32x16_bf16 a[160:175], v[104:107], v[120:123], a[160:175]
    v_mfma_f32_32x32x16_bf16 a[176:191], v[108:111], v[120:123], a[176:191]
    v_mfma_f32_32x32x16_bf16 a[192:207], v[96:99], v[124:127], a[192:207]
    v_mfma_f32_32x32x16_bf16 a[208:223], v[100:103], v[124:127], a[208:223]
    v_mfma_f32_32x32x16_bf16 a[224:239], v[104:107], v[124:127], a[224:239]
    v_mfma_f32_32x32x16_bf16 a[240:255], v[108:111], v[124:127], a[240:255]
    s_branch G_EPI
G_EPI:
    s_cmp_eq_u32 s48, 0
    s_cbranch_scc1 G_EPI1
    buffer_store_dword v25, v24, s[8:11], s48 offen sc1
    s_mov_b32 s48, 0
G_EPI1:
    s_cmp_eq_u32 s25, 3
    s_cbranch_scc1 G_EPI_FFN
    s_cmp_lg_u32 s60, 0
    s_cbranch_scc1 G_POLD
    s_mov_b32 s32, 200000
G_POLL:
    buffer_load_dword v18, off, s[12:15], 0 offset:12 sc1
    buffer_load_dword v19, off, s[12:15], 0 offset:0 sc1
    s_waitcnt vmcnt(0)
    v_readfirstlane_b32 s60, v18
    v_readfirstlane_b32 s61, v19
    s_nop 0
    s_cmp_ge_u32 s61, 64
    s_cselect_b32 s60, s60, 0
    s_cmp_lg_u32 s60, 0
    s_cbranch_scc1 G_POLD
    s_sub_u32 s32, s32, 1
    s_cbranch_scc0 G_POLL
    s_endpgm
G_POLD:
    s_lshr_b32 s33, s44, 2
    s_xor_b32 s33, s33, s60
    s_and_b32 s33, s33, 1
    s_lshl_b32 s33, s33, 13
    s_xor_b32 s28, s28, s33
    s_mov_b32 s47, s28
    s_lshl_b32 s46, 1, s43
    s_cmp_eq_u32 s25, 2
    s_cbranch_scc1 G_EPI_Q
    s_lshl_b32 s48, s27, 5
    s_add_u32 s48, s48, s24
    s_lshl_b32 s48, s48, 2
    s_add_u32 s48, s48, 0x5030000
    s_cmp_eq_u32 s5, 0
    s_cselect_b32 s48, s48, 0
    v_mov_b32 v19, 0x80000000
    v_lshlrev_b32 v20, 2, v17
    v_cmp_gt_u32 vcc, s43, v17
    s_nop 1
    v_cndmask_b32 v24, v19, v20, vcc
    v_accvgpr_read_b32 v64, a0
    v_accvgpr_read_b32 v65, a1
    v_accvgpr_read_b32 v66, a2
    v_accvgpr_read_b32 v67, a3
    v_accvgpr_read_b32 v68, a4
    v_accvgpr_read_b32 v69, a5
    v_accvgpr_read_b32 v70, a6
    v_accvgpr_read_b32 v71, a7
    v_cvt_pk_bf16_f32 v128, v64, v65
    v_cvt_pk_bf16_f32 v129, v66, v67
    v_cvt_pk_bf16_f32 v130, v68, v69
    v_cvt_pk_bf16_f32 v131, v70, v71
    v_accvgpr_read_b32 v72, a8
    v_accvgpr_read_b32 v73, a9
    v_accvgpr_read_b32 v74, a10
    v_accvgpr_read_b32 v75, a11
    v_accvgpr_read_b32 v76, a12
    v_accvgpr_read_b32 v77, a13
    v_accvgpr_read_b32 v78, a14
    v_accvgpr_read_b32 v79, a15
    v_cvt_pk_bf16_f32 v132, v72, v73
    v_cvt_pk_bf16_f32 v133, v74, v75
    v_cvt_pk_bf16_f32 v134, v76, v77
    v_cvt_pk_bf16_f32 v135, v78, v79
    v_accvgpr_read_b32 v80, a64
    v_accvgpr_read_b32 v81, a65
    v_accvgpr_read_b32 v82, a66
    v_accvgpr_read_b32 v83, a67
    v_accvgpr_read_b32 v84, a68
    v_accvgpr_read_b32 v85, a69
    v_accvgpr_read_b32 v86, a70
    v_accvgpr_read_b32 v87, a71
    v_cvt_pk_bf16_f32 v136, v80, v81
    v_cvt_pk_bf16_f32 v137, v82, v83
    v_cvt_pk_bf16_f32 v138, v84, v85
    v_cvt_pk_bf16_f32 v139, v86, v87
    v_accvgpr_read_b32 v88, a72
    v_accvgpr_read_b32 v89, a73
    v_accvgpr_read_b32 v90, a74
    v_accvgpr_read_b32 v91, a75
    v_accvgpr_read_b32 v92, a76
    v_accvgpr_read_b32 v93, a77
    v_accvgpr_read_b32 v94, a78
    v_accvgpr_read_b32 v95, a79
    v_cvt_pk_bf16_f32 v140, v88, v89
    v_cvt_pk_bf16_f32 v141, v90, v91
    v_cvt_pk_bf16_f32 v142, v92, v93
    v_cvt_pk_bf16_f32 v143, v94, v95
    v_accvgpr_read_b32 v64, a128
    v_accvgpr_read_b32 v65, a129
    v_accvgpr_read_b32 v66, a130
    v_accvgpr_read_b32 v67, a131
    v_accvgpr_read_b32 v68, a132
    v_accvgpr_read_b32 v69, a133
    v_accvgpr_read_b32 v70, a134
    v_accvgpr_read_b32 v71, a135
    v_cvt_pk_bf16_f32 v144, v64, v65
    v_cvt_pk_bf16_f32 v145, v66, v67
    v_cvt_pk_bf16_f32 v146, v68, v69
    v_cvt_pk_bf16_f32 v147, v70, v71
    v_accvgpr_read_b32 v72, a136
    v_accvgpr_read_b32 v73, a137
    v_accvgpr_read_b32 v74, a138
    v_accvgpr_read_b32 v75, a139
    v_accvgpr_read_b32 v76, a140
    v_accvgpr_read_b32 v77, a141
    v_accvgpr_read_b32 v78, a142
    v_accvgpr_read_b32 v79, a143
    v_cvt_pk_bf16_f32 v148, v72, v73
    v_cvt_pk_bf16_f32 v149, v74, v75
    v_cvt_pk_bf16_f32 v150, v76, v77
    v_cvt_pk_bf16_f32 v151, v78, v79
    v_accvgpr_read_b32 v80, a192
    v_accvgpr_read_b32 v81, a193
    v_accvgpr_read_b32 v82, a194
    v_accvgpr_read_b32 v83, a195
    v_accvgpr_read_b32 v84, a196
    v_accvgpr_read_b32 v85, a197
    v_accvgpr_read_b32 v86, a198
    v_accvgpr_read_b32 v87, a199
    v_cvt_pk_bf16_f32 v152, v80, v81
    v_cvt_pk_bf16_f32 v153, v82, v83
    v_cvt_pk_bf16_f32 v154, v84, v85
    v_cvt_pk_bf16_f32 v155, v86, v87
    v_accvgpr_read_b32 v88, a200
    v_accvgpr_read_b32 v89, a201
    v_accvgpr_read_b32 v90, a202
    v_accvgpr_read_b32 v91, a203
    v_accvgpr_read_b32 v92, a204
    v_accvgpr_read_b32 v93, a205
    v_accvgpr_read_b32 v94, a206
    v_accvgpr_read_b32 v95, a207
    v_cvt_pk_bf16_f32 v156, v88, v89
    v_cvt_pk_bf16_f32 v157, v90, v91
    v_cvt_pk_bf16_f32 v158, v92, v93
    v_cvt_pk_bf16_f32 v159, v94, v95
    v_accvgpr_read_b32 v64, a16
    v_accvgpr_read_b32 v65, a17
    v_accvgpr_read_b32 v66, a18
    v_accvgpr_read_b32 v67, a19
    v_accvgpr_read_b32 v68, a20
    v_accvgpr_read_b32 v69, a21
    v_accvgpr_read_b32 v70, a22
    v_accvgpr_read_b32 v71, a23
    v_cvt_pk_bf16_f32 v160, v64, v65
    v_cvt_pk_bf16_f32 v161, v66, v67
    v_cvt_pk_bf16_f32 v162, v68, v69
    v_cvt_pk_bf16_f32 v163, v70, v71
    v_accvgpr_read_b32 v72, a24
    v_accvgpr_read_b32 v73, a25
    v_accvgpr_read_b32 v74, a26
    v_accvgpr_read_b32 v75, a27
    v_accvgpr_read_b32 v76, a28
    v_accvgpr_read_b32 v77, a29
    v_accvgpr_read_b32 v78, a30
    v_accvgpr_read_b32 v79, a31
    v_cvt_pk_bf16_f32 v164, v72, v73
    v_cvt_pk_bf16_f32 v165, v74, v75
    v_cvt_pk_bf16_f32 v166, v76, v77
    v_cvt_pk_bf16_f32 v167, v78, v79
    v_accvgpr_read_b32 v80, a80
    v_accvgpr_read_b32 v81, a81
    v_accvgpr_read_b32 v82, a82
    v_accvgpr_read_b32 v83, a83
    v_accvgpr_read_b32 v84, a84
    v_accvgpr_read_b32 v85, a85
    v_accvgpr_read_b32 v86, a86
    v_accvgpr_read_b32 v87, a87
    v_cvt_pk_bf16_f32 v168, v80, v81
    v_cvt_pk_bf16_f32 v169, v82, v83
    v_cvt_pk_bf16_f32 v170, v84, v85
    v_cvt_pk_bf16_f32 v171, v86, v87
    v_accvgpr_read_b32 v88, a88
    v_accvgpr_read_b32 v89, a89
    v_accvgpr_read_b32 v90, a90
    v_accvgpr_read_b32 v91, a91
    v_accvgpr_read_b32 v92, a92
    v_accvgpr_read_b32 v93, a93
    v_accvgpr_read_b32 v94, a94
    v_accvgpr_read_b32 v95, a95
    v_cvt_pk_bf16_f32 v172, v88, v89
    v_cvt_pk_bf16_f32 v173, v90, v91
    v_cvt_pk_bf16_f32 v174, v92, v93
    v_cvt_pk_bf16_f32 v175, v94, v95
    v_accvgpr_read_b32 v64, a144
    v_accvgpr_read_b32 v65, a145
    v_accvgpr_read_b32 v66, a146
    v_accvgpr_read_b32 v67, a147
    v_accvgpr_read_b32 v68, a148
    v_accvgpr_read_b32 v69, a149
    v_accvgpr_read_b32 v70, a150
    v_accvgpr_read_b32 v71, a151
    v_cvt_pk_bf16_f32 v176, v64, v65
    v_cvt_pk_bf16_f32 v177, v66, v67
    v_cvt_pk_bf16_f32 v178, v68, v69
    v_cvt_pk_bf16_f32 v179, v70, v71
    v_accvgpr_read_b32 v72, a152
    v_accvgpr_read_b32 v73, a153
    v_accvgpr_read_b32 v74, a154
    v_accvgpr_read_b32 v75, a155
    v_accvgpr_read_b32 v76, a156
    v_accvgpr_read_b32 v77, a157
    v_accvgpr_read_b32 v78, a158
    v_accvgpr_read_b32 v79, a159
    v_cvt_pk_bf16_f32 v180, v72, v73
    v_cvt_pk_bf16_f32 v181, v74, v75
    v_cvt_pk_bf16_f32 v182, v76, v77
    v_cvt_pk_bf16_f32 v183, v78, v79
    v_accvgpr_read_b32 v80, a208
    v_accvgpr_read_b32 v81, a209
    v_accvgpr_read_b32 v82, a210
    v_accvgpr_read_b32 v83, a211
    v_accvgpr_read_b32 v84, a212
    v_accvgpr_read_b32 v85, a213
    v_accvgpr_read_b32 v86, a214
    v_accvgpr_read_b32 v87, a215
    v_cvt_pk_bf16_f32 v184, v80, v81
    v_cvt_pk_bf16_f32 v185, v82, v83
    v_cvt_pk_bf16_f32 v186, v84, v85
    v_cvt_pk_bf16_f32 v187, v86, v87
    v_accvgpr_read_b32 v88, a216
    v_accvgpr_read_b32 v89, a217
    v_accvgpr_read_b32 v90, a218
    v_accvgpr_read_b32 v91, a219
    v_accvgpr_read_b32 v92, a220
    v_accvgpr_read_b32 v93, a221
    v_accvgpr_read_b32 v94, a222
    v_accvgpr_read_b32 v95, a223
    v_cvt_pk_bf16_f32 v188, v88, v89
    v_cvt_pk_bf16_f32 v189, v90, v91
    v_cvt_pk_bf16_f32 v190, v92, v93
    v_cvt_pk_bf16_f32 v191, v94, v95
    s_cmp_eq_u32 s43, 1
    s_cbranch_scc1 G_EPI_CD
    v_accvgpr_read_b32 v64, a32
    v_accvgpr_read_b32 v65, a33
    v_accvgpr_read_b32 v66, a34
    v_accvgpr_read_b32 v67, a35
    v_accvgpr_read_b32 v68, a36
    v_accvgpr_read_b32 v69, a37
    v_accvgpr_read_b32 v70, a38
    v_accvgpr_read_b32 v71, a39
    v_cvt_pk_bf16_f32 v192, v64, v65
    v_cvt_pk_bf16_f32 v193, v66, v67
    v_cvt_pk_bf16_f32 v194, v68, v69
    v_cvt_pk_bf16_f32 v195, v70, v71
    v_accvgpr_read_b32 v72, a40
    v_accvgpr_read_b32 v73, a41
    v_accvgpr_read_b32 v74, a42
    v_accvgpr_read_b32 v75, a43
    v_accvgpr_read_b32 v76, a44
    v_accvgpr_read_b32 v77, a45
    v_accvgpr_read_b32 v78, a46
    v_accvgpr_read_b32 v79, a47
    v_cvt_pk_bf16_f32 v196, v72, v73
    v_cvt_pk_bf16_f32 v197, v74, v75
    v_cvt_pk_bf16_f32 v198, v76, v77
    v_cvt_pk_bf16_f32 v199, v78, v79
    v_accvgpr_read_b32 v80, a96
    v_accvgpr_read_b32 v81, a97
    v_accvgpr_read_b32 v82, a98
    v_accvgpr_read_b32 v83, a99
    v_accvgpr_read_b32 v84, a100
    v_accvgpr_read_b32 v85, a101
    v_accvgpr_read_b32 v86, a102
    v_accvgpr_read_b32 v87, a103
    v_cvt_pk_bf16_f32 v200, v80, v81
    v_cvt_pk_bf16_f32 v201, v82, v83
    v_cvt_pk_bf16_f32 v202, v84, v85
    v_cvt_pk_bf16_f32 v203, v86, v87
    v_accvgpr_read_b32 v88, a104
    v_accvgpr_read_b32 v89, a105
    v_accvgpr_read_b32 v90, a106
    v_accvgpr_read_b32 v91, a107
    v_accvgpr_read_b32 v92, a108
    v_accvgpr_read_b32 v93, a109
    v_accvgpr_read_b32 v94, a110
    v_accvgpr_read_b32 v95, a111
    v_cvt_pk_bf16_f32 v204, v88, v89
    v_cvt_pk_bf16_f32 v205, v90, v91
    v_cvt_pk_bf16_f32 v206, v92, v93
    v_cvt_pk_bf16_f32 v207, v94, v95
    v_accvgpr_read_b32 v64, a160
    v_accvgpr_read_b32 v65, a161
    v_accvgpr_read_b32 v66, a162
    v_accvgpr_read_b32 v67, a163
    v_accvgpr_read_b32 v68, a164
    v_accvgpr_read_b32 v69, a165
    v_accvgpr_read_b32 v70, a166
    v_accvgpr_read_b32 v71, a167
    v_cvt_pk_bf16_f32 v208, v64, v65
    v_cvt_pk_bf16_f32 v209, v66, v67
    v_cvt_pk_bf16_f32 v210, v68, v69
    v_cvt_pk_bf16_f32 v211, v70, v71
    v_accvgpr_read_b32 v72, a168
    v_accvgpr_read_b32 v73, a169
    v_accvgpr_read_b32 v74, a170
    v_accvgpr_read_b32 v75, a171
    v_accvgpr_read_b32 v76, a172
    v_accvgpr_read_b32 v77, a173
    v_accvgpr_read_b32 v78, a174
    v_accvgpr_read_b32 v79, a175
    v_cvt_pk_bf16_f32 v212, v72, v73
    v_cvt_pk_bf16_f32 v213, v74, v75
    v_cvt_pk_bf16_f32 v214, v76, v77
    v_cvt_pk_bf16_f32 v215, v78, v79
    v_accvgpr_read_b32 v80, a224
    v_accvgpr_read_b32 v81, a225
    v_accvgpr_read_b32 v82, a226
    v_accvgpr_read_b32 v83, a227
    v_accvgpr_read_b32 v84, a228
    v_accvgpr_read_b32 v85, a229
    v_accvgpr_read_b32 v86, a230
    v_accvgpr_read_b32 v87, a231
    v_cvt_pk_bf16_f32 v216, v80, v81
    v_cvt_pk_bf16_f32 v217, v82, v83
    v_cvt_pk_bf16_f32 v218, v84, v85
    v_cvt_pk_bf16_f32 v219, v86, v87
    v_accvgpr_read_b32 v88, a232
    v_accvgpr_read_b32 v89, a233
    v_accvgpr_read_b32 v90, a234
    v_accvgpr_read_b32 v91, a235
    v_accvgpr_read_b32 v92, a236
    v_accvgpr_read_b32 v93, a237
    v_accvgpr_read_b32 v94, a238
    v_accvgpr_read_b32 v95, a239
    v_cvt_pk_bf16_f32 v220, v88, v89
    v_cvt_pk_bf16_f32 v221, v90, v91
    v_cvt_pk_bf16_f32 v222, v92, v93
    v_cvt_pk_bf16_f32 v223, v94, v95
    v_accvgpr_read_b32 v64, a48
    v_accvgpr_read_b32 v65, a49
    v_accvgpr_read_b32 v66, a50
    v_accvgpr_read_b32 v67, a51
    v_accvgpr_read_b32 v68, a52
    v_accvgpr_read_b32 v69, a53
    v_accvgpr_read_b32 v70, a54
    v_accvgpr_read_b32 v71, a55
    v_cvt_pk_bf16_f32 v224, v64, v65
    v_cvt_pk_bf16_f32 v225, v66, v67
    v_cvt_pk_bf16_f32 v226, v68, v69
    v_cvt_pk_bf16_f32 v227, v70, v71
    v_accvgpr_read_b32 v72, a56
    v_accvgpr_read_b32 v73, a57
    v_accvgpr_read_b32 v74, a58
    v_accvgpr_read_b32 v75, a59
    v_accvgpr_read_b32 v76, a60
    v_accvgpr_read_b32 v77, a61
    v_accvgpr_read_b32 v78, a62
    v_accvgpr_read_b32 v79, a63
    v_cvt_pk_bf16_f32 v228, v72, v73
    v_cvt_pk_bf16_f32 v229, v74, v75
    v_cvt_pk_bf16_f32 v230, v76, v77
    v_cvt_pk_bf16_f32 v231, v78, v79
    v_accvgpr_read_b32 v80, a112
    v_accvgpr_read_b32 v81, a113
    v_accvgpr_read_b32 v82, a114
    v_accvgpr_read_b32 v83, a115
    v_accvgpr_read_b32 v84, a116
    v_accvgpr_read_b32 v85, a117
    v_accvgpr_read_b32 v86, a118
    v_accvgpr_read_b32 v87, a119
    v_cvt_pk_bf16_f32 v232, v80, v81
    v_cvt_pk_bf16_f32 v233, v82, v83
    v_cvt_pk_bf16_f32 v234, v84, v85
    v_cvt_pk_bf16_f32 v235, v86, v87
    v_accvgpr_read_b32 v88, a120
    v_accvgpr_read_b32 v89, a121
    v_accvgpr_read_b32 v90, a122
    v_accvgpr_read_b32 v91, a123
    v_accvgpr_read_b32 v92, a124
    v_accvgpr_read_b32 v93, a125
    v_accvgpr_read_b32 v94, a126
    v_accvgpr_read_b32 v95, a127
    v_cvt_pk_bf16_f32 v236, v88, v89
    v_cvt_pk_bf16_f32 v237, v90, v91
    v_cvt_pk_bf16_f32 v238, v92, v93
    v_cvt_pk_bf16_f32 v239, v94, v95
    v_accvgpr_read_b32 v64, a176
    v_accvgpr_read_b32 v65, a177
    v_accvgpr_read_b32 v66, a178
    v_accvgpr_read_b32 v67, a179
    v_accvgpr_read_b32 v68, a180
    v_accvgpr_read_b32 v69, a181
    v_accvgpr_read_b32 v70, a182
    v_accvgpr_read_b32 v71, a183
    v_cvt_pk_bf16_f32 v240, v64, v65
    v_cvt_pk_bf16_f32 v241, v66, v67
    v_cvt_pk_bf16_f32 v242, v68, v69
    v_cvt_pk_bf16_f32 v243, v70, v71
    v_accvgpr_read_b32 v72, a184
    v_accvgpr_read_b32 v73, a185
    v_accvgpr_read_b32 v74, a186
    v_accvgpr_read_b32 v75, a187
    v_accvgpr_read_b32 v76, a188
    v_accvgpr_read_b32 v77, a189
    v_accvgpr_read_b32 v78, a190
    v_accvgpr_read_b32 v79, a191
    v_cvt_pk_bf16_f32 v244, v72, v73
    v_cvt_pk_bf16_f32 v245, v74, v75
    v_cvt_pk_bf16_f32 v246, v76, v77
    v_cvt_pk_bf16_f32 v247, v78, v79
    v_accvgpr_read_b32 v80, a240
    v_accvgpr_read_b32 v81, a241
    v_accvgpr_read_b32 v82, a242
    v_accvgpr_read_b32 v83, a243
    v_accvgpr_read_b32 v84, a244
    v_accvgpr_read_b32 v85, a245
    v_accvgpr_read_b32 v86, a246
    v_accvgpr_read_b32 v87, a247
    v_cvt_pk_bf16_f32 v248, v80, v81
    v_cvt_pk_bf16_f32 v249, v82, v83
    v_cvt_pk_bf16_f32 v250, v84, v85
    v_cvt_pk_bf16_f32 v251, v86, v87
    v_accvgpr_read_b32 v88, a248
    v_accvgpr_read_b32 v89, a249
    v_accvgpr_read_b32 v90, a250
    v_accvgpr_read_b32 v91, a251
    v_accvgpr_read_b32 v92, a252
    v_accvgpr_read_b32 v93, a253
    v_accvgpr_read_b32 v94, a254
    v_accvgpr_read_b32 v95, a255
    v_cvt_pk_bf16_f32 v252, v88, v89
    v_cvt_pk_bf16_f32 v253, v90, v91
    v_cvt_pk_bf16_f32 v254, v92, v93
    v_cvt_pk_bf16_f32 v255, v94, v95
    s_branch G_EPI_CD
G_EPI_Q:
    s_mov_b32 s34, 0x3e0293ee
    v_accvgpr_read_b32 v64, a0
    v_accvgpr_read_b32 v65, a1
    v_accvgpr_read_b32 v66, a2
    v_accvgpr_read_b32 v67, a3
    v_accvgpr_read_b32 v68, a4
    v_accvgpr_read_b32 v69, a5
    v_accvgpr_read_b32 v70, a6
    v_accvgpr_read_b32 v71, a7
    v_mul_f32 v64, s34, v64
    v_mul_f32 v65, s34, v65
    v_mul_f32 v66, s34, v66
    v_mul_f32 v67, s34, v67
    v_mul_f32 v68, s34, v68
    v_mul_f32 v69, s34, v69
    v_mul_f32 v70, s34, v70
    v_mul_f32 v71, s34, v71
    v_cvt_pk_bf16_f32 v128, v64, v65
    v_cvt_pk_bf16_f32 v129, v66, v67
    v_cvt_pk_bf16_f32 v130, v68, v69
    v_cvt_pk_bf16_f32 v131, v70, v71
    v_accvgpr_read_b32 v72, a8
    v_accvgpr_read_b32 v73, a9
    v_accvgpr_read_b32 v74, a10
    v_accvgpr_read_b32 v75, a11
    v_accvgpr_read_b32 v76, a12
    v_accvgpr_read_b32 v77, a13
    v_accvgpr_read_b32 v78, a14
    v_accvgpr_read_b32 v79, a15
    v_mul_f32 v72, s34, v72
    v_mul_f32 v73, s34, v73
    v_mul_f32 v74, s34, v74
    v_mul_f32 v75, s34, v75
    v_mul_f32 v76, s34, v76
    v_mul_f32 v77, s34, v77
    v_mul_f32 v78, s34, v78
    v_mul_f32 v79, s34, v79
    v_cvt_pk_bf16_f32 v132, v72, v73
    v_cvt_pk_bf16_f32 v133, v74, v75
    v_cvt_pk_bf16_f32 v134, v76, v77
    v_cvt_pk_bf16_f32 v135, v78, v79
    v_accvgpr_read_b32 v80, a64
    v_accvgpr_read_b32 v81, a65
    v_accvgpr_read_b32 v82, a66
    v_accvgpr_read_b32 v83, a67
    v_accvgpr_read_b32 v84, a68
    v_accvgpr_read_b32 v85, a69
    v_accvgpr_read_b32 v86, a70
    v_accvgpr_read_b32 v87, a71
    v_mul_f32 v80, s34, v80
    v_mul_f32 v81, s34, v81
    v_mul_f32 v82, s34, v82
    v_mul_f32 v83, s34, v83
    v_mul_f32 v84, s34, v84
    v_mul_f32 v85, s34, v85
    v_mul_f32 v86, s34, v86
    v_mul_f32 v87, s34, v87
    v_cvt_pk_bf16_f32 v136, v80, v81
    v_cvt_pk_bf16_f32 v137, v82, v83
    v_cvt_pk_bf16_f32 v138, v84, v85
    v_cvt_pk_bf16_f32 v139, v86, v87
    v_accvgpr_read_b32 v88, a72
    v_accvgpr_read_b32 v89, a73
    v_accvgpr_read_b32 v90, a74
    v_accvgpr_read_b32 v91, a75
    v_accvgpr_read_b32 v92, a76
    v_accvgpr_read_b32 v93, a77
    v_accvgpr_read_b32 v94, a78
    v_accvgpr_read_b32 v95, a79
    v_mul_f32 v88, s34, v88
    v_mul_f32 v89, s34, v89
    v_mul_f32 v90, s34, v90
    v_mul_f32 v91, s34, v91
    v_mul_f32 v92, s34, v92
    v_mul_f32 v93, s34, v93
    v_mul_f32 v94, s34, v94
    v_mul_f32 v95, s34, v95
    v_cvt_pk_bf16_f32 v140, v88, v89
    v_cvt_pk_bf16_f32 v141, v90, v91
    v_cvt_pk_bf16_f32 v142, v92, v93
    v_cvt_pk_bf16_f32 v143, v94, v95
    v_accvgpr_read_b32 v64, a128
    v_accvgpr_read_b32 v65, a129
    v_accvgpr_read_b32 v66, a130
    v_accvgpr_read_b32 v67, a131
    v_accvgpr_read_b32 v68, a132
    v_accvgpr_read_b32 v69, a133
    v_accvgpr_read_b32 v70, a134
    v_accvgpr_read_b32 v71, a135
    v_mul_f32 v64, s34, v64
    v_mul_f32 v65, s34, v65
    v_mul_f32 v66, s34, v66
    v_mul_f32 v67, s34, v67
    v_mul_f32 v68, s34, v68
    v_mul_f32 v69, s34, v69
    v_mul_f32 v70, s34, v70
    v_mul_f32 v71, s34, v71
    v_cvt_pk_bf16_f32 v144, v64, v65
    v_cvt_pk_bf16_f32 v145, v66, v67
    v_cvt_pk_bf16_f32 v146, v68, v69
    v_cvt_pk_bf16_f32 v147, v70, v71
    v_accvgpr_read_b32 v72, a136
    v_accvgpr_read_b32 v73, a137
    v_accvgpr_read_b32 v74, a138
    v_accvgpr_read_b32 v75, a139
    v_accvgpr_read_b32 v76, a140
    v_accvgpr_read_b32 v77, a141
    v_accvgpr_read_b32 v78, a142
    v_accvgpr_read_b32 v79, a143
    v_mul_f32 v72, s34, v72
    v_mul_f32 v73, s34, v73
    v_mul_f32 v74, s34, v74
    v_mul_f32 v75, s34, v75
    v_mul_f32 v76, s34, v76
    v_mul_f32 v77, s34, v77
    v_mul_f32 v78, s34, v78
    v_mul_f32 v79, s34, v79
    v_cvt_pk_bf16_f32 v148, v72, v73
    v_cvt_pk_bf16_f32 v149, v74, v75
    v_cvt_pk_bf16_f32 v150, v76, v77
    v_cvt_pk_bf16_f32 v151, v78, v79
    v_accvgpr_read_b32 v80, a192
    v_accvgpr_read_b32 v81, a193
    v_accvgpr_read_b32 v82, a194
    v_accvgpr_read_b32 v83, a195
    v_accvgpr_read_b32 v84, a196
    v_accvgpr_read_b32 v85, a197
    v_accvgpr_read_b32 v86, a198
    v_accvgpr_read_b32 v87, a199
    v_mul_f32 v80, s34, v80
    v_mul_f32 v81, s34, v81
    v_mul_f32 v82, s34, v82
    v_mul_f32 v83, s34, v83
    v_mul_f32 v84, s34, v84
    v_mul_f32 v85, s34, v85
    v_mul_f32 v86, s34, v86
    v_mul_f32 v87, s34, v87
    v_cvt_pk_bf16_f32 v152, v80, v81
    v_cvt_pk_bf16_f32 v153, v82, v83
    v_cvt_pk_bf16_f32 v154, v84, v85
    v_cvt_pk_bf16_f32 v155, v86, v87
    v_accvgpr_read_b32 v88, a200
    v_accvgpr_read_b32 v89, a201
    v_accvgpr_read_b32 v90, a202
    v_accvgpr_read_b32 v91, a203
    v_accvgpr_read_b32 v92, a204
    v_accvgpr_read_b32 v93, a205
    v_accvgpr_read_b32 v94, a206
    v_accvgpr_read_b32 v95, a207
    v_mul_f32 v88, s34, v88
    v_mul_f32 v89, s34, v89
    v_mul_f32 v90, s34, v90
    v_mul_f32 v91, s34, v91
    v_mul_f32 v92, s34, v92
    v_mul_f32 v93, s34, v93
    v_mul_f32 v94, s34, v94
    v_mul_f32 v95, s34, v95
    v_cvt_pk_bf16_f32 v156, v88, v89
    v_cvt_pk_bf16_f32 v157, v90, v91
    v_cvt_pk_bf16_f32 v158, v92, v93
    v_cvt_pk_bf16_f32 v159, v94, v95
    v_accvgpr_read_b32 v64, a16
    v_accvgpr_read_b32 v65, a17
    v_accvgpr_read_b32 v66, a18
    v_accvgpr_read_b32 v67, a19
    v_accvgpr_read_b32 v68, a20
    v_accvgpr_read_b32 v69, a21
    v_accvgpr_read_b32 v70, a22
    v_accvgpr_read_b32 v71, a23
    v_mul_f32 v64, s34, v64
    v_mul_f32 v65, s34, v65
    v_mul_f32 v66, s34, v66
    v_mul_f32 v67, s34, v67
    v_mul_f32 v68, s34, v68
    v_mul_f32 v69, s34, v69
    v_mul_f32 v70, s34, v70
    v_mul_f32 v71, s34, v71
    v_cvt_pk_bf16_f32 v160, v64, v65
    v_cvt_pk_bf16_f32 v161, v66, v67
    v_cvt_pk_bf16_f32 v162, v68, v69
    v_cvt_pk_bf16_f32 v163, v70, v71
    v_accvgpr_read_b32 v72, a24
    v_accvgpr_read_b32 v73, a25
    v_accvgpr_read_b32 v74, a26
    v_accvgpr_read_b32 v75, a27
    v_accvgpr_read_b32 v76, a28
    v_accvgpr_read_b32 v77, a29
    v_accvgpr_read_b32 v78, a30
    v_accvgpr_read_b32 v79, a31
    v_mul_f32 v72, s34, v72
    v_mul_f32 v73, s34, v73
    v_mul_f32 v74, s34, v74
    v_mul_f32 v75, s34, v75
    v_mul_f32 v76, s34, v76
    v_mul_f32 v77, s34, v77
    v_mul_f32 v78, s34, v78
    v_mul_f32 v79, s34, v79
    v_cvt_pk_bf16_f32 v164, v72, v73
    v_cvt_pk_bf16_f32 v165, v74, v75
    v_cvt_pk_bf16_f32 v166, v76, v77
    v_cvt_pk_bf16_f32 v167, v78, v79
    v_accvgpr_read_b32 v80, a80
    v_accvgpr_read_b32 v81, a81
    v_accvgpr_read_b32 v82, a82
    v_accvgpr_read_b32 v83, a83
    v_accvgpr_read_b32 v84, a84
    v_accvgpr_read_b32 v85, a85
    v_accvgpr_read_b32 v86, a86
    v_accvgpr_read_b32 v87, a87
    v_mul_f32 v80, s34, v80
    v_mul_f32 v81, s34, v81
    v_mul_f32 v82, s34, v82
    v_mul_f32 v83, s34, v83
    v_mul_f32 v84, s34, v84
    v_mul_f32 v85, s34, v85
    v_mul_f32 v86, s34, v86
    v_mul_f32 v87, s34, v87
    v_cvt_pk_bf16_f32 v168, v80, v81
    v_cvt_pk_bf16_f32 v169, v82, v83
    v_cvt_pk_bf16_f32 v170, v84, v85
    v_cvt_pk_bf16_f32 v171, v86, v87
    v_accvgpr_read_b32 v88, a88
    v_accvgpr_read_b32 v89, a89
    v_accvgpr_read_b32 v90, a90
    v_accvgpr_read_b32 v91, a91
    v_accvgpr_read_b32 v92, a92
    v_accvgpr_read_b32 v93, a93
    v_accvgpr_read_b32 v94, a94
    v_accvgpr_read_b32 v95, a95
    v_mul_f32 v88, s34, v88
    v_mul_f32 v89, s34, v89
    v_mul_f32 v90, s34, v90
    v_mul_f32 v91, s34, v91
    v_mul_f32 v92, s34, v92
    v_mul_f32 v93, s34, v93
    v_mul_f32 v94, s34, v94
    v_mul_f32 v95, s34, v95
    v_cvt_pk_bf16_f32 v172, v88, v89
    v_cvt_pk_bf16_f32 v173, v90, v91
    v_cvt_pk_bf16_f32 v174, v92, v93
    v_cvt_pk_bf16_f32 v175, v94, v95
    v_accvgpr_read_b32 v64, a144
    v_accvgpr_read_b32 v65, a145
    v_accvgpr_read_b32 v66, a146
    v_accvgpr_read_b32 v67, a147
    v_accvgpr_read_b32 v68, a148
    v_accvgpr_read_b32 v69, a149
    v_accvgpr_read_b32 v70, a150
    v_accvgpr_read_b32 v71, a151
    v_mul_f32 v64, s34, v64
    v_mul_f32 v65, s34, v65
    v_mul_f32 v66, s34, v66
    v_mul_f32 v67, s34, v67
    v_mul_f32 v68, s34, v68
    v_mul_f32 v69, s34, v69
    v_mul_f32 v70, s34, v70
    v_mul_f32 v71, s34, v71
    v_cvt_pk_bf16_f32 v176, v64, v65
    v_cvt_pk_bf16_f32 v177, v66, v67
    v_cvt_pk_bf16_f32 v178, v68, v69
    v_cvt_pk_bf16_f32 v179, v70, v71
    v_accvgpr_read_b32 v72, a152
    v_accvgpr_read_b32 v73, a153
    v_accvgpr_read_b32 v74, a154
    v_accvgpr_read_b32 v75, a155
    v_accvgpr_read_b32 v76, a156
    v_accvgpr_read_b32 v77, a157
    v_accvgpr_read_b32 v78, a158
    v_accvgpr_read_b32 v79, a159
    v_mul_f32 v72, s34, v72
    v_mul_f32 v73, s34, v73
    v_mul_f32 v74, s34, v74
    v_mul_f32 v75, s34, v75
    v_mul_f32 v76, s34, v76
    v_mul_f32 v77, s34, v77
    v_mul_f32 v78, s34, v78
    v_mul_f32 v79, s34, v79
    v_cvt_pk_bf16_f32 v180, v72, v73
    v_cvt_pk_bf16_f32 v181, v74, v75
    v_cvt_pk_bf16_f32 v182, v76, v77
    v_cvt_pk_bf16_f32 v183, v78, v79
    v_accvgpr_read_b32 v80, a208
    v_accvgpr_read_b32 v81, a209
    v_accvgpr_read_b32 v82, a210
    v_accvgpr_read_b32 v83, a211
    v_accvgpr_read_b32 v84, a212
    v_accvgpr_read_b32 v85, a213
    v_accvgpr_read_b32 v86, a214
    v_accvgpr_read_b32 v87, a215
    v_mul_f32 v80, s34, v80
    v_mul_f32 v81, s34, v81
    v_mul_f32 v82, s34, v82
    v_mul_f32 v83, s34, v83
    v_mul_f32 v84, s34, v84
    v_mul_f32 v85, s34, v85
    v_mul_f32 v86, s34, v86
    v_mul_f32 v87, s34, v87
    v_cvt_pk_bf16_f32 v184, v80, v81
    v_cvt_pk_bf16_f32 v185, v82, v83
    v_cvt_pk_bf16_f32 v186, v84, v85
    v_cvt_pk_bf16_f32 v187, v86, v87
    v_accvgpr_read_b32 v88, a216
    v_accvgpr_read_b32 v89, a217
    v_accvgpr_read_b32 v90, a218
    v_accvgpr_read_b32 v91, a219
    v_accvgpr_read_b32 v92, a220
    v_accvgpr_read_b32 v93, a221
    v_accvgpr_read_b32 v94, a222
    v_accvgpr_read_b32 v95, a223
    v_mul_f32 v88, s34, v88
    v_mul_f32 v89, s34, v89
    v_mul_f32 v90, s34, v90
    v_mul_f32 v91, s34, v91
    v_mul_f32 v92, s34, v92
    v_mul_f32 v93, s34, v93
    v_mul_f32 v94, s34, v94
    v_mul_f32 v95, s34, v95
    v_cvt_pk_bf16_f32 v188, v88, v89
    v_cvt_pk_bf16_f32 v189, v90, v91
    v_cvt_pk_bf16_f32 v190, v92, v93
    v_cvt_pk_bf16_f32 v191, v94, v95
    v_accvgpr_read_b32 v64, a32
    v_accvgpr_read_b32 v65, a33
    v_accvgpr_read_b32 v66, a34
    v_accvgpr_read_b32 v67, a35
    v_accvgpr_read_b32 v68, a36
    v_accvgpr_read_b32 v69, a37
    v_accvgpr_read_b32 v70, a38
    v_accvgpr_read_b32 v71, a39
    v_mul_f32 v64, s34, v64
    v_mul_f32 v65, s34, v65
    v_mul_f32 v66, s34, v66
    v_mul_f32 v67, s34, v67
    v_mul_f32 v68, s34, v68
    v_mul_f32 v69, s34, v69
    v_mul_f32 v70, s34, v70
    v_mul_f32 v71, s34, v71
    v_cvt_pk_bf16_f32 v192, v64, v65
    v_cvt_pk_bf16_f32 v193, v66, v67
    v_cvt_pk_bf16_f32 v194, v68, v69
    v_cvt_pk_bf16_f32 v195, v70, v71
    v_accvgpr_read_b32 v72, a40
    v_accvgpr_read_b32 v73, a41
    v_accvgpr_read_b32 v74, a42
    v_accvgpr_read_b32 v75, a43
    v_accvgpr_read_b32 v76, a44
    v_accvgpr_read_b32 v77, a45
    v_accvgpr_read_b32 v78, a46
    v_accvgpr_read_b32 v79, a47
    v_mul_f32 v72, s34, v72
    v_mul_f32 v73, s34, v73
    v_mul_f32 v74, s34, v74
    v_mul_f32 v75, s34, v75
    v_mul_f32 v76, s34, v76
    v_mul_f32 v77, s34, v77
    v_mul_f32 v78, s34, v78
    v_mul_f32 v79, s34, v79
    v_cvt_pk_bf16_f32 v196, v72, v73
    v_cvt_pk_bf16_f32 v197, v74, v75
    v_cvt_pk_bf16_f32 v198, v76, v77
    v_cvt_pk_bf16_f32 v199, v78, v79
    v_accvgpr_read_b32 v80, a96
    v_accvgpr_read_b32 v81, a97
    v_accvgpr_read_b32 v82, a98
    v_accvgpr_read_b32 v83, a99
    v_accvgpr_read_b32 v84, a100
    v_accvgpr_read_b32 v85, a101
    v_accvgpr_read_b32 v86, a102
    v_accvgpr_read_b32 v87, a103
    v_mul_f32 v80, s34, v80
    v_mul_f32 v81, s34, v81
    v_mul_f32 v82, s34, v82
    v_mul_f32 v83, s34, v83
    v_mul_f32 v84, s34, v84
    v_mul_f32 v85, s34, v85
    v_mul_f32 v86, s34, v86
    v_mul_f32 v87, s34, v87
    v_cvt_pk_bf16_f32 v200, v80, v81
    v_cvt_pk_bf16_f32 v201, v82, v83
    v_cvt_pk_bf16_f32 v202, v84, v85
    v_cvt_pk_bf16_f32 v203, v86, v87
    v_accvgpr_read_b32 v88, a104
    v_accvgpr_read_b32 v89, a105
    v_accvgpr_read_b32 v90, a106
    v_accvgpr_read_b32 v91, a107
    v_accvgpr_read_b32 v92, a108
    v_accvgpr_read_b32 v93, a109
    v_accvgpr_read_b32 v94, a110
    v_accvgpr_read_b32 v95, a111
    v_mul_f32 v88, s34, v88
    v_mul_f32 v89, s34, v89
    v_mul_f32 v90, s34, v90
    v_mul_f32 v91, s34, v91
    v_mul_f32 v92, s34, v92
    v_mul_f32 v93, s34, v93
    v_mul_f32 v94, s34, v94
    v_mul_f32 v95, s34, v95
    v_cvt_pk_bf16_f32 v204, v88, v89
    v_cvt_pk_bf16_f32 v205, v90, v91
    v_cvt_pk_bf16_f32 v206, v92, v93
    v_cvt_pk_bf16_f32 v207, v94, v95
    v_accvgpr_read_b32 v64, a160
    v_accvgpr_read_b32 v65, a161
    v_accvgpr_read_b32 v66, a162
    v_accvgpr_read_b32 v67, a163
    v_accvgpr_read_b32 v68, a164
    v_accvgpr_read_b32 v69, a165
    v_accvgpr_read_b32 v70, a166
    v_accvgpr_read_b32 v71, a167
    v_mul_f32 v64, s34, v64
    v_mul_f32 v65, s34, v65
    v_mul_f32 v66, s34, v66
    v_mul_f32 v67, s34, v67
    v_mul_f32 v68, s34, v68
    v_mul_f32 v69, s34, v69
    v_mul_f32 v70, s34, v70
    v_mul_f32 v71, s34, v71
    v_cvt_pk_bf16_f32 v208, v64, v65
    v_cvt_pk_bf16_f32 v209, v66, v67
    v_cvt_pk_bf16_f32 v210, v68, v69
    v_cvt_pk_bf16_f32 v211, v70, v71
    v_accvgpr_read_b32 v72, a168
    v_accvgpr_read_b32 v73, a169
    v_accvgpr_read_b32 v74, a170
    v_accvgpr_read_b32 v75, a171
    v_accvgpr_read_b32 v76, a172
    v_accvgpr_read_b32 v77, a173
    v_accvgpr_read_b32 v78, a174
    v_accvgpr_read_b32 v79, a175
    v_mul_f32 v72, s34, v72
    v_mul_f32 v73, s34, v73
    v_mul_f32 v74, s34, v74
    v_mul_f32 v75, s34, v75
    v_mul_f32 v76, s34, v76
    v_mul_f32 v77, s34, v77
    v_mul_f32 v78, s34, v78
    v_mul_f32 v79, s34, v79
    v_cvt_pk_bf16_f32 v212, v72, v73
    v_cvt_pk_bf16_f32 v213, v74, v75
    v_cvt_pk_bf16_f32 v214, v76, v77
    v_cvt_pk_bf16_f32 v215, v78, v79
    v_accvgpr_read_b32 v80, a224
    v_accvgpr_read_b32 v81, a225
    v_accvgpr_read_b32 v82, a226
    v_accvgpr_read_b32 v83, a227
    v_accvgpr_read_b32 v84, a228
    v_accvgpr_read_b32 v85, a229
    v_accvgpr_read_b32 v86, a230
    v_accvgpr_read_b32 v87, a231
    v_mul_f32 v80, s34, v80
    v_mul_f32 v81, s34, v81
    v_mul_f32 v82, s34, v82
    v_mul_f32 v83, s34, v83
    v_mul_f32 v84, s34, v84
    v_mul_f32 v85, s34, v85
    v_mul_f32 v86, s34, v86
    v_mul_f32 v87, s34, v87
    v_cvt_pk_bf16_f32 v216, v80, v81
    v_cvt_pk_bf16_f32 v217, v82, v83
    v_cvt_pk_bf16_f32 v218, v84, v85
    v_cvt_pk_bf16_f32 v219, v86, v87
    v_accvgpr_read_b32 v88, a232
    v_accvgpr_read_b32 v89, a233
    v_accvgpr_read_b32 v90, a234
    v_accvgpr_read_b32 v91, a235
    v_accvgpr_read_b32 v92, a236
    v_accvgpr_read_b32 v93, a237
    v_accvgpr_read_b32 v94, a238
    v_accvgpr_read_b32 v95, a239
    v_mul_f32 v88, s34, v88
    v_mul_f32 v89, s34, v89
    v_mul_f32 v90, s34, v90
    v_mul_f32 v91, s34, v91
    v_mul_f32 v92, s34, v92
    v_mul_f32 v93, s34, v93
    v_mul_f32 v94, s34, v94
    v_mul_f32 v95, s34, v95
    v_cvt_pk_bf16_f32 v220, v88, v89
    v_cvt_pk_bf16_f32 v221, v90, v91
    v_cvt_pk_bf16_f32 v222, v92, v93
    v_cvt_pk_bf16_f32 v223, v94, v95
    v_accvgpr_read_b32 v64, a48
    v_accvgpr_read_b32 v65, a49
    v_accvgpr_read_b32 v66, a50
    v_accvgpr_read_b32 v67, a51
    v_accvgpr_read_b32 v68, a52
    v_accvgpr_read_b32 v69, a53
    v_accvgpr_read_b32 v70, a54
    v_accvgpr_read_b32 v71, a55
    v_mul_f32 v64, s34, v64
    v_mul_f32 v65, s34, v65
    v_mul_f32 v66, s34, v66
    v_mul_f32 v67, s34, v67
    v_mul_f32 v68, s34, v68
    v_mul_f32 v69, s34, v69
    v_mul_f32 v70, s34, v70
    v_mul_f32 v71, s34, v71
    v_cvt_pk_bf16_f32 v224, v64, v65
    v_cvt_pk_bf16_f32 v225, v66, v67
    v_cvt_pk_bf16_f32 v226, v68, v69
    v_cvt_pk_bf16_f32 v227, v70, v71
    v_accvgpr_read_b32 v72, a56
    v_accvgpr_read_b32 v73, a57
    v_accvgpr_read_b32 v74, a58
    v_accvgpr_read_b32 v75, a59
    v_accvgpr_read_b32 v76, a60
    v_accvgpr_read_b32 v77, a61
    v_accvgpr_read_b32 v78, a62
    v_accvgpr_read_b32 v79, a63
    v_mul_f32 v72, s34, v72
    v_mul_f32 v73, s34, v73
    v_mul_f32 v74, s34, v74
    v_mul_f32 v75, s34, v75
    v_mul_f32 v76, s34, v76
    v_mul_f32 v77, s34, v77
    v_mul_f32 v78, s34, v78
    v_mul_f32 v79, s34, v79
    v_cvt_pk_bf16_f32 v228, v72, v73
    v_cvt_pk_bf16_f32 v229, v74, v75
    v_cvt_pk_bf16_f32 v230, v76, v77
    v_cvt_pk_bf16_f32 v231, v78, v79
    v_accvgpr_read_b32 v80, a112
    v_accvgpr_read_b32 v81, a113
    v_accvgpr_read_b32 v82, a114
    v_accvgpr_read_b32 v83, a115
    v_accvgpr_read_b32 v84, a116
    v_accvgpr_read_b32 v85, a117
    v_accvgpr_read_b32 v86, a118
    v_accvgpr_read_b32 v87, a119
    v_mul_f32 v80, s34, v80
    v_mul_f32 v81, s34, v81
    v_mul_f32 v82, s34, v82
    v_mul_f32 v83, s34, v83
    v_mul_f32 v84, s34, v84
    v_mul_f32 v85, s34, v85
    v_mul_f32 v86, s34, v86
    v_mul_f32 v87, s34, v87
    v_cvt_pk_bf16_f32 v232, v80, v81
    v_cvt_pk_bf16_f32 v233, v82, v83
    v_cvt_pk_bf16_f32 v234, v84, v85
    v_cvt_pk_bf16_f32 v235, v86, v87
    v_accvgpr_read_b32 v88, a120
    v_accvgpr_read_b32 v89, a121
    v_accvgpr_read_b32 v90, a122
    v_accvgpr_read_b32 v91, a123
    v_accvgpr_read_b32 v92, a124
    v_accvgpr_read_b32 v93, a125
    v_accvgpr_read_b32 v94, a126
    v_accvgpr_read_b32 v95, a127
    v_mul_f32 v88, s34, v88
    v_mul_f32 v89, s34, v89
    v_mul_f32 v90, s34, v90
    v_mul_f32 v91, s34, v91
    v_mul_f32 v92, s34, v92
    v_mul_f32 v93, s34, v93
    v_mul_f32 v94, s34, v94
    v_mul_f32 v95, s34, v95
    v_cvt_pk_bf16_f32 v236, v88, v89
    v_cvt_pk_bf16_f32 v237, v90, v91
    v_cvt_pk_bf16_f32 v238, v92, v93
    v_cvt_pk_bf16_f32 v239, v94, v95
    v_accvgpr_read_b32 v64, a176
    v_accvgpr_read_b32 v65, a177
    v_accvgpr_read_b32 v66, a178
    v_accvgpr_read_b32 v67, a179
    v_accvgpr_read_b32 v68, a180
    v_accvgpr_read_b32 v69, a181
    v_accvgpr_read_b32 v70, a182
    v_accvgpr_read_b32 v71, a183
    v_mul_f32 v64, s34, v64
    v_mul_f32 v65, s34, v65
    v_mul_f32 v66, s34, v66
    v_mul_f32 v67, s34, v67
    v_mul_f32 v68, s34, v68
    v_mul_f32 v69, s34, v69
    v_mul_f32 v70, s34, v70
    v_mul_f32 v71, s34, v71
    v_cvt_pk_bf16_f32 v240, v64, v65
    v_cvt_pk_bf16_f32 v241, v66, v67
    v_cvt_pk_bf16_f32 v242, v68, v69
    v_cvt_pk_bf16_f32 v243, v70, v71
    v_accvgpr_read_b32 v72, a184
    v_accvgpr_read_b32 v73, a185
    v_accvgpr_read_b32 v74, a186
    v_accvgpr_read_b32 v75, a187
    v_accvgpr_read_b32 v76, a188
    v_accvgpr_read_b32 v77, a189
    v_accvgpr_read_b32 v78, a190
    v_accvgpr_read_b32 v79, a191
    v_mul_f32 v72, s34, v72
    v_mul_f32 v73, s34, v73
    v_mul_f32 v74, s34, v74
    v_mul_f32 v75, s34, v75
    v_mul_f32 v76, s34, v76
    v_mul_f32 v77, s34, v77
    v_mul_f32 v78, s34, v78
    v_mul_f32 v79, s34, v79
    v_cvt_pk_bf16_f32 v244, v72, v73
    v_cvt_pk_bf16_f32 v245, v74, v75
    v_cvt_pk_bf16_f32 v246, v76, v77
    v_cvt_pk_bf16_f32 v247, v78, v79
    v_accvgpr_read_b32 v80, a240
    v_accvgpr_read_b32 v81, a241
    v_accvgpr_read_b32 v82, a242
    v_accvgpr_read_b32 v83, a243
    v_accvgpr_read_b32 v84, a244
    v_accvgpr_read_b32 v85, a245
    v_accvgpr_read_b32 v86, a246
    v_accvgpr_read_b32 v87, a247
    v_mul_f32 v80, s34, v80
    v_mul_f32 v81, s34, v81
    v_mul_f32 v82, s34, v82
    v_mul_f32 v83, s34, v83
    v_mul_f32 v84, s34, v84
    v_mul_f32 v85, s34, v85
    v_mul_f32 v86, s34, v86
    v_mul_f32 v87, s34, v87
    v_cvt_pk_bf16_f32 v248, v80, v81
    v_cvt_pk_bf16_f32 v249, v82, v83
    v_cvt_pk_bf16_f32 v250, v84, v85
    v_cvt_pk_bf16_f32 v251, v86, v87
    v_accvgpr_read_b32 v88, a248
    v_accvgpr_read_b32 v89, a249
    v_accvgpr_read_b32 v90, a250
    v_accvgpr_read_b32 v91, a251
    v_accvgpr_read_b32 v92, a252
    v_accvgpr_read_b32 v93, a253
    v_accvgpr_read_b32 v94, a254
    v_accvgpr_read_b32 v95, a255
    v_mul_f32 v88, s34, v88
    v_mul_f32 v89, s34, v89
    v_mul_f32 v90, s34, v90
    v_mul_f32 v91, s34, v91
    v_mul_f32 v92, s34, v92
    v_mul_f32 v93, s34, v93
    v_mul_f32 v94, s34, v94
    v_mul_f32 v95, s34, v95
    v_cvt_pk_bf16_f32 v252, v88, v89
    v_cvt_pk_bf16_f32 v253, v90, v91
    v_cvt_pk_bf16_f32 v254, v92, v93
    v_cvt_pk_bf16_f32 v255, v94, v95
G_EPI_CD:
    s_cmp_eq_u32 s6, 2
    s_cbranch_scc1 G_EPI_NOW
    s_lshl_b32 s33, s6, 4
    s_add_u32 s33, s33, s24
    s_cmp_ge_u32 s33, 6
    s_cbranch_scc1 G_NEXT
G_EPI_NOW:
    s_or_b32 vcc_lo, s24, s6
    s_mov_b32 vcc_hi, 0
    buffer_store_dwordx4 v[128:131], v21, s[8:11], s47 offen offset:0 sc1
    s_cbranch_vccz EW_81
    s_waitcnt vmcnt(0)
EW_81:
    buffer_store_dwordx4 v[132:135], v21, s[8:11], s47 offen offset:1024 sc1
    s_cbranch_vccz EW_82
    s_waitcnt vmcnt(0)
EW_82:
    s_add_u32 s47, s47, 2048
    buffer_store_dwordx4 v[136:139], v21, s[8:11], s47 offen offset:0 sc1
    s_cbranch_vccz EW_83
    s_waitcnt vmcnt(0)
EW_83:
    buffer_store_dwordx4 v[140:143], v21, s[8:11], s47 offen offset:1024 sc1
    s_cbranch_vccz EW_84
    s_waitcnt vmcnt(0)
EW_84:
    s_add_u32 s47, s47, 2048
    buffer_store_dwordx4 v[144:147], v21, s[8:11], s47 offen offset:0 sc1
    s_cbranch_vccz EW_85
    s_waitcnt vmcnt(0)
EW_85:
    buffer_store_dwordx4 v[148:151], v21, s[8:11], s47 offen offset:1024 sc1
    s_cbranch_vccz EW_86
    s_waitcnt vmcnt(0)
EW_86:
    s_add_u32 s47, s47, 2048
    buffer_store_dwordx4 v[152:155], v21, s[8:11], s47 offen offset:0 sc1
    s_cbranch_vccz EW_87
    s_waitcnt vmcnt(0)
EW_87:
    buffer_store_dwordx4 v[156:159], v21, s[8:11], s47 offen offset:1024 sc1
    s_cbranch_vccz EW_88
    s_waitcnt vmcnt(0)
EW_88:
    s_add_u32 s47, s47, 518144
    buffer_store_dwordx4 v[160:163], v21, s[8:11], s47 offen offset:0 sc1
    s_cbranch_vccz EW_89
    s_waitcnt vmcnt(0)
EW_89:
    buffer_store_dwordx4 v[164:167], v21, s[8:11], s47 offen offset:1024 sc1
    s_cbranch_vccz EW_90
    s_waitcnt vmcnt(0)
EW_90:
    s_add_u32 s47, s47, 2048
    buffer_store_dwordx4 v[168:171], v21, s[8:11], s47 offen offset:0 sc1
    s_cbranch_vccz EW_91
    s_waitcnt vmcnt(0)
EW_91:
    buffer_store_dwordx4 v[172:175], v21, s[8:11], s47 offen offset:1024 sc1
    s_cbranch_vccz EW_92
    s_waitcnt vmcnt(0)
EW_92:
    s_add_u32 s47, s47, 2048
    buffer_store_dwordx4 v[176:179], v21, s[8:11], s47 offen offset:0 sc1
    s_cbranch_vccz EW_93
    s_waitcnt vmcnt(0)
EW_93:
    buffer_store_dwordx4 v[180:183], v21, s[8:11], s47 offen offset:1024 sc1
    s_cbranch_vccz EW_94
    s_waitcnt vmcnt(0)
EW_94:
    s_add_u32 s47, s47, 2048
    buffer_store_dwordx4 v[184:187], v21, s[8:11], s47 offen offset:0 sc1
    s_cbranch_vccz EW_95
    s_waitcnt vmcnt(0)
EW_95:
    buffer_store_dwordx4 v[188:191], v21, s[8:11], s47 offen offset:1024 sc1
    s_cbranch_vccz EW_96
    s_waitcnt vmcnt(0)
EW_96:
    s_add_u32 s47, s47, 518144
    s_cmp_eq_u32 s43, 1
    s_cbranch_scc1 G_EPI_ND
    buffer_store_dwordx4 v[192:195], v21, s[8:11], s47 offen offset:0 sc1
    s_cbranch_vccz EW_97
    s_waitcnt vmcnt(0)
EW_97:
    buffer_store_dwordx4 v[196:199], v21, s[8:11], s47 offen offset:1024 sc1
    s_cbranch_vccz EW_98
    s_waitcnt vmcnt(0)
EW_98:
    s_add_u32 s47, s47, 2048
    buffer_store_dwordx4 v[200:203], v21, s[8:11], s47 offen offset:0 sc1
    s_cbranch_vccz EW_99
    s_waitcnt vmcnt(0)
EW_99:
    buffer_store_dwordx4 v[204:207], v21, s[8:11], s47 offen offset:1024 sc1
    s_cbranch_vccz EW_100
    s_waitcnt vmcnt(0)
EW_100:
    s_add_u32 s47, s47, 2048
    buffer_store_dwordx4 v[208:211], v21, s[8:11], s47 offen offset:0 sc1
    s_cbranch_vccz EW_101
    s_waitcnt vmcnt(0)
EW_101:
    buffer_store_dwordx4 v[212:215], v21, s[8:11], s47 offen offset:1024 sc1
    s_cbranch_vccz EW_102
    s_waitcnt vmcnt(0)
EW_102:
    s_add_u32 s47, s47, 2048
    buffer_store_dwordx4 v[216:219], v21, s[8:11], s47 offen offset:0 sc1
    s_cbranch_vccz EW_103
    s_waitcnt vmcnt(0)
EW_103:
    buffer_store_dwordx4 v[220:223], v21, s[8:11], s47 offen offset:1024 sc1
    s_cbranch_vccz EW_104
    s_waitcnt vmcnt(0)
EW_104:
    s_add_u32 s47, s47, 518144
    buffer_store_dwordx4 v[224:227], v21, s[8:11], s47 offen offset:0 sc1
    s_cbranch_vccz EW_105
    s_waitcnt vmcnt(0)
EW_105:
    buffer_store_dwordx4 v[228:231], v21, s[8:11], s47 offen offset:1024 sc1
    s_cbranch_vccz EW_106
    s_waitcnt vmcnt(0)
EW_106:
    s_add_u32 s47, s47, 2048
    buffer_store_dwordx4 v[232:235], v21, s[8:11], s47 offen offset:0 sc1
    s_cbranch_vccz EW_107
    s_waitcnt vmcnt(0)
EW_107:
    buffer_store_dwordx4 v[236:239], v21, s[8:11], s47 offen offset:1024 sc1
    s_cbranch_vccz EW_108
    s_waitcnt vmcnt(0)
EW_108:
    s_add_u32 s47, s47, 2048
    buffer_store_dwordx4 v[240:243], v21, s[8:11], s47 offen offset:0 sc1
    s_cbranch_vccz EW_109
    s_waitcnt vmcnt(0)
EW_109:
    buffer_store_dwordx4 v[244:247], v21, s[8:11], s47 offen offset:1024 sc1
    s_cbranch_vccz EW_110
    s_waitcnt vmcnt(0)
EW_110:
    s_add_u32 s47, s47, 2048
    buffer_store_dwordx4 v[248:251], v21, s[8:11], s47 offen offset:0 sc1
    s_cbranch_vccz EW_111
    s_waitcnt vmcnt(0)
EW_111:
    buffer_store_dwordx4 v[252:255], v21, s[8:11], s47 offen offset:1024 sc1
    s_cbranch_vccz EW_112
    s_waitcnt vmcnt(0)
EW_112:
    s_add_u32 s47, s47, 518144
G_EPI_ND:
    s_mov_b32 s46, 0
    s_waitcnt vmcnt(0)
    s_barrier
    s_cmp_eq_u32 s48, 0
    s_cbranch_scc1 G_NEXT
    buffer_store_dword v25, v24, s[8:11], s48 offen sc1
    s_mov_b32 s48, 0
    s_branch G_NEXT
G_EPI_FFN:
    s_cmp_ge_u32 s27, 54
    s_cbranch_scc1 G_NEXT
    v_accvgpr_read_b32 v64, a0
    v_accvgpr_read_b32 v65, a1
    v_accvgpr_read_b32 v66, a2
    v_accvgpr_read_b32 v67, a3
    v_accvgpr_read_b32 v68, a4
    v_accvgpr_read_b32 v69, a5
    v_accvgpr_read_b32 v70, a6
    v_accvgpr_read_b32 v71, a7
    v_accvgpr_read_b32 v72, a128
    v_accvgpr_read_b32 v73, a129
    v_accvgpr_read_b32 v74, a130
    v_accvgpr_read_b32 v75, a131
    v_accvgpr_read_b32 v76, a132
    v_accvgpr_read_b32 v77, a133
    v_accvgpr_read_b32 v78, a134
    v_accvgpr_read_b32 v79, a135
    v_mul_f32 v64, v64, v72
    v_mul_f32 v65, v65, v73
    v_mul_f32 v66, v66, v74
    v_mul_f32 v67, v67, v75
    v_mul_f32 v68, v68, v76
    v_mul_f32 v69, v69, v77
    v_mul_f32 v70, v70, v78
    v_mul_f32 v71, v71, v79
    v_cvt_pk_bf16_f32 v80, v64, v65
    v_cvt_pk_bf16_f32 v81, v66, v67
    v_cvt_pk_bf16_f32 v82, v68, v69
    v_cvt_pk_bf16_f32 v83, v70, v71
    buffer_store_dwordx4 v[80:83], v21, s[8:11], s28 offen offset:0 sc1
    s_waitcnt vmcnt(0)
    v_accvgpr_read_b32 v84, a8
    v_accvgpr_read_b32 v85, a9
    v_accvgpr_read_b32 v86, a10
    v_accvgpr_read_b32 v87, a11
    v_accvgpr_read_b32 v88, a12
    v_accvgpr_read_b32 v89, a13
    v_accvgpr_read_b32 v90, a14
    v_accvgpr_read_b32 v91, a15
    v_accvgpr_read_b32 v92, a136
    v_accvgpr_read_b32 v93, a137
    v_accvgpr_read_b32 v94, a138
    v_accvgpr_read_b32 v95, a139
    v_accvgpr_read_b32 v96, a140
    v_accvgpr_read_b32 v97, a141
    v_accvgpr_read_b32 v98, a142
    v_accvgpr_read_b32 v99, a143
    v_mul_f32 v84, v84, v92
    v_mul_f32 v85, v85, v93
    v_mul_f32 v86, v86, v94
    v_mul_f32 v87, v87, v95
    v_mul_f32 v88, v88, v96
    v_mul_f32 v89, v89, v97
    v_mul_f32 v90, v90, v98
    v_mul_f32 v91, v91, v99
    v_cvt_pk_bf16_f32 v100, v84, v85
    v_cvt_pk_bf16_f32 v101, v86, v87
    v_cvt_pk_bf16_f32 v102, v88, v89
    v_cvt_pk_bf16_f32 v103, v90, v91
    buffer_store_dwordx4 v[100:103], v21, s[8:11], s28 offen offset:1024 sc1
    s_waitcnt vmcnt(0)
    v_accvgpr_read_b32 v104, a64
    v_accvgpr_read_b32 v105, a65
    v_accvgpr_read_b32 v106, a66
    v_accvgpr_read_b32 v107, a67
    v_accvgpr_read_b32 v108, a68
    v_accvgpr_read_b32 v109, a69
    v_accvgpr_read_b32 v110, a70
    v_accvgpr_read_b32 v111, a71
    v_accvgpr_read_b32 v112, a192
    v_accvgpr_read_b32 v113, a193
    v_accvgpr_read_b32 v114, a194
    v_accvgpr_read_b32 v115, a195
    v_accvgpr_read_b32 v116, a196
    v_accvgpr_read_b32 v117, a197
    v_accvgpr_read_b32 v118, a198
    v_accvgpr_read_b32 v119, a199
    v_mul_f32 v104, v104, v112
    v_mul_f32 v105, v105, v113
    v_mul_f32 v106, v106, v114
    v_mul_f32 v107, v107, v115
    v_mul_f32 v108, v108, v116
    v_mul_f32 v109, v109, v117
    v_mul_f32 v110, v110, v118
    v_mul_f32 v111, v111, v119
    v_cvt_pk_bf16_f32 v120, v104, v105
    v_cvt_pk_bf16_f32 v121, v106, v107
    v_cvt_pk_bf16_f32 v122, v108, v109
    v_cvt_pk_bf16_f32 v123, v110, v111
    buffer_store_dwordx4 v[120:123], v21, s[8:11], s28 offen offset:2048 sc1
    s_waitcnt vmcnt(0)
    v_accvgpr_read_b32 v124, a72
    v_accvgpr_read_b32 v125, a73
    v_accvgpr_read_b32 v126, a74
    v_accvgpr_read_b32 v127, a75
    v_accvgpr_read_b32 v128, a76
    v_accvgpr_read_b32 v129, a77
    v_accvgpr_read_b32 v130, a78
    v_accvgpr_read_b32 v131, a79
    v_accvgpr_read_b32 v132, a200
    v_accvgpr_read_b32 v133, a201
    v_accvgpr_read_b32 v134, a202
    v_accvgpr_read_b32 v135, a203
    v_accvgpr_read_b32 v136, a204
    v_accvgpr_read_b32 v137, a205
    v_accvgpr_read_b32 v138, a206
    v_accvgpr_read_b32 v139, a207
    v_mul_f32 v124, v124, v132
    v_mul_f32 v125, v125, v133
    v_mul_f32 v126, v126, v134
    v_mul_f32 v127, v127, v135
    v_mul_f32 v128, v128, v136
    v_mul_f32 v129, v129, v137
    v_mul_f32 v130, v130, v138
    v_mul_f32 v131, v131, v139
    v_cvt_pk_bf16_f32 v140, v124, v125
    v_cvt_pk_bf16_f32 v141, v126, v127
    v_cvt_pk_bf16_f32 v142, v128, v129
    v_cvt_pk_bf16_f32 v143, v130, v131
    buffer_store_dwordx4 v[140:143], v21, s[8:11], s28 offen offset:3072 sc1
    s_waitcnt vmcnt(0)
    s_add_u32 s28, s28, 110592
    v_accvgpr_read_b32 v144, a16
    v_accvgpr_read_b32 v145, a17
    v_accvgpr_read_b32 v146, a18
    v_accvgpr_read_b32 v147, a19
    v_accvgpr_read_b32 v148, a20
    v_accvgpr_read_b32 v149, a21
    v_accvgpr_read_b32 v150, a22
    v_accvgpr_read_b32 v151, a23
    v_accvgpr_read_b32 v152, a144
    v_accvgpr_read_b32 v153, a145
    v_accvgpr_read_b32 v154, a146
    v_accvgpr_read_b32 v155, a147
    v_accvgpr_read_b32 v156, a148
    v_accvgpr_read_b32 v157, a149
    v_accvgpr_read_b32 v158, a150
    v_accvgpr_read_b32 v159, a151
    v_mul_f32 v144, v144, v152
    v_mul_f32 v145, v145, v153
    v_mul_f32 v146, v146, v154
    v_mul_f32 v147, v147, v155
    v_mul_f32 v148, v148, v156
    v_mul_f32 v149, v149, v157
    v_mul_f32 v150, v150, v158
    v_mul_f32 v151, v151, v159
    v_cvt_pk_bf16_f32 v160, v144, v145
    v_cvt_pk_bf16_f32 v161, v146, v147
    v_cvt_pk_bf16_f32 v162, v148, v149
    v_cvt_pk_bf16_f32 v163, v150, v151
    buffer_store_dwordx4 v[160:163], v21, s[8:11], s28 offen offset:0 sc1
    s_waitcnt vmcnt(0)
    v_accvgpr_read_b32 v164, a24
    v_accvgpr_read_b32 v165, a25
    v_accvgpr_read_b32 v166, a26
    v_accvgpr_read_b32 v167, a27
    v_accvgpr_read_b32 v168, a28
    v_accvgpr_read_b32 v169, a29
    v_accvgpr_read_b32 v170, a30
    v_accvgpr_read_b32 v171, a31
    v_accvgpr_read_b32 v172, a152
    v_accvgpr_read_b32 v173, a153
    v_accvgpr_read_b32 v174, a154
    v_accvgpr_read_b32 v175, a155
    v_accvgpr_read_b32 v176, a156
    v_accvgpr_read_b32 v177, a157
    v_accvgpr_read_b32 v178, a158
    v_accvgpr_read_b32 v179, a159
    v_mul_f32 v164, v164, v172
    v_mul_f32 v165, v165, v173
    v_mul_f32 v166, v166, v174
    v_mul_f32 v167, v167, v175
    v_mul_f32 v168, v168, v176
    v_mul_f32 v169, v169, v177
    v_mul_f32 v170, v170, v178
    v_mul_f32 v171, v171, v179
    v_cvt_pk_bf16_f32 v180, v164, v165
    v_cvt_pk_bf16_f32 v181, v166, v167
    v_cvt_pk_bf16_f32 v182, v168, v169
    v_cvt_pk_bf16_f32 v183, v170, v171
    buffer_store_dwordx4 v[180:183], v21, s[8:11], s28 offen offset:1024 sc1
    s_waitcnt vmcnt(0)
    v_accvgpr_read_b32 v184, a80
    v_accvgpr_read_b32 v185, a81
    v_accvgpr_read_b32 v186, a82
    v_accvgpr_read_b32 v187, a83
    v_accvgpr_read_b32 v188, a84
    v_accvgpr_read_b32 v189, a85
    v_accvgpr_read_b32 v190, a86
    v_accvgpr_read_b32 v191, a87
    v_accvgpr_read_b32 v192, a208
    v_accvgpr_read_b32 v193, a209
    v_accvgpr_read_b32 v194, a210
    v_accvgpr_read_b32 v195, a211
    v_accvgpr_read_b32 v196, a212
    v_accvgpr_read_b32 v197, a213
    v_accvgpr_read_b32 v198, a214
    v_accvgpr_read_b32 v199, a215
    v_mul_f32 v184, v184, v192
    v_mul_f32 v185, v185, v193
    v_mul_f32 v186, v186, v194
    v_mul_f32 v187, v187, v195
    v_mul_f32 v188, v188, v196
    v_mul_f32 v189, v189, v197
    v_mul_f32 v190, v190, v198
    v_mul_f32 v191, v191, v199
    v_cvt_pk_bf16_f32 v200, v184, v185
    v_cvt_pk_bf16_f32 v201, v186, v187
    v_cvt_pk_bf16_f32 v202, v188, v189
    v_cvt_pk_bf16_f32 v203, v190, v191
    buffer_store_dwordx4 v[200:203], v21, s[8:11], s28 offen offset:2048 sc1
    s_waitcnt vmcnt(0)
    v_accvgpr_read_b32 v204, a88
    v_accvgpr_read_b32 v205, a89
    v_accvgpr_read_b32 v206, a90
    v_accvgpr_read_b32 v207, a91
    v_accvgpr_read_b32 v208, a92
    v_accvgpr_read_b32 v209, a93
    v_accvgpr_read_b32 v210, a94
    v_accvgpr_read_b32 v211, a95
    v_accvgpr_read_b32 v212, a216
    v_accvgpr_read_b32 v213, a217
    v_accvgpr_read_b32 v214, a218
    v_accvgpr_read_b32 v215, a219
    v_accvgpr_read_b32 v216, a220
    v_accvgpr_read_b32 v217, a221
    v_accvgpr_read_b32 v218, a222
    v_accvgpr_read_b32 v219, a223
    v_mul_f32 v204, v204, v212
    v_mul_f32 v205, v205, v213
    v_mul_f32 v206, v206, v214
    v_mul_f32 v207, v207, v215
    v_mul_f32 v208, v208, v216
    v_mul_f32 v209, v209, v217
    v_mul_f32 v210, v210, v218
    v_mul_f32 v211, v211, v219
    v_cvt_pk_bf16_f32 v220, v204, v205
    v_cvt_pk_bf16_f32 v221, v206, v207
    v_cvt_pk_bf16_f32 v222, v208, v209
    v_cvt_pk_bf16_f32 v223, v210, v211
    buffer_store_dwordx4 v[220:223], v21, s[8:11], s28 offen offset:3072 sc1
    s_waitcnt vmcnt(0)
    s_add_u32 s28, s28, 110592
    s_cmp_eq_u32 s43, 1
    s_cbranch_scc1 G_NEXT
    v_accvgpr_read_b32 v64, a32
    v_accvgpr_read_b32 v65, a33
    v_accvgpr_read_b32 v66, a34
    v_accvgpr_read_b32 v67, a35
    v_accvgpr_read_b32 v68, a36
    v_accvgpr_read_b32 v69, a37
    v_accvgpr_read_b32 v70, a38
    v_accvgpr_read_b32 v71, a39
    v_accvgpr_read_b32 v72, a160
    v_accvgpr_read_b32 v73, a161
    v_accvgpr_read_b32 v74, a162
    v_accvgpr_read_b32 v75, a163
    v_accvgpr_read_b32 v76, a164
    v_accvgpr_read_b32 v77, a165
    v_accvgpr_read_b32 v78, a166
    v_accvgpr_read_b32 v79, a167
    v_mul_f32 v64, v64, v72
    v_mul_f32 v65, v65, v73
    v_mul_f32 v66, v66, v74
    v_mul_f32 v67, v67, v75
    v_mul_f32 v68, v68, v76
    v_mul_f32 v69, v69, v77
    v_mul_f32 v70, v70, v78
    v_mul_f32 v71, v71, v79
    v_cvt_pk_bf16_f32 v80, v64, v65
    v_cvt_pk_bf16_f32 v81, v66, v67
    v_cvt_pk_bf16_f32 v82, v68, v69
    v_cvt_pk_bf16_f32 v83, v70, v71
    buffer_store_dwordx4 v[80:83], v21, s[8:11], s28 offen offset:0 sc1
    s_waitcnt vmcnt(0)
    v_accvgpr_read_b32 v84, a40
    v_accvgpr_read_b32 v85, a41
    v_accvgpr_read_b32 v86, a42
    v_accvgpr_read_b32 v87, a43
    v_accvgpr_read_b32 v88, a44
    v_accvgpr_read_b32 v89, a45
    v_accvgpr_read_b32 v90, a46
    v_accvgpr_read_b32 v91, a47
    v_accvgpr_read_b32 v92, a168
    v_accvgpr_read_b32 v93, a169
    v_accvgpr_read_b32 v94, a170
    v_accvgpr_read_b32 v95, a171
    v_accvgpr_read_b32 v96, a172
    v_accvgpr_read_b32 v97, a173
    v_accvgpr_read_b32 v98, a174
    v_accvgpr_read_b32 v99, a175
    v_mul_f32 v84, v84, v92
    v_mul_f32 v85, v85, v93
    v_mul_f32 v86, v86, v94
    v_mul_f32 v87, v87, v95
    v_mul_f32 v88, v88, v96
    v_mul_f32 v89, v89, v97
    v_mul_f32 v90, v90, v98
    v_mul_f32 v91, v91, v99
    v_cvt_pk_bf16_f32 v100, v84, v85
    v_cvt_pk_bf16_f32 v101, v86, v87
    v_cvt_pk_bf16_f32 v102, v88, v89
    v_cvt_pk_bf16_f32 v103, v90, v91
    buffer_store_dwordx4 v[100:103], v21, s[8:11], s28 offen offset:1024 sc1
    s_waitcnt vmcnt(0)
    v_accvgpr_read_b32 v104, a96
    v_accvgpr_read_b32 v105, a97
    v_accvgpr_read_b32 v106, a98
    v_accvgpr_read_b32 v107, a99
    v_accvgpr_read_b32 v108, a100
    v_accvgpr_read_b32 v109, a101
    v_accvgpr_read_b32 v110, a102
    v_accvgpr_read_b32 v111, a103
    v_accvgpr_read_b32 v112, a224
    v_accvgpr_read_b32 v113, a225
    v_accvgpr_read_b32 v114, a226
    v_accvgpr_read_b32 v115, a227
    v_accvgpr_read_b32 v116, a228
    v_accvgpr_read_b32 v117, a229
    v_accvgpr_read_b32 v118, a230
    v_accvgpr_read_b32 v119, a231
    v_mul_f32 v104, v104, v112
    v_mul_f32 v105, v105, v113
    v_mul_f32 v106, v106, v114
    v_mul_f32 v107, v107, v115
    v_mul_f32 v108, v108, v116
    v_mul_f32 v109, v109, v117
    v_mul_f32 v110, v110, v118
    v_mul_f32 v111, v111, v119
    v_cvt_pk_bf16_f32 v120, v104, v105
    v_cvt_pk_bf16_f32 v121, v106, v107
    v_cvt_pk_bf16_f32 v122, v108, v109
    v_cvt_pk_bf16_f32 v123, v110, v111
    buffer_store_dwordx4 v[120:123], v21, s[8:11], s28 offen offset:2048 sc1
    s_waitcnt vmcnt(0)
    v_accvgpr_read_b32 v124, a104
    v_accvgpr_read_b32 v125, a105
    v_accvgpr_read_b32 v126, a106
    v_accvgpr_read_b32 v127, a107
    v_accvgpr_read_b32 v128, a108
    v_accvgpr_read_b32 v129, a109
    v_accvgpr_read_b32 v130, a110
    v_accvgpr_read_b32 v131, a111
    v_accvgpr_read_b32 v132, a232
    v_accvgpr_read_b32 v133, a233
    v_accvgpr_read_b32 v134, a234
    v_accvgpr_read_b32 v135, a235
    v_accvgpr_read_b32 v136, a236
    v_accvgpr_read_b32 v137, a237
    v_accvgpr_read_b32 v138, a238
    v_accvgpr_read_b32 v139, a239
    v_mul_f32 v124, v124, v132
    v_mul_f32 v125, v125, v133
    v_mul_f32 v126, v126, v134
    v_mul_f32 v127, v127, v135
    v_mul_f32 v128, v128, v136
    v_mul_f32 v129, v129, v137
    v_mul_f32 v130, v130, v138
    v_mul_f32 v131, v131, v139
    v_cvt_pk_bf16_f32 v140, v124, v125
    v_cvt_pk_bf16_f32 v141, v126, v127
    v_cvt_pk_bf16_f32 v142, v128, v129
    v_cvt_pk_bf16_f32 v143, v130, v131
    buffer_store_dwordx4 v[140:143], v21, s[8:11], s28 offen offset:3072 sc1
    s_waitcnt vmcnt(0)
    s_add_u32 s28, s28, 110592
    v_accvgpr_read_b32 v144, a48
    v_accvgpr_read_b32 v145, a49
    v_accvgpr_read_b32 v146, a50
    v_accvgpr_read_b32 v147, a51
    v_accvgpr_read_b32 v148, a52
    v_accvgpr_read_b32 v149, a53
    v_accvgpr_read_b32 v150, a54
    v_accvgpr_read_b32 v151, a55
    v_accvgpr_read_b32 v152, a176
    v_accvgpr_read_b32 v153, a177
    v_accvgpr_read_b32 v154, a178
    v_accvgpr_read_b32 v155, a179
    v_accvgpr_read_b32 v156, a180
    v_accvgpr_read_b32 v157, a181
    v_accvgpr_read_b32 v158, a182
    v_accvgpr_read_b32 v159, a183
    v_mul_f32 v144, v144, v152
    v_mul_f32 v145, v145, v153
    v_mul_f32 v146, v146, v154
    v_mul_f32 v147, v147, v155
    v_mul_f32 v148, v148, v156
    v_mul_f32 v149, v149, v157
    v_mul_f32 v150, v150, v158
    v_mul_f32 v151, v151, v159
    v_cvt_pk_bf16_f32 v160, v144, v145
    v_cvt_pk_bf16_f32 v161, v146, v147
    v_cvt_pk_bf16_f32 v162, v148, v149
    v_cvt_pk_bf16_f32 v163, v150, v151
    buffer_store_dwordx4 v[160:163], v21, s[8:11], s28 offen offset:0 sc1
    s_waitcnt vmcnt(0)
    v_accvgpr_read_b32 v164, a56
    v_accvgpr_read_b32 v165, a57
    v_accvgpr_read_b32 v166, a58
    v_accvgpr_read_b32 v167, a59
    v_accvgpr_read_b32 v168, a60
    v_accvgpr_read_b32 v169, a61
    v_accvgpr_read_b32 v170, a62
    v_accvgpr_read_b32 v171, a63
    v_accvgpr_read_b32 v172, a184
    v_accvgpr_read_b32 v173, a185
    v_accvgpr_read_b32 v174, a186
    v_accvgpr_read_b32 v175, a187
    v_accvgpr_read_b32 v176, a188
    v_accvgpr_read_b32 v177, a189
    v_accvgpr_read_b32 v178, a190
    v_accvgpr_read_b32 v179, a191
    v_mul_f32 v164, v164, v172
    v_mul_f32 v165, v165, v173
    v_mul_f32 v166, v166, v174
    v_mul_f32 v167, v167, v175
    v_mul_f32 v168, v168, v176
    v_mul_f32 v169, v169, v177
    v_mul_f32 v170, v170, v178
    v_mul_f32 v171, v171, v179
    v_cvt_pk_bf16_f32 v180, v164, v165
    v_cvt_pk_bf16_f32 v181, v166, v167
    v_cvt_pk_bf16_f32 v182, v168, v169
    v_cvt_pk_bf16_f32 v183, v170, v171
    buffer_store_dwordx4 v[180:183], v21, s[8:11], s28 offen offset:1024 sc1
    s_waitcnt vmcnt(0)
    v_accvgpr_read_b32 v184, a112
    v_accvgpr_read_b32 v185, a113
    v_accvgpr_read_b32 v186, a114
    v_accvgpr_read_b32 v187, a115
    v_accvgpr_read_b32 v188, a116
    v_accvgpr_read_b32 v189, a117
    v_accvgpr_read_b32 v190, a118
    v_accvgpr_read_b32 v191, a119
    v_accvgpr_read_b32 v192, a240
    v_accvgpr_read_b32 v193, a241
    v_accvgpr_read_b32 v194, a242
    v_accvgpr_read_b32 v195, a243
    v_accvgpr_read_b32 v196, a244
    v_accvgpr_read_b32 v197, a245
    v_accvgpr_read_b32 v198, a246
    v_accvgpr_read_b32 v199, a247
    v_mul_f32 v184, v184, v192
    v_mul_f32 v185, v185, v193
    v_mul_f32 v186, v186, v194
    v_mul_f32 v187, v187, v195
    v_mul_f32 v188, v188, v196
    v_mul_f32 v189, v189, v197
    v_mul_f32 v190, v190, v198
    v_mul_f32 v191, v191, v199
    v_cvt_pk_bf16_f32 v200, v184, v185
    v_cvt_pk_bf16_f32 v201, v186, v187
    v_cvt_pk_bf16_f32 v202, v188, v189
    v_cvt_pk_bf16_f32 v203, v190, v191
    buffer_store_dwordx4 v[200:203], v21, s[8:11], s28 offen offset:2048 sc1
    s_waitcnt vmcnt(0)
    v_accvgpr_read_b32 v204, a120
    v_accvgpr_read_b32 v205, a121
    v_accvgpr_read_b32 v206, a122
    v_accvgpr_read_b32 v207, a123
    v_accvgpr_read_b32 v208, a124
    v_accvgpr_read_b32 v209, a125
    v_accvgpr_read_b32 v210, a126
    v_accvgpr_read_b32 v211, a127
    v_accvgpr_read_b32 v212, a248
    v_accvgpr_read_b32 v213, a249
    v_accvgpr_read_b32 v214, a250
    v_accvgpr_read_b32 v215, a251
    v_accvgpr_read_b32 v216, a252
    v_accvgpr_read_b32 v217, a253
    v_accvgpr_read_b32 v218, a254
    v_accvgpr_read_b32 v219, a255
    v_mul_f32 v204, v204, v212
    v_mul_f32 v205, v205, v213
    v_mul_f32 v206, v206, v214
    v_mul_f32 v207, v207, v215
    v_mul_f32 v208, v208, v216
    v_mul_f32 v209, v209, v217
    v_mul_f32 v210, v210, v218
    v_mul_f32 v211, v211, v219
    v_cvt_pk_bf16_f32 v220, v204, v205
    v_cvt_pk_bf16_f32 v221, v206, v207
    v_cvt_pk_bf16_f32 v222, v208, v209
    v_cvt_pk_bf16_f32 v223, v210, v211
    buffer_store_dwordx4 v[220:223], v21, s[8:11], s28 offen offset:3072 sc1
    s_waitcnt vmcnt(0)
    s_add_u32 s28, s28, 110592
G_NEXT:
    s_waitcnt vmcnt(0)
    s_add_u32 s6, s6, 1
    s_cmp_lt_u32 s6, 4
    s_cbranch_scc1 G_ROUND
G_END:
    s_cmp_ge_u32 s7, 128
    s_cbranch_scc1 G_GATE_END
    s_load_dwordx2 s[36:37], s[0:1], 88
    s_waitcnt lgkmcnt(0)
    s_mov_b32 s20, s36
    s_and_b32 s21, s37, 0xffff
    s_mov_b32 s22, 0x500
    s_mov_b32 s23, 0x20000
    v_lshrrev_b32 v18, 4, v0
    s_lshl_b32 s33, s7, 4
    v_add_u32 v18, s33, v18
    v_and_b32 v19, 15, v0
    v_lshlrev_b32 v19, 4, v19
    v_mul_u32_u24 v20, 1280, v18
    v_add_u32 v20, v20, v19
    buffer_load_dwordx4 v[64:67], v20, s[16:19], 0 offen offset:0
    buffer_load_dwordx4 v[96:99], v19, s[20:23], 0 offen offset:0
    buffer_load_dwordx4 v[68:71], v20, s[16:19], 0 offen offset:256
    buffer_load_dwordx4 v[100:103], v19, s[20:23], 0 offen offset:256
    buffer_load_dwordx4 v[72:75], v20, s[16:19], 0 offen offset:512
    buffer_load_dwordx4 v[104:107], v19, s[20:23], 0 offen offset:512
    buffer_load_dwordx4 v[76:79], v20, s[16:19], 0 offen offset:768
    buffer_load_dwordx4 v[108:111], v19, s[20:23], 0 offen offset:768
    buffer_load_dwordx4 v[80:83], v20, s[16:19], 0 offen offset:1024
    buffer_load_dwordx4 v[112:115], v19, s[20:23], 0 offen offset:1024
    v_mov_b32 v60, 0
    v_mov_b32 v61, 0
    s_waitcnt vmcnt(0)
    v_lshlrev_b32 v56, 16, v64
    v_lshlrev_b32 v57, 16, v96
    v_and_b32 v58, 0xffff0000, v64
    v_and_b32 v59, 0xffff0000, v96
    v_fmac_f32 v60, v56, v57
    v_fmac_f32 v61, v58, v59
    v_lshlrev_b32 v56, 16, v65
    v_lshlrev_b32 v57, 16, v97
    v_and_b32 v58, 0xffff0000, v65
    v_and_b32 v59, 0xffff0000, v97
    v_fmac_f32 v60, v56, v57
    v_fmac_f32 v61, v58, v59
    v_lshlrev_b32 v56, 16, v66
    v_lshlrev_b32 v57, 16, v98
    v_and_b32 v58, 0xffff0000, v66
    v_and_b32 v59, 0xffff0000, v98
    v_fmac_f32 v60, v56, v57
    v_fmac_f32 v61, v58, v59
    v_lshlrev_b32 v56, 16, v67
    v_lshlrev_b32 v57, 16, v99
    v_and_b32 v58, 0xffff0000, v67
    v_and_b32 v59, 0xffff0000, v99
    v_fmac_f32 v60, v56, v57
    v_fmac_f32 v61, v58, v59
    v_lshlrev_b32 v56, 16, v68
    v_lshlrev_b32 v57, 16, v100
    v_and_b32 v58, 0xffff0000, v68
    v_and_b32 v59, 0xffff0000, v100
    v_fmac_f32 v60, v56, v57
    v_fmac_f32 v61, v58, v59
    v_lshlrev_b32 v56, 16, v69
    v_lshlrev_b32 v57, 16, v101
    v_and_b32 v58, 0xffff0000, v69
    v_and_b32 v59, 0xffff0000, v101
    v_fmac_f32 v60, v56, v57
    v_fmac_f32 v61, v58, v59
    v_lshlrev_b32 v56, 16, v70
    v_lshlrev_b32 v57, 16, v102
    v_and_b32 v58, 0xffff0000, v70
    v_and_b32 v59, 0xffff0000, v102
    v_fmac_f32 v60, v56, v57
    v_fmac_f32 v61, v58, v59
    v_lshlrev_b32 v56, 16, v71
    v_lshlrev_b32 v57, 16, v103
    v_and_b32 v58, 0xffff0000, v71
    v_and_b32 v59, 0xffff0000, v103
    v_fmac_f32 v60, v56, v57
    v_fmac_f32 v61, v58, v59
    v_lshlrev_b32 v56, 16, v72
    v_lshlrev_b32 v57, 16, v104
    v_and_b32 v58, 0xffff0000, v72
    v_and_b32 v59, 0xffff0000, v104
    v_fmac_f32 v60, v56, v57
    v_fmac_f32 v61, v58, v59
    v_lshlrev_b32 v56, 16, v73
    v_lshlrev_b32 v57, 16, v105
    v_and_b32 v58, 0xffff0000, v73
    v_and_b32 v59, 0xffff0000, v105
    v_fmac_f32 v60, v56, v57
    v_fmac_f32 v61, v58, v59
    v_lshlrev_b32 v56, 16, v74
    v_lshlrev_b32 v57, 16, v106
    v_and_b32 v58, 0xffff0000, v74
    v_and_b32 v59, 0xffff0000, v106
    v_fmac_f32 v60, v56, v57
    v_fmac_f32 v61, v58, v59
    v_lshlrev_b32 v56, 16, v75
    v_lshlrev_b32 v57, 16, v107
    v_and_b32 v58, 0xffff0000, v75
    v_and_b32 v59, 0xffff0000, v107
    v_fmac_f32 v60, v56, v57
    v_fmac_f32 v61, v58, v59
    v_lshlrev_b32 v56, 16, v76
    v_lshlrev_b32 v57, 16, v108
    v_and_b32 v58, 0xffff0000, v76
    v_and_b32 v59, 0xffff0000, v108
    v_fmac_f32 v60, v56, v57
    v_fmac_f32 v61, v58, v59
    v_lshlrev_b32 v56, 16, v77
    v_lshlrev_b32 v57, 16, v109
    v_and_b32 v58, 0xffff0000, v77
    v_and_b32 v59, 0xffff0000, v109
    v_fmac_f32 v60, v56, v57
    v_fmac_f32 v61, v58, v59
    v_lshlrev_b32 v56, 16, v78
    v_lshlrev_b32 v57, 16, v110
    v_and_b32 v58, 0xffff0000, v78
    v_and_b32 v59, 0xffff0000, v110
    v_fmac_f32 v60, v56, v57
    v_fmac_f32 v61, v58, v59
    v_lshlrev_b32 v56, 16, v79
    v_lshlrev_b32 v57, 16, v111
    v_and_b32 v58, 0xffff0000, v79
    v_and_b32 v59, 0xffff0000, v111
    v_fmac_f32 v60, v56, v57
    v_fmac_f32 v61, v58, v59
    v_lshlrev_b32 v56, 16, v80
    v_lshlrev_b32 v57, 16, v112
    v_and_b32 v58, 0xffff0000, v80
    v_and_b32 v59, 0xffff0000, v112
    v_fmac_f32 v60, v56, v57
    v_fmac_f32 v61, v58, v59
    v_lshlrev_b32 v56, 16, v81
    v_lshlrev_b32 v57, 16, v113
    v_and_b32 v58, 0xffff0000, v81
    v_and_b32 v59, 0xffff0000, v113
    v_fmac_f32 v60, v56, v57
    v_fmac_f32 v61, v58, v59
    v_lshlrev_b32 v56, 16, v82
    v_lshlrev_b32 v57, 16, v114
    v_and_b32 v58, 0xffff0000, v82
    v_and_b32 v59, 0xffff0000, v114
    v_fmac_f32 v60, v56, v57
    v_fmac_f32 v61, v58, v59
    v_lshlrev_b32 v56, 16, v83
    v_lshlrev_b32 v57, 16, v115
    v_and_b32 v58, 0xffff0000, v83
    v_and_b32 v59, 0xffff0000, v115
    v_fmac_f32 v60, v56, v57
    v_fmac_f32 v61, v58, v59
    v_add_f32 v60, v60, v61
    s_nop 1
    v_mov_b32_dpp v61, v60 row_ror:8 row_mask:0xf bank_mask:0xf
    v_add_f32 v60, v60, v61
    s_nop 1
    v_mov_b32_dpp v61, v60 row_ror:4 row_mask:0xf bank_mask:0xf
    v_add_f32 v60, v60, v61
    s_nop 1
    v_mov_b32_dpp v61, v60 row_ror:2 row_mask:0xf bank_mask:0xf
    v_add_f32 v60, v60, v61
    s_nop 1
    v_mov_b32_dpp v61, v60 row_ror:1 row_mask:0xf bank_mask:0xf
    v_add_f32 v60, v60, v61
    v_mul_f32 v60, 0xbfb8aa3b, v60
    v_exp_f32 v60, v60
    s_nop 0
    v_add_f32 v60, 1.0, v60
    v_rcp_f32 v60, v60
    v_lshlrev_b32 v18, 2, v18
    v_mov_b32 v20, 0x80000000
    v_cmp_eq_u32 vcc, 0, v19
    s_nop 1
    v_cndmask_b32 v18, v20, v18, vcc
    s_mov_b32 s33, 0x5000000
    buffer_store_dword v60, v18, s[8:11], s33 offen sc1
G_GATE_END:
    s_cmp_lg_u32 s60, 0
    s_cbranch_scc1 F_POLD
    s_mov_b32 s27, 200000
F_POLL:
    buffer_load_dword v3, off, s[12:15], 0 offset:12 sc1
    buffer_load_dword v4, off, s[12:15], 0 offset:0 sc1
    s_waitcnt vmcnt(0)
    v_readfirstlane_b32 s60, v3
    v_readfirstlane_b32 s61, v4
    s_nop 0
    s_cmp_ge_u32 s61, 64
    s_cselect_b32 s60, s60, 0
    s_cmp_lg_u32 s60, 0
    s_cbranch_scc1 F_POLD
    s_sub_u32 s27, s27, 1
    s_cbranch_scc0 F_POLL
    s_endpgm
F_POLD:
    s_mov_b32 s27, 200000
    v_and_b32 v1, 63, v0
    v_lshlrev_b32 v2, 4, v1
    s_lshl_b32 s29, s3, 10
    s_add_u32 s29, s29, 0x5020000
    s_cmp_lt_u32 s4, 20
    s_cbranch_scc1 F_ARRIVE
    s_cmp_ge_u32 s4, 28
    s_cbranch_scc1 F_ARRIVE
    s_sub_u32 s24, s4, 20
    s_lshl_b32 s24, s24, 7
    s_add_u32 s29, s29, s24
    v_mov_b32 v3, 0
    s_mov_b64 exec, 1
    buffer_store_dword v3, off, s[8:11], s29 sc1
    s_mov_b64 exec, -1
F_ARRIVE:
    s_waitcnt vmcnt(0)
    s_barrier
    s_cmp_eq_u32 s5, 0
    s_cbranch_scc0 F_ARRIVED
    v_mov_b32 v3, 1
    s_mov_b64 exec, 1
    buffer_atomic_add v3, off, s[12:15], 0 offset:16 sc1
    s_mov_b64 exec, -1
F_ARRIVED:
    s_cmp_ge_u32 s4, 28
    s_cbranch_scc1 F_END
    s_cmp_ge_u32 s4, 20
    s_cbranch_scc1 F_AT
    s_load_dwordx2 s[44:45], s[0:1], 40
    s_load_dwordx2 s[46:47], s[0:1], 80
    s_load_dwordx2 s[48:49], s[0:1], 96
    s_waitcnt lgkmcnt(0)
    s_mov_b32 s32, s44
    s_and_b32 s33, s45, 0xffff
    s_mov_b32 s34, 0x500000
    s_mov_b32 s35, 0x20000
    s_mov_b32 s36, s46
    s_and_b32 s37, s47, 0xffff
    s_mov_b32 s38, 0x21c000
    s_mov_b32 s39, 0x20000
    s_mov_b32 s40, s48
    s_and_b32 s41, s49, 0xffff
    s_mov_b32 s42, 0x280000
    s_mov_b32 s43, 0x20000
    v_lshrrev_b32 v3, 2, v1
    v_mul_u32_u24 v3, 1280, v3
    v_and_b32 v4, 3, v1
    v_lshl_add_u32 v6, v4, 4, v3
    s_mul_i32 s50, s5, 40960
    v_lshrrev_b32 v3, 5, v1
    v_bfe_u32 v4, v1, 2, 2
    v_lshl_add_u32 v3, v3, 2, v4
    v_lshlrev_b32 v3, 6, v3
    v_bfe_u32 v4, v1, 4, 1
    v_lshl_add_u32 v3, v4, 5, v3
    v_and_b32 v4, 3, v1
    v_lshl_add_u32 v3, v4, 3, v3
    v_add_u32 v7, s50, v3
    s_lshl_b32 s24, s4, 6
    s_mul_i32 s51, s5, 1310720
    s_add_u32 s51, s51, s24
    s_mul_i32 s52, s5, 552960
    s_add_u32 s52, s52, s24
    s_add_u32 m0, s50, 0
    s_nop 0
    buffer_load_dwordx4 v6, s[32:35], s51 offen lds
    s_add_u32 s51, s51, 20480
    s_add_u32 m0, s50, 1024
    s_nop 0
    buffer_load_dwordx4 v6, s[32:35], s51 offen lds
    s_add_u32 s51, s51, 20480
    s_add_u32 m0, s50, 2048
    s_nop 0
    buffer_load_dwordx4 v6, s[32:35], s51 offen lds
    s_add_u32 s51, s51, 20480
    s_add_u32 m0, s50, 3072
    s_nop 0
    buffer_load_dwordx4 v6, s[32:35], s51 offen lds
    s_add_u32 s51, s51, 20480
    s_add_u32 m0, s50, 4096
    s_nop 0
    buffer_load_dwordx4 v6, s[32:35], s51 offen lds
    s_add_u32 s51, s51, 20480
    s_add_u32 m0, s50, 5120
    s_nop 0
    buffer_load_dwordx4 v6, s[32:35], s51 offen lds
    s_add_u32 s51, s51, 20480
    s_add_u32 m0, s50, 6144
    s_nop 0
    buffer_load_dwordx4 v6, s[32:35], s51 offen lds
    s_add_u32 s51, s51, 20480
    s_add_u32 m0, s50, 7168
    s_nop 0
    buffer_load_dwordx4 v6, s[32:35], s51 offen lds
    s_add_u32 s51, s51, 20480
    s_add_u32 m0, s50, 8192
    s_nop 0
    buffer_load_dwordx4 v6, s[32:35], s51 offen lds
    s_add_u32 s51, s51, 20480
    s_add_u32 m0, s50, 9216
    s_nop 0
    buffer_load_dwordx4 v6, s[32:35], s51 offen lds
    s_add_u32 s51, s51, 20480
    s_add_u32 m0, s50, 10240
    s_nop 0
    buffer_load_dwordx4 v6, s[32:35], s51 offen lds
    s_add_u32 s51, s51, 20480
    s_add_u32 m0, s50, 11264
    s_nop 0
    buffer_load_dwordx4 v6, s[32:35], s51 offen lds
    s_add_u32 s51, s51, 20480
    s_add_u32 m0, s50, 12288
    s_nop 0
    buffer_load_dwordx4 v6, s[32:35], s51 offen lds
    s_add_u32 s51, s51, 20480
    s_add_u32 m0, s50, 13312
    s_nop 0
    buffer_load_dwordx4 v6, s[32:35], s51 offen lds
    s_add_u32 s51, s51, 20480
    s_add_u32 m0, s50, 14336
    s_nop 0
    buffer_load_dwordx4 v6, s[32:35], s51 offen lds
    s_add_u32 s51, s51, 20480
    s_add_u32 m0, s50, 15360
    s_nop 0
    buffer_load_dwordx4 v6, s[32:35], s51 offen lds
    s_add_u32 s51, s51, 20480
    s_add_u32 m0, s50, 16384
    s_nop 0
    buffer_load_dwordx4 v6, s[32:35], s51 offen lds
    s_add_u32 s51, s51, 20480
    s_add_u32 m0, s50, 17408
    s_nop 0
    buffer_load_dwordx4 v6, s[32:35], s51 offen lds
    s_add_u32 s51, s51, 20480
    s_add_u32 m0, s50, 18432
    s_nop 0
    buffer_load_dwordx4 v6, s[32:35], s51 offen lds
    s_add_u32 s51, s51, 20480
    s_add_u32 m0, s50, 19456
    s_nop 0
    buffer_load_dwordx4 v6, s[32:35], s51 offen lds
    s_add_u32 s51, s51, 20480
    s_add_u32 m0, s50, 20480
    s_nop 0
    buffer_load_dwordx4 v6, s[32:35], s51 offen lds
    s_add_u32 s51, s51, 20480
    s_add_u32 m0, s50, 21504
    s_nop 0
    buffer_load_dwordx4 v6, s[32:35], s51 offen lds
    s_add_u32 s51, s51, 20480
    s_add_u32 m0, s50, 22528
    s_nop 0
    buffer_load_dwordx4 v6, s[32:35], s51 offen lds
    s_add_u32 s51, s51, 20480
    s_add_u32 m0, s50, 23552
    s_nop 0
    buffer_load_dwordx4 v6, s[32:35], s51 offen lds
    s_add_u32 s51, s51, 20480
    s_add_u32 m0, s50, 24576
    s_nop 0
    buffer_load_dwordx4 v6, s[32:35], s51 offen lds
    s_add_u32 s51, s51, 20480
    s_add_u32 m0, s50, 25600
    s_nop 0
    buffer_load_dwordx4 v6, s[32:35], s51 offen lds
    s_add_u32 s51, s51, 20480
    s_add_u32 m0, s50, 26624
    s_nop 0
    buffer_load_dwordx4 v6, s[32:35], s51 offen lds
    s_add_u32 s51, s51, 20480
    s_add_u32 m0, s50, 27648
    s_nop 0
    buffer_load_dwordx4 v6, s[32:35], s51 offen lds
    s_add_u32 s51, s51, 20480
    s_add_u32 m0, s50, 28672
    s_nop 0
    buffer_load_dwordx4 v6, s[32:35], s51 offen lds
    s_add_u32 s51, s51, 20480
    s_add_u32 m0, s50, 29696
    s_nop 0
    buffer_load_dwordx4 v6, s[32:35], s51 offen lds
    s_add_u32 s51, s51, 20480
    s_add_u32 m0, s50, 30720
    s_nop 0
    buffer_load_dwordx4 v6, s[32:35], s51 offen lds
    s_add_u32 s51, s51, 20480
    s_add_u32 m0, s50, 31744
    s_nop 0
    buffer_load_dwordx4 v6, s[32:35], s51 offen lds
    s_add_u32 s51, s51, 20480
    s_add_u32 m0, s50, 32768
    s_nop 0
    buffer_load_dwordx4 v6, s[32:35], s51 offen lds
    s_add_u32 s51, s51, 20480
    s_add_u32 m0, s50, 33792
    s_nop 0
    buffer_load_dwordx4 v6, s[32:35], s51 offen lds
    s_add_u32 s51, s51, 20480
    s_add_u32 m0, s50, 34816
    s_nop 0
    buffer_load_dwordx4 v6, s[32:35], s51 offen lds
    s_add_u32 s51, s51, 20480
    s_add_u32 m0, s50, 35840
    s_nop 0
    buffer_load_dwordx4 v6, s[32:35], s51 offen lds
    s_add_u32 s51, s51, 20480
    s_add_u32 m0, s50, 36864
    s_nop 0
    buffer_load_dwordx4 v6, s[32:35], s51 offen lds
    s_add_u32 s51, s51, 20480
    s_add_u32 m0, s50, 37888
    s_nop 0
    buffer_load_dwordx4 v6, s[32:35], s51 offen lds
    s_add_u32 s51, s51, 20480
    s_add_u32 m0, s50, 38912
    s_nop 0
    buffer_load_dwordx4 v6, s[32:35], s51 offen lds
    s_add_u32 s51, s51, 20480
    s_add_u32 m0, s50, 39936
    s_nop 0
    buffer_load_dwordx4 v6, s[32:35], s51 offen lds
    s_add_u32 s51, s51, 20480
    s_waitcnt vmcnt(36)
    ds_read_b64_tr_b16 a[0:1], v7 offset:0
    ds_read_b64_tr_b16 a[2:3], v7 offset:512
    ds_read_b64_tr_b16 a[4:5], v7 offset:1024
    ds_read_b64_tr_b16 a[6:7], v7 offset:1536
    ds_read_b64_tr_b16 a[8:9], v7 offset:2048
    ds_read_b64_tr_b16 a[10:11], v7 offset:2560
    ds_read_b64_tr_b16 a[12:13], v7 offset:3072
    ds_read_b64_tr_b16 a[14:15], v7 offset:3584
    s_waitcnt lgkmcnt(0)
    s_add_u32 m0, s50, 0
    s_nop 0
    buffer_load_dwordx4 v6, s[32:35], s51 offen lds
    s_add_u32 s51, s51, 20480
    s_add_u32 m0, s50, 1024
    s_nop 0
    buffer_load_dwordx4 v6, s[32:35], s51 offen lds
    s_add_u32 s51, s51, 20480
    s_add_u32 m0, s50, 2048
    s_nop 0
    buffer_load_dwordx4 v6, s[32:35], s51 offen lds
    s_add_u32 s51, s51, 20480
    s_add_u32 m0, s50, 3072
    s_nop 0
    buffer_load_dwordx4 v6, s[32:35], s51 offen lds
    s_add_u32 s51, s51, 20480
    s_waitcnt vmcnt(36)
    ds_read_b64_tr_b16 a[16:17], v7 offset:4096
    ds_read_b64_tr_b16 a[18:19], v7 offset:4608
    ds_read_b64_tr_b16 a[20:21], v7 offset:5120
    ds_read_b64_tr_b16 a[22:23], v7 offset:5632
    ds_read_b64_tr_b16 a[24:25], v7 offset:6144
    ds_read_b64_tr_b16 a[26:27], v7 offset:6656
    ds_read_b64_tr_b16 a[28:29], v7 offset:7168
    ds_read_b64_tr_b16 a[30:31], v7 offset:7680
    s_waitcnt lgkmcnt(0)
    s_add_u32 m0, s50, 4096
    s_nop 0
    buffer_load_dwordx4 v6, s[32:35], s51 offen lds
    s_add_u32 s51, s51, 20480
    s_add_u32 m0, s50, 5120
    s_nop 0
    buffer_load_dwordx4 v6, s[32:35], s51 offen lds
    s_add_u32 s51, s51, 20480
    s_add_u32 m0, s50, 6144
    s_nop 0
    buffer_load_dwordx4 v6, s[32:35], s51 offen lds
    s_add_u32 s51, s51, 20480
    s_add_u32 m0, s50, 7168
    s_nop 0
    buffer_load_dwordx4 v6, s[32:35], s51 offen lds
    s_add_u32 s51, s51, 20480
    s_waitcnt vmcnt(36)
    ds_read_b64_tr_b16 a[32:33], v7 offset:8192
    ds_read_b64_tr_b16 a[34:35], v7 offset:8704
    ds_read_b64_tr_b16 a[36:37], v7 offset:9216
    ds_read_b64_tr_b16 a[38:39], v7 offset:9728
    ds_read_b64_tr_b16 a[40:41], v7 offset:10240
    ds_read_b64_tr_b16 a[42:43], v7 offset:10752
    ds_read_b64_tr_b16 a[44:45], v7 offset:11264
    ds_read_b64_tr_b16 a[46:47], v7 offset:11776
    s_waitcnt lgkmcnt(0)
    s_add_u32 m0, s50, 8192
    s_nop 0
    buffer_load_dwordx4 v6, s[32:35], s51 offen lds
    s_add_u32 s51, s51, 20480
    s_add_u32 m0, s50, 9216
    s_nop 0
    buffer_load_dwordx4 v6, s[32:35], s51 offen lds
    s_add_u32 s51, s51, 20480
    s_add_u32 m0, s50, 10240
    s_nop 0
    buffer_load_dwordx4 v6, s[32:35], s51 offen lds
    s_add_u32 s51, s51, 20480
    s_add_u32 m0, s50, 11264
    s_nop 0
    buffer_load_dwordx4 v6, s[32:35], s51 offen lds
    s_add_u32 s51, s51, 20480
    s_waitcnt vmcnt(36)
    ds_read_b64_tr_b16 a[48:49], v7 offset:12288
    ds_read_b64_tr_b16 a[50:51], v7 offset:12800
    ds_read_b64_tr_b16 a[52:53], v7 offset:13312
    ds_read_b64_tr_b16 a[54:55], v7 offset:13824
    ds_read_b64_tr_b16 a[56:57], v7 offset:14336
    ds_read_b64_tr_b16 a[58:59], v7 offset:14848
    ds_read_b64_tr_b16 a[60:61], v7 offset:15360
    ds_read_b64_tr_b16 a[62:63], v7 offset:15872
    s_waitcnt lgkmcnt(0)
    s_add_u32 m0, s50, 12288
    s_nop 0
    buffer_load_dwordx4 v6, s[32:35], s51 offen lds
    s_add_u32 s51, s51, 20480
    s_add_u32 m0, s50, 13312
    s_nop 0
    buffer_load_dwordx4 v6, s[32:35], s51 offen lds
    s_add_u32 s51, s51, 20480
    s_add_u32 m0, s50, 14336
    s_nop 0
    buffer_load_dwordx4 v6, s[32:35], s51 offen lds
    s_add_u32 s51, s51, 20480
    s_add_u32 m0, s50, 15360
    s_nop 0
    buffer_load_dwordx4 v6, s[32:35], s51 offen lds
    s_add_u32 s51, s51, 20480
    s_waitcnt vmcnt(36)
    ds_read_b64_tr_b16 a[64:65], v7 offset:16384
    ds_read_b64_tr_b16 a[66:67], v7 offset:16896
    ds_read_b64_tr_b16 a[68:69], v7 offset:17408
    ds_read_b64_tr_b16 a[70:71], v7 offset:17920
    ds_read_b64_tr_b16 a[72:73], v7 offset:18432
    ds_read_b64_tr_b16 a[74:75], v7 offset:18944
    ds_read_b64_tr_b16 a[76:77], v7 offset:19456
    ds_read_b64_tr_b16 a[78:79], v7 offset:19968
    s_waitcnt lgkmcnt(0)
    s_add_u32 m0, s50, 16384
    s_nop 0
    buffer_load_dwordx4 v6, s[32:35], s51 offen lds
    s_add_u32 s51, s51, 20480
    s_add_u32 m0, s50, 17408
    s_nop 0
    buffer_load_dwordx4 v6, s[32:35], s51 offen lds
    s_add_u32 s51, s51, 20480
    s_add_u32 m0, s50, 18432
    s_nop 0
    buffer_load_dwordx4 v6, s[32:35], s51 offen lds
    s_add_u32 s51, s51, 20480
    s_add_u32 m0, s50, 19456
    s_nop 0
    buffer_load_dwordx4 v6, s[32:35], s51 offen lds
    s_add_u32 s51, s51, 20480
    s_waitcnt vmcnt(36)
    ds_read_b64_tr_b16 a[80:81], v7 offset:20480
    ds_read_b64_tr_b16 a[82:83], v7 offset:20992
    ds_read_b64_tr_b16 a[84:85], v7 offset:21504
    ds_read_b64_tr_b16 a[86:87], v7 offset:22016
    ds_read_b64_tr_b16 a[88:89], v7 offset:22528
    ds_read_b64_tr_b16 a[90:91], v7 offset:23040
    ds_read_b64_tr_b16 a[92:93], v7 offset:23552
    ds_read_b64_tr_b16 a[94:95], v7 offset:24064
    s_waitcnt lgkmcnt(0)
    s_add_u32 m0, s50, 20480
    s_nop 0
    buffer_load_dwordx4 v6, s[32:35], s51 offen lds
    s_add_u32 s51, s51, 20480
    s_add_u32 m0, s50, 21504
    s_nop 0
    buffer_load_dwordx4 v6, s[32:35], s51 offen lds
    s_add_u32 s51, s51, 20480
    s_add_u32 m0, s50, 22528
    s_nop 0
    buffer_load_dwordx4 v6, s[32:35], s51 offen lds
    s_add_u32 s51, s51, 20480
    s_add_u32 m0, s50, 23552
    s_nop 0
    buffer_load_dwordx4 v6, s[32:35], s51 offen lds
    s_add_u32 s51, s51, 20480
    s_waitcnt vmcnt(36)
    ds_read_b64_tr_b16 a[96:97], v7 offset:24576
    ds_read_b64_tr_b16 a[98:99], v7 offset:25088
    ds_read_b64_tr_b16 a[100:101], v7 offset:25600
    ds_read_b64_tr_b16 a[102:103], v7 offset:26112
    ds_read_b64_tr_b16 a[104:105], v7 offset:26624
    ds_read_b64_tr_b16 a[106:107], v7 offset:27136
    ds_read_b64_tr_b16 a[108:109], v7 offset:27648
    ds_read_b64_tr_b16 a[110:111], v7 offset:28160
    s_waitcnt lgkmcnt(0)
    s_add_u32 m0, s50, 24576
    s_nop 0
    buffer_load_dwordx4 v6, s[36:39], s52 offen lds
    s_add_u32 s52, s52, 20480
    s_add_u32 m0, s50, 25600
    s_nop 0
    buffer_load_dwordx4 v6, s[36:39], s52 offen lds
    s_add_u32 s52, s52, 20480
    s_add_u32 m0, s50, 26624
    s_nop 0
    buffer_load_dwordx4 v6, s[36:39], s52 offen lds
    s_add_u32 s52, s52, 20480
    s_add_u32 m0, s50, 27648
    s_nop 0
    buffer_load_dwordx4 v6, s[36:39], s52 offen lds
    s_add_u32 s52, s52, 20480
    s_waitcnt vmcnt(36)
    ds_read_b64_tr_b16 a[112:113], v7 offset:28672
    ds_read_b64_tr_b16 a[114:115], v7 offset:29184
    ds_read_b64_tr_b16 a[116:117], v7 offset:29696
    ds_read_b64_tr_b16 a[118:119], v7 offset:30208
    ds_read_b64_tr_b16 a[120:121], v7 offset:30720
    ds_read_b64_tr_b16 a[122:123], v7 offset:31232
    ds_read_b64_tr_b16 a[124:125], v7 offset:31744
    ds_read_b64_tr_b16 a[126:127], v7 offset:32256
    s_waitcnt lgkmcnt(0)
    s_add_u32 m0, s50, 28672
    s_nop 0
    buffer_load_dwordx4 v6, s[36:39], s52 offen lds
    s_add_u32 s52, s52, 20480
    s_add_u32 m0, s50, 29696
    s_nop 0
    buffer_load_dwordx4 v6, s[36:39], s52 offen lds
    s_add_u32 s52, s52, 20480
    s_add_u32 m0, s50, 30720
    s_nop 0
    buffer_load_dwordx4 v6, s[36:39], s52 offen lds
    s_add_u32 s52, s52, 20480
    s_add_u32 m0, s50, 31744
    s_nop 0
    buffer_load_dwordx4 v6, s[36:39], s52 offen lds
    s_add_u32 s52, s52, 20480
    s_waitcnt vmcnt(36)
    ds_read_b64_tr_b16 a[128:129], v7 offset:32768
    ds_read_b64_tr_b16 a[130:131], v7 offset:33280
    ds_read_b64_tr_b16 a[132:133], v7 offset:33792
    ds_read_b64_tr_b16 a[134:135], v7 offset:34304
    ds_read_b64_tr_b16 a[136:137], v7 offset:34816
    ds_read_b64_tr_b16 a[138:139], v7 offset:35328
    ds_read_b64_tr_b16 a[140:141], v7 offset:35840
    ds_read_b64_tr_b16 a[142:143], v7 offset:36352
    s_waitcnt lgkmcnt(0)
    s_add_u32 m0, s50, 32768
    s_nop 0
    buffer_load_dwordx4 v6, s[36:39], s52 offen lds
    s_add_u32 s52, s52, 20480
    s_add_u32 m0, s50, 33792
    s_nop 0
    buffer_load_dwordx4 v6, s[36:39], s52 offen lds
    s_add_u32 s52, s52, 20480
    s_add_u32 m0, s50, 34816
    s_nop 0
    buffer_load_dwordx4 v6, s[36:39], s52 offen lds
    s_add_u32 s52, s52, 20480
    s_add_u32 m0, s50, 35840
    s_nop 0
    buffer_load_dwordx4 v6, s[36:39], s52 offen lds
    s_add_u32 s52, s52, 20480
    s_waitcnt vmcnt(36)
    ds_read_b64_tr_b16 a[144:145], v7 offset:36864
    ds_read_b64_tr_b16 a[146:147], v7 offset:37376
    ds_read_b64_tr_b16 a[148:149], v7 offset:37888
    ds_read_b64_tr_b16 a[150:151], v7 offset:38400
    ds_read_b64_tr_b16 a[152:153], v7 offset:38912
    ds_read_b64_tr_b16 a[154:155], v7 offset:39424
    ds_read_b64_tr_b16 a[156:157], v7 offset:39936
    ds_read_b64_tr_b16 a[158:159], v7 offset:40448
    s_waitcnt lgkmcnt(0)
    s_add_u32 m0, s50, 36864
    s_nop 0
    buffer_load_dwordx4 v6, s[36:39], s52 offen lds
    s_add_u32 s52, s52, 20480
    s_add_u32 m0, s50, 37888
    s_nop 0
    buffer_load_dwordx4 v6, s[36:39], s52 offen lds
    s_add_u32 s52, s52, 20480
    s_add_u32 m0, s50, 38912
    s_nop 0
    buffer_load_dwordx4 v6, s[36:39], s52 offen lds
    s_add_u32 s52, s52, 20480
    s_add_u32 m0, s50, 39936
    s_nop 0
    buffer_load_dwordx4 v6, s[36:39], s52 offen lds
    s_add_u32 s52, s52, 20480
    s_waitcnt vmcnt(36)
    ds_read_b64_tr_b16 a[160:161], v7 offset:0
    ds_read_b64_tr_b16 a[162:163], v7 offset:512
    ds_read_b64_tr_b16 a[164:165], v7 offset:1024
    ds_read_b64_tr_b16 a[166:167], v7 offset:1536
    ds_read_b64_tr_b16 a[168:169], v7 offset:2048
    ds_read_b64_tr_b16 a[170:171], v7 offset:2560
    ds_read_b64_tr_b16 a[172:173], v7 offset:3072
    ds_read_b64_tr_b16 a[174:175], v7 offset:3584
    s_waitcnt lgkmcnt(0)
    s_add_u32 m0, s50, 0
    s_nop 0
    buffer_load_dwordx4 v6, s[36:39], s52 offen lds
    s_add_u32 s52, s52, 20480
    s_add_u32 m0, s50, 1024
    s_nop 0
    buffer_load_dwordx4 v6, s[36:39], s52 offen lds
    s_add_u32 s52, s52, 20480
    s_add_u32 m0, s50, 2048
    s_nop 0
    buffer_load_dwordx4 v6, s[36:39], s52 offen lds
    s_add_u32 s52, s52, 20480
    s_add_u32 m0, s50, 3072
    s_nop 0
    buffer_load_dwordx4 v6, s[36:39], s52 offen lds
    s_add_u32 s52, s52, 20480
    s_waitcnt vmcnt(36)
    ds_read_b64_tr_b16 a[176:177], v7 offset:4096
    ds_read_b64_tr_b16 a[178:179], v7 offset:4608
    ds_read_b64_tr_b16 a[180:181], v7 offset:5120
    ds_read_b64_tr_b16 a[182:183], v7 offset:5632
    ds_read_b64_tr_b16 a[184:185], v7 offset:6144
    ds_read_b64_tr_b16 a[186:187], v7 offset:6656
    ds_read_b64_tr_b16 a[188:189], v7 offset:7168
    ds_read_b64_tr_b16 a[190:191], v7 offset:7680
    s_waitcnt lgkmcnt(0)
    s_add_u32 m0, s50, 4096
    s_nop 0
    buffer_load_dwordx4 v6, s[36:39], s52 offen lds
    s_add_u32 s52, s52, 20480
    s_add_u32 m0, s50, 5120
    s_nop 0
    buffer_load_dwordx4 v6, s[36:39], s52 offen lds
    s_add_u32 s52, s52, 20480
    s_add_u32 m0, s50, 6144
    s_nop 0
    buffer_load_dwordx4 v6, s[36:39], s52 offen lds
    s_add_u32 s52, s52, 20480
    s_add_u32 m0, s50, 7168
    s_nop 0
    buffer_load_dwordx4 v6, s[36:39], s52 offen lds
    s_add_u32 s52, s52, 20480
    s_waitcnt vmcnt(36)
    ds_read_b64_tr_b16 a[192:193], v7 offset:8192
    ds_read_b64_tr_b16 a[194:195], v7 offset:8704
    ds_read_b64_tr_b16 a[196:197], v7 offset:9216
    ds_read_b64_tr_b16 a[198:199], v7 offset:9728
    ds_read_b64_tr_b16 a[200:201], v7 offset:10240
    ds_read_b64_tr_b16 a[202:203], v7 offset:10752
    ds_read_b64_tr_b16 a[204:205], v7 offset:11264
    ds_read_b64_tr_b16 a[206:207], v7 offset:11776
    s_waitcnt lgkmcnt(0)
    s_add_u32 m0, s50, 8192
    s_nop 0
    buffer_load_dwordx4 v6, s[36:39], s52 offen lds
    s_add_u32 s52, s52, 20480
    s_add_u32 m0, s50, 9216
    s_nop 0
    buffer_load_dwordx4 v6, s[36:39], s52 offen lds
    s_add_u32 s52, s52, 20480
    s_add_u32 m0, s50, 10240
    s_nop 0
    buffer_load_dwordx4 v6, s[36:39], s52 offen lds
    s_add_u32 s52, s52, 20480
    s_waitcnt vmcnt(35)
    ds_read_b64_tr_b16 a[208:209], v7 offset:12288
    ds_read_b64_tr_b16 a[210:211], v7 offset:12800
    ds_read_b64_tr_b16 a[212:213], v7 offset:13312
    ds_read_b64_tr_b16 a[214:215], v7 offset:13824
    ds_read_b64_tr_b16 a[216:217], v7 offset:14336
    ds_read_b64_tr_b16 a[218:219], v7 offset:14848
    ds_read_b64_tr_b16 a[220:221], v7 offset:15360
    ds_read_b64_tr_b16 a[222:223], v7 offset:15872
    s_waitcnt lgkmcnt(0)
    s_waitcnt vmcnt(31)
    ds_read_b64_tr_b16 a[224:225], v7 offset:16384
    ds_read_b64_tr_b16 a[226:227], v7 offset:16896
    ds_read_b64_tr_b16 a[228:229], v7 offset:17408
    ds_read_b64_tr_b16 a[230:231], v7 offset:17920
    ds_read_b64_tr_b16 a[232:233], v7 offset:18432
    ds_read_b64_tr_b16 a[234:235], v7 offset:18944
    ds_read_b64_tr_b16 a[236:237], v7 offset:19456
    ds_read_b64_tr_b16 a[238:239], v7 offset:19968
    s_waitcnt lgkmcnt(0)
    s_waitcnt vmcnt(27)
    ds_read_b64_tr_b16 a[240:241], v7 offset:20480
    ds_read_b64_tr_b16 a[242:243], v7 offset:20992
    ds_read_b64_tr_b16 a[244:245], v7 offset:21504
    ds_read_b64_tr_b16 a[246:247], v7 offset:22016
    ds_read_b64_tr_b16 a[248:249], v7 offset:22528
    ds_read_b64_tr_b16 a[250:251], v7 offset:23040
    ds_read_b64_tr_b16 a[252:253], v7 offset:23552
    ds_read_b64_tr_b16 a[254:255], v7 offset:24064
    s_waitcnt lgkmcnt(0)
    s_waitcnt vmcnt(23)
    ds_read_b64_tr_b16 v[148:149], v7 offset:24576
    ds_read_b64_tr_b16 v[150:151], v7 offset:25088
    ds_read_b64_tr_b16 v[152:153], v7 offset:25600
    ds_read_b64_tr_b16 v[154:155], v7 offset:26112
    ds_read_b64_tr_b16 v[156:157], v7 offset:26624
    ds_read_b64_tr_b16 v[158:159], v7 offset:27136
    ds_read_b64_tr_b16 v[160:161], v7 offset:27648
    ds_read_b64_tr_b16 v[162:163], v7 offset:28160
    s_waitcnt lgkmcnt(0)
    s_waitcnt vmcnt(19)
    ds_read_b64_tr_b16 v[164:165], v7 offset:28672
    ds_read_b64_tr_b16 v[166:167], v7 offset:29184
    ds_read_b64_tr_b16 v[168:169], v7 offset:29696
    ds_read_b64_tr_b16 v[170:171], v7 offset:30208
    ds_read_b64_tr_b16 v[172:173], v7 offset:30720
    ds_read_b64_tr_b16 v[174:175], v7 offset:31232
    ds_read_b64_tr_b16 v[176:177], v7 offset:31744
    ds_read_b64_tr_b16 v[178:179], v7 offset:32256
    s_waitcnt lgkmcnt(0)
    s_waitcnt vmcnt(15)
    ds_read_b64_tr_b16 v[180:181], v7 offset:32768
    ds_read_b64_tr_b16 v[182:183], v7 offset:33280
    ds_read_b64_tr_b16 v[184:185], v7 offset:33792
    ds_read_b64_tr_b16 v[186:187], v7 offset:34304
    ds_read_b64_tr_b16 v[188:189], v7 offset:34816
    ds_read_b64_tr_b16 v[190:191], v7 offset:35328
    ds_read_b64_tr_b16 v[192:193], v7 offset:35840
    ds_read_b64_tr_b16 v[194:195], v7 offset:36352
    s_waitcnt lgkmcnt(0)
    s_waitcnt vmcnt(11)
    ds_read_b64_tr_b16 v[196:197], v7 offset:36864
    ds_read_b64_tr_b16 v[198:199], v7 offset:37376
    ds_read_b64_tr_b16 v[200:201], v7 offset:37888
    ds_read_b64_tr_b16 v[202:203], v7 offset:38400
    ds_read_b64_tr_b16 v[204:205], v7 offset:38912
    ds_read_b64_tr_b16 v[206:207], v7 offset:39424
    ds_read_b64_tr_b16 v[208:209], v7 offset:39936
    ds_read_b64_tr_b16 v[210:211], v7 offset:40448
    s_waitcnt lgkmcnt(0)
    s_waitcnt vmcnt(7)
    ds_read_b64_tr_b16 v[212:213], v7 offset:0
    ds_read_b64_tr_b16 v[214:215], v7 offset:512
    ds_read_b64_tr_b16 v[216:217], v7 offset:1024
    ds_read_b64_tr_b16 v[218:219], v7 offset:1536
    ds_read_b64_tr_b16 v[220:221], v7 offset:2048
    ds_read_b64_tr_b16 v[222:223], v7 offset:2560
    ds_read_b64_tr_b16 v[224:225], v7 offset:3072
    ds_read_b64_tr_b16 v[226:227], v7 offset:3584
    s_waitcnt lgkmcnt(0)
    s_waitcnt vmcnt(3)
    ds_read_b64_tr_b16 v[228:229], v7 offset:4096
    ds_read_b64_tr_b16 v[230:231], v7 offset:4608
    ds_read_b64_tr_b16 v[232:233], v7 offset:5120
    ds_read_b64_tr_b16 v[234:235], v7 offset:5632
    ds_read_b64_tr_b16 v[236:237], v7 offset:6144
    ds_read_b64_tr_b16 v[238:239], v7 offset:6656
    ds_read_b64_tr_b16 v[240:241], v7 offset:7168
    ds_read_b64_tr_b16 v[242:243], v7 offset:7680
    s_waitcnt lgkmcnt(0)
    s_waitcnt vmcnt(0)
    ds_read_b64_tr_b16 v[244:245], v7 offset:8192
    ds_read_b64_tr_b16 v[246:247], v7 offset:8704
    ds_read_b64_tr_b16 v[248:249], v7 offset:9216
    ds_read_b64_tr_b16 v[250:251], v7 offset:9728
    ds_read_b64_tr_b16 v[252:253], v7 offset:10240
    ds_read_b64_tr_b16 v[254:255], v7 offset:10752
    s_waitcnt lgkmcnt(0)
    v_and_b32 v3, 31, v1
    v_lshlrev_b32 v9, 2, v3
    v_mul_u32_u24 v3, 1280, v3
    v_lshrrev_b32 v4, 5, v1
    v_lshl_add_u32 v3, v4, 3, v3
    s_lshl_b32 s24, s4, 6
    s_lshl_b32 s25, s5, 4
    s_add_u32 s24, s24, s25
    v_add_u32 v8, s24, v3
    s_lshl_b32 s24, s5, 12
    v_add_u32 v10, s24, v2
    s_lshl_b32 s24, s5, 10
    v_add_u32 v11, s24, v2
    s_lshl_b32 s24, s5, 8
    s_add_u32 s29, s29, s24
    s_barrier
F_OPW:
    buffer_load_dword v3, off, s[12:15], 0 offset:0 sc1
    buffer_load_dword v4, off, s[12:15], 0 offset:16 sc1
    s_waitcnt vmcnt(0)
    v_readfirstlane_b32 s24, v3
    v_readfirstlane_b32 s25, v4
    s_cmp_ge_u32 s24, 64
    s_cselect_b32 s25, s25, 0
    s_cmp_ge_u32 s25, 192
    s_cbranch_scc1 F_OPW_OK
    s_sleep 8
    s_sub_u32 s27, s27, 1
    s_cbranch_scc0 F_OPW
    s_branch F_FAIL
F_OPW_OK:
    s_mov_b32 s28, s3
    s_mov_b32 s54, s3
    buffer_load_dword v3, off, s[8:11], s29 sc1
    buffer_load_dword v4, off, s[8:11], s29 offset:128 sc1
    s_cmp_lt_u32 s54, 64
    s_cselect_b32 s25, s54, s28
    s_mul_i32 s52, s25, 110592
    s_mul_i32 s24, s5, 27648
    s_add_u32 s52, s52, s24
    s_add_u32 s52, s52, 0x4000000
    s_lshl_b32 s26, s25, 7
    s_add_u32 s26, s26, 0x5000000
    buffer_load_dword v48, v9, s[8:11], s26 offen sc1
    buffer_load_dwordx4 v[52:55], v2, s[8:11], s52 offen offset:0 sc1
    buffer_load_dwordx4 v[56:59], v2, s[8:11], s52 offen offset:1024 sc1
    buffer_load_dwordx4 v[60:63], v2, s[8:11], s52 offen offset:2048 sc1
    buffer_load_dwordx4 v[64:67], v2, s[8:11], s52 offen offset:3072 sc1
    s_add_u32 s52, s52, 4096
    buffer_load_dwordx4 v[68:71], v2, s[8:11], s52 offen offset:0 sc1
    buffer_load_dwordx4 v[72:75], v2, s[8:11], s52 offen offset:1024 sc1
    buffer_load_dwordx4 v[76:79], v2, s[8:11], s52 offen offset:2048 sc1
    buffer_load_dwordx4 v[80:83], v2, s[8:11], s52 offen offset:3072 sc1
    s_add_u32 s52, s52, 4096
    buffer_load_dwordx4 v[84:87], v2, s[8:11], s52 offen offset:0 sc1
    buffer_load_dwordx4 v[88:91], v2, s[8:11], s52 offen offset:1024 sc1
    buffer_load_dwordx4 v[92:95], v2, s[8:11], s52 offen offset:2048 sc1
    buffer_load_dwordx4 v[96:99], v2, s[8:11], s52 offen offset:3072 sc1
    s_add_u32 s52, s52, 4096
    buffer_load_dwordx4 v[100:103], v2, s[8:11], s52 offen offset:0 sc1
    buffer_load_dwordx4 v[104:107], v2, s[8:11], s52 offen offset:1024 sc1
    buffer_load_dwordx4 v[108:111], v2, s[8:11], s52 offen offset:2048 sc1
    buffer_load_dwordx4 v[112:115], v2, s[8:11], s52 offen offset:3072 sc1
    s_add_u32 s52, s52, 4096
    buffer_load_dwordx4 v[116:119], v2, s[8:11], s52 offen offset:0 sc1
    buffer_load_dwordx4 v[120:123], v2, s[8:11], s52 offen offset:1024 sc1
    buffer_load_dwordx4 v[124:127], v2, s[8:11], s52 offen offset:2048 sc1
    buffer_load_dwordx4 v[128:131], v2, s[8:11], s52 offen offset:3072 sc1
    s_add_u32 s52, s52, 4096
    buffer_load_dwordx4 v[132:135], v2, s[8:11], s52 offen offset:0 sc1
    buffer_load_dword v14, off, s[8:11], s29 sc1
F_OP_LOOP:
    s_lshl_b32 s51, s28, 19
    s_lshl_b32 s24, s5, 17
    s_add_u32 s51, s51, s24
    s_add_u32 s51, s51, 0x2002000
    s_lshr_b32 s24, s28, 2
    s_xor_b32 s24, s24, s60
    s_and_b32 s24, s24, 1
    s_lshl_b32 s24, s24, 13
    s_xor_b32 s51, s51, s24
    s_waitcnt vmcnt(22)
    v_mov_b32 v12, v48
    buffer_load_dwordx4 v[136:139], v2, s[8:11], s52 offen offset:1024 sc1
    s_waitcnt vmcnt(22)
    v_mfma_f32_32x32x16_bf16 v[32:47], v[148:151], v[52:55], 0
    buffer_load_dwordx4 v[48:51], v2, s[8:11], s52 offen offset:2048 sc1
    s_waitcnt vmcnt(22)
    v_mfma_f32_32x32x16_bf16 v[32:47], v[152:155], v[56:59], v[32:47]
    buffer_load_dwordx4 v[52:55], v2, s[8:11], s52 offen offset:3072 sc1
    s_add_u32 s52, s52, 4096
    s_waitcnt vmcnt(22)
    v_mfma_f32_32x32x16_bf16 v[32:47], v[156:159], v[60:63], v[32:47]
    buffer_load_dwordx4 v[56:59], v2, s[8:11], s52 offen offset:0 sc1
    s_waitcnt vmcnt(22)
    v_mfma_f32_32x32x16_bf16 v[32:47], v[160:163], v[64:67], v[32:47]
    buffer_load_dwordx4 v[60:63], v2, s[8:11], s52 offen offset:1024 sc1
    s_waitcnt vmcnt(22)
    v_mfma_f32_32x32x16_bf16 v[32:47], v[164:167], v[68:71], v[32:47]
    buffer_load_dwordx4 v[64:67], v2, s[8:11], s52 offen offset:2048 sc1
    v_min_u32 v3, v3, v4
    s_nop 0
    v_readfirstlane_b32 s24, v3
    s_nop 0
    s_cmp_gt_u32 s24, s28
    s_cbranch_scc1 F_OP_FAST
    s_waitcnt vmcnt(22)
    v_mfma_f32_32x32x16_bf16 v[32:47], v[168:171], v[72:75], v[32:47]
    s_waitcnt vmcnt(21)
    v_mfma_f32_32x32x16_bf16 v[32:47], v[172:175], v[76:79], v[32:47]
    s_waitcnt vmcnt(20)
    v_mfma_f32_32x32x16_bf16 v[32:47], v[176:179], v[80:83], v[32:47]
    s_waitcnt vmcnt(19)
    v_mfma_f32_32x32x16_bf16 v[32:47], v[180:183], v[84:87], v[32:47]
    s_waitcnt vmcnt(18)
    v_mfma_f32_32x32x16_bf16 v[32:47], v[184:187], v[88:91], v[32:47]
    s_waitcnt vmcnt(17)
    v_mfma_f32_32x32x16_bf16 v[32:47], v[188:191], v[92:95], v[32:47]
    s_waitcnt vmcnt(16)
    v_mfma_f32_32x32x16_bf16 v[32:47], v[192:195], v[96:99], v[32:47]
    s_waitcnt vmcnt(15)
    v_mfma_f32_32x32x16_bf16 v[32:47], v[196:199], v[100:103], v[32:47]
    s_waitcnt vmcnt(14)
    v_mfma_f32_32x32x16_bf16 v[32:47], v[200:203], v[104:107], v[32:47]
    s_waitcnt vmcnt(13)
    v_mfma_f32_32x32x16_bf16 v[32:47], v[204:207], v[108:111], v[32:47]
    s_waitcnt vmcnt(12)
    v_mfma_f32_32x32x16_bf16 v[32:47], v[208:211], v[112:115], v[32:47]
    s_waitcnt vmcnt(11)
    v_mfma_f32_32x32x16_bf16 v[32:47], v[212:215], v[116:119], v[32:47]
    s_waitcnt vmcnt(10)
    v_mfma_f32_32x32x16_bf16 v[32:47], v[216:219], v[120:123], v[32:47]
    s_waitcnt vmcnt(9)
    v_mfma_f32_32x32x16_bf16 v[32:47], v[220:223], v[124:127], v[32:47]
    s_waitcnt vmcnt(8)
    v_mfma_f32_32x32x16_bf16 v[32:47], v[224:227], v[128:131], v[32:47]
    s_waitcnt vmcnt(7)
    v_mfma_f32_32x32x16_bf16 v[32:47], v[228:231], v[132:135], v[32:47]
    s_waitcnt vmcnt(5)
    v_mfma_f32_32x32x16_bf16 v[32:47], v[232:235], v[136:139], v[32:47]
    s_waitcnt vmcnt(4)
    v_mfma_f32_32x32x16_bf16 v[32:47], v[236:239], v[48:51], v[32:47]
    s_waitcnt vmcnt(3)
    v_mfma_f32_32x32x16_bf16 v[32:47], v[240:243], v[52:55], v[32:47]
    s_waitcnt vmcnt(2)
    v_mfma_f32_32x32x16_bf16 v[32:47], v[244:247], v[56:59], v[32:47]
    s_waitcnt vmcnt(1)
    v_mfma_f32_32x32x16_bf16 v[32:47], v[248:251], v[60:63], v[32:47]
    s_waitcnt vmcnt(0)
    v_mfma_f32_32x32x16_bf16 v[32:47], v[252:255], v[64:67], v[32:47]
F_OP_POLL:
    buffer_load_dword v3, off, s[8:11], s29 sc1
    buffer_load_dword v4, off, s[8:11], s29 offset:128 sc1
    s_waitcnt vmcnt(0)
    v_min_u32 v3, v3, v4
    s_nop 0
    v_readfirstlane_b32 s24, v3
    s_nop 0
    s_cmp_gt_u32 s24, s28
    s_cbranch_scc1 F_OP_GO
    s_sleep 1
    s_sub_u32 s27, s27, 1
    s_cbranch_scc0 F_OP_POLL
    s_branch F_FAIL
F_OP_GO:
    buffer_load_dwordx4 v[68:71], v2, s[8:11], s51 offen offset:0 sc1
    buffer_load_dwordx4 v[72:75], v2, s[8:11], s51 offen offset:1024 sc1
    buffer_load_dwordx4 v[76:79], v2, s[8:11], s51 offen offset:2048 sc1
    buffer_load_dwordx4 v[80:83], v2, s[8:11], s51 offen offset:3072 sc1
    s_add_u32 s51, s51, 4096
    buffer_load_dwordx4 v[84:87], v2, s[8:11], s51 offen offset:0 sc1
    buffer_load_dwordx4 v[88:91], v2, s[8:11], s51 offen offset:1024 sc1
    buffer_load_dwordx4 v[92:95], v2, s[8:11], s51 offen offset:2048 sc1
    buffer_load_dwordx4 v[96:99], v2, s[8:11], s51 offen offset:3072 sc1
    s_add_u32 s51, s51, 12288
    buffer_load_dwordx4 v[100:103], v2, s[8:11], s51 offen offset:0 sc1
    buffer_load_dwordx4 v[104:107], v2, s[8:11], s51 offen offset:1024 sc1
    buffer_load_dwordx4 v[108:111], v2, s[8:11], s51 offen offset:2048 sc1
    buffer_load_dwordx4 v[112:115], v2, s[8:11], s51 offen offset:3072 sc1
    s_add_u32 s51, s51, 4096
    buffer_load_dwordx4 v[116:119], v2, s[8:11], s51 offen offset:0 sc1
    buffer_load_dwordx4 v[120:123], v2, s[8:11], s51 offen offset:1024 sc1
    buffer_load_dwordx4 v[124:127], v2, s[8:11], s51 offen offset:2048 sc1
    buffer_load_dwordx4 v[128:131], v2, s[8:11], s51 offen offset:3072 sc1
    s_add_u32 s51, s51, 12288
    buffer_load_dwordx4 v[132:135], v2, s[8:11], s51 offen offset:0 sc1
    buffer_load_dwordx4 v[136:139], v2, s[8:11], s51 offen offset:1024 sc1
    buffer_load_dwordx4 v[48:51], v2, s[8:11], s51 offen offset:2048 sc1
    buffer_load_dwordx4 v[52:55], v2, s[8:11], s51 offen offset:3072 sc1
    s_add_u32 s51, s51, 4096
    buffer_load_dwordx4 v[56:59], v2, s[8:11], s51 offen offset:0 sc1
    buffer_load_dwordx4 v[60:63], v2, s[8:11], s51 offen offset:1024 sc1
    s_branch F_OP_O
F_OP_FAST:
    s_waitcnt vmcnt(22)
    v_mfma_f32_32x32x16_bf16 v[32:47], v[168:171], v[72:75], v[32:47]
    buffer_load_dwordx4 v[68:71], v2, s[8:11], s51 offen offset:0 sc1
    s_waitcnt vmcnt(22)
    v_mfma_f32_32x32x16_bf16 v[32:47], v[172:175], v[76:79], v[32:47]
    buffer_load_dwordx4 v[72:75], v2, s[8:11], s51 offen offset:1024 sc1
    s_waitcnt vmcnt(22)
    v_mfma_f32_32x32x16_bf16 v[32:47], v[176:179], v[80:83], v[32:47]
    buffer_load_dwordx4 v[76:79], v2, s[8:11], s51 offen offset:2048 sc1
    s_waitcnt vmcnt(22)
    v_mfma_f32_32x32x16_bf16 v[32:47], v[180:183], v[84:87], v[32:47]
    buffer_load_dwordx4 v[80:83], v2, s[8:11], s51 offen offset:3072 sc1
    s_add_u32 s51, s51, 4096
    s_waitcnt vmcnt(22)
    v_mfma_f32_32x32x16_bf16 v[32:47], v[184:187], v[88:91], v[32:47]
    buffer_load_dwordx4 v[84:87], v2, s[8:11], s51 offen offset:0 sc1
    s_waitcnt vmcnt(22)
    v_mfma_f32_32x32x16_bf16 v[32:47], v[188:191], v[92:95], v[32:47]
    buffer_load_dwordx4 v[88:91], v2, s[8:11], s51 offen offset:1024 sc1
    s_waitcnt vmcnt(22)
    v_mfma_f32_32x32x16_bf16 v[32:47], v[192:195], v[96:99], v[32:47]
    buffer_load_dwordx4 v[92:95], v2, s[8:11], s51 offen offset:2048 sc1
    s_waitcnt vmcnt(22)
    v_mfma_f32_32x32x16_bf16 v[32:47], v[196:199], v[100:103], v[32:47]
    buffer_load_dwordx4 v[96:99], v2, s[8:11], s51 offen offset:3072 sc1
    s_add_u32 s51, s51, 12288
    s_waitcnt vmcnt(22)
    v_mfma_f32_32x32x16_bf16 v[32:47], v[200:203], v[104:107], v[32:47]
    buffer_load_dwordx4 v[100:103], v2, s[8:11], s51 offen offset:0 sc1
    s_waitcnt vmcnt(22)
    v_mfma_f32_32x32x16_bf16 v[32:47], v[204:207], v[108:111], v[32:47]
    buffer_load_dwordx4 v[104:107], v2, s[8:11], s51 offen offset:1024 sc1
    s_waitcnt vmcnt(22)
    v_mfma_f32_32x32x16_bf16 v[32:47], v[208:211], v[112:115], v[32:47]
    buffer_load_dwordx4 v[108:111], v2, s[8:11], s51 offen offset:2048 sc1
    s_waitcnt vmcnt(22)
    v_mfma_f32_32x32x16_bf16 v[32:47], v[212:215], v[116:119], v[32:47]
    buffer_load_dwordx4 v[112:115], v2, s[8:11], s51 offen offset:3072 sc1
    s_add_u32 s51, s51, 4096
    s_waitcnt vmcnt(22)
    v_mfma_f32_32x32x16_bf16 v[32:47], v[216:219], v[120:123], v[32:47]
    buffer_load_dwordx4 v[116:119], v2, s[8:11], s51 offen offset:0 sc1
    s_waitcnt vmcnt(22)
    v_mfma_f32_32x32x16_bf16 v[32:47], v[220:223], v[124:127], v[32:47]
    buffer_load_dwordx4 v[120:123], v2, s[8:11], s51 offen offset:1024 sc1
    s_waitcnt vmcnt(22)
    v_mfma_f32_32x32x16_bf16 v[32:47], v[224:227], v[128:131], v[32:47]
    buffer_load_dwordx4 v[124:127], v2, s[8:11], s51 offen offset:2048 sc1
    s_waitcnt vmcnt(22)
    v_mfma_f32_32x32x16_bf16 v[32:47], v[228:231], v[132:135], v[32:47]
    buffer_load_dwordx4 v[128:131], v2, s[8:11], s51 offen offset:3072 sc1
    s_add_u32 s51, s51, 12288
    s_waitcnt vmcnt(21)
    v_mfma_f32_32x32x16_bf16 v[32:47], v[232:235], v[136:139], v[32:47]
    buffer_load_dwordx4 v[132:135], v2, s[8:11], s51 offen offset:0 sc1
    s_waitcnt vmcnt(21)
    v_mfma_f32_32x32x16_bf16 v[32:47], v[236:239], v[48:51], v[32:47]
    buffer_load_dwordx4 v[136:139], v2, s[8:11], s51 offen offset:1024 sc1
    s_waitcnt vmcnt(21)
    v_mfma_f32_32x32x16_bf16 v[32:47], v[240:243], v[52:55], v[32:47]
    buffer_load_dwordx4 v[48:51], v2, s[8:11], s51 offen offset:2048 sc1
    s_waitcnt vmcnt(21)
    v_mfma_f32_32x32x16_bf16 v[32:47], v[244:247], v[56:59], v[32:47]
    buffer_load_dwordx4 v[52:55], v2, s[8:11], s51 offen offset:3072 sc1
    s_add_u32 s51, s51, 4096
    s_waitcnt vmcnt(21)
    v_mfma_f32_32x32x16_bf16 v[32:47], v[248:251], v[60:63], v[32:47]
    buffer_load_dwordx4 v[56:59], v2, s[8:11], s51 offen offset:0 sc1
    s_waitcnt vmcnt(21)
    v_mfma_f32_32x32x16_bf16 v[32:47], v[252:255], v[64:67], v[32:47]
    buffer_load_dwordx4 v[60:63], v2, s[8:11], s51 offen offset:1024 sc1
F_OP_O:
    s_waitcnt vmcnt(21)
    v_mfma_f32_32x32x16_bf16 v[16:31], a[0:3], v[68:71], 0
    buffer_load_dwordx4 v[64:67], v2, s[8:11], s51 offen offset:2048 sc1
    s_waitcnt vmcnt(21)
    v_mfma_f32_32x32x16_bf16 v[16:31], a[4:7], v[72:75], v[16:31]
    buffer_load_dwordx4 v[68:71], v2, s[8:11], s51 offen offset:3072 sc1
    s_add_u32 s51, s51, 12288
    s_waitcnt vmcnt(21)
    v_mfma_f32_32x32x16_bf16 v[16:31], a[8:11], v[76:79], v[16:31]
    buffer_load_dwordx4 v[72:75], v2, s[8:11], s51 offen offset:0 sc1
    s_waitcnt vmcnt(21)
    v_mfma_f32_32x32x16_bf16 v[16:31], a[12:15], v[80:83], v[16:31]
    buffer_load_dwordx4 v[76:79], v2, s[8:11], s51 offen offset:1024 sc1
    s_waitcnt vmcnt(21)
    v_mfma_f32_32x32x16_bf16 v[16:31], a[16:19], v[84:87], v[16:31]
    buffer_load_dwordx4 v[80:83], v2, s[8:11], s51 offen offset:2048 sc1
    s_waitcnt vmcnt(21)
    v_mfma_f32_32x32x16_bf16 v[16:31], a[20:23], v[88:91], v[16:31]
    buffer_load_dwordx4 v[84:87], v2, s[8:11], s51 offen offset:3072 sc1
    s_add_u32 s51, s51, 4096
    s_waitcnt vmcnt(21)
    v_mfma_f32_32x32x16_bf16 v[16:31], a[24:27], v[92:95], v[16:31]
    buffer_load_dwordx4 v[88:91], v2, s[8:11], s51 offen offset:0 sc1
    s_waitcnt vmcnt(21)
    v_mfma_f32_32x32x16_bf16 v[16:31], a[28:31], v[96:99], v[16:31]
    buffer_load_dwordx4 v[92:95], v2, s[8:11], s51 offen offset:1024 sc1
    s_waitcnt vmcnt(21)
    v_mfma_f32_32x32x16_bf16 v[16:31], a[32:35], v[100:103], v[16:31]
    buffer_load_dwordx4 v[96:99], v2, s[8:11], s51 offen offset:2048 sc1
    s_waitcnt vmcnt(21)
    v_mfma_f32_32x32x16_bf16 v[16:31], a[36:39], v[104:107], v[16:31]
    buffer_load_dwordx4 v[100:103], v2, s[8:11], s51 offen offset:3072 sc1
    s_add_u32 s51, s51, 12288
    s_waitcnt vmcnt(21)
    v_mfma_f32_32x32x16_bf16 v[16:31], a[40:43], v[108:111], v[16:31]
    buffer_load_dwordx4 v[104:107], v2, s[8:11], s51 offen offset:0 sc1
    s_waitcnt vmcnt(21)
    v_mfma_f32_32x32x16_bf16 v[16:31], a[44:47], v[112:115], v[16:31]
    buffer_load_dwordx4 v[108:111], v2, s[8:11], s51 offen offset:1024 sc1
    s_waitcnt vmcnt(21)
    v_mfma_f32_32x32x16_bf16 v[16:31], a[48:51], v[116:119], v[16:31]
    buffer_load_dwordx4 v[112:115], v2, s[8:11], s51 offen offset:2048 sc1
    s_waitcnt vmcnt(21)
    v_mfma_f32_32x32x16_bf16 v[16:31], a[52:55], v[120:123], v[16:31]
    buffer_load_dwordx4 v[116:119], v2, s[8:11], s51 offen offset:3072 sc1
    s_add_u32 s51, s51, 4096
    s_waitcnt vmcnt(21)
    v_mfma_f32_32x32x16_bf16 v[16:31], a[56:59], v[124:127], v[16:31]
    buffer_load_dwordx4 v[120:123], v2, s[8:11], s51 offen offset:0 sc1
    s_waitcnt vmcnt(21)
    v_mfma_f32_32x32x16_bf16 v[16:31], a[60:63], v[128:131], v[16:31]
    buffer_load_dwordx4 v[124:127], v2, s[8:11], s51 offen offset:1024 sc1
    s_waitcnt vmcnt(21)
    v_mfma_f32_32x32x16_bf16 v[16:31], a[64:67], v[132:135], v[16:31]
    buffer_load_dwordx4 v[128:131], v2, s[8:11], s51 offen offset:2048 sc1
    s_waitcnt vmcnt(21)
    v_mfma_f32_32x32x16_bf16 v[16:31], a[68:71], v[136:139], v[16:31]
    buffer_load_dwordx4 v[132:135], v2, s[8:11], s51 offen offset:3072 sc1
    s_add_u32 s51, s51, 12288
    s_waitcnt vmcnt(21)
    v_mfma_f32_32x32x16_bf16 v[16:31], a[72:75], v[48:51], v[16:31]
    buffer_load_dwordx4 v[136:139], v2, s[8:11], s51 offen offset:0 sc1
    s_waitcnt vmcnt(21)
    v_mfma_f32_32x32x16_bf16 v[16:31], a[76:79], v[52:55], v[16:31]
    buffer_load_dwordx4 v[48:51], v2, s[8:11], s51 offen offset:1024 sc1
    s_waitcnt vmcnt(21)
    v_mfma_f32_32x32x16_bf16 v[16:31], a[80:83], v[56:59], v[16:31]
    buffer_load_dwordx4 v[52:55], v2, s[8:11], s51 offen offset:2048 sc1
    s_waitcnt vmcnt(21)
    v_mfma_f32_32x32x16_bf16 v[16:31], a[84:87], v[60:63], v[16:31]
    buffer_load_dwordx4 v[56:59], v2, s[8:11], s51 offen offset:3072 sc1
    s_add_u32 s51, s51, 4096
    s_waitcnt vmcnt(21)
    v_mfma_f32_32x32x16_bf16 v[16:31], a[88:91], v[64:67], v[16:31]
    buffer_load_dwordx4 v[60:63], v2, s[8:11], s51 offen offset:0 sc1
    s_waitcnt vmcnt(21)
    v_mfma_f32_32x32x16_bf16 v[16:31], a[92:95], v[68:71], v[16:31]
    buffer_load_dwordx4 v[64:67], v2, s[8:11], s51 offen offset:1024 sc1
    s_waitcnt vmcnt(21)
    v_mfma_f32_32x32x16_bf16 v[16:31], a[96:99], v[72:75], v[16:31]
    buffer_load_dwordx4 v[68:71], v2, s[8:11], s51 offen offset:2048 sc1
    s_waitcnt vmcnt(21)
    v_mfma_f32_32x32x16_bf16 v[16:31], a[100:103], v[76:79], v[16:31]
    buffer_load_dwordx4 v[72:75], v2, s[8:11], s51 offen offset:3072 sc1
    s_add_u32 s51, s51, 12288
    s_waitcnt vmcnt(21)
    v_mfma_f32_32x32x16_bf16 v[16:31], a[104:107], v[80:83], v[16:31]
    buffer_load_dwordx4 v[76:79], v2, s[8:11], s51 offen offset:0 sc1
    s_waitcnt vmcnt(21)
    v_mfma_f32_32x32x16_bf16 v[16:31], a[108:111], v[84:87], v[16:31]
    buffer_load_dwordx4 v[80:83], v2, s[8:11], s51 offen offset:1024 sc1
    s_waitcnt vmcnt(21)
    v_mfma_f32_32x32x16_bf16 v[16:31], a[112:115], v[88:91], v[16:31]
    buffer_load_dwordx4 v[84:87], v2, s[8:11], s51 offen offset:2048 sc1
    s_waitcnt vmcnt(21)
    v_mfma_f32_32x32x16_bf16 v[16:31], a[116:119], v[92:95], v[16:31]
    buffer_load_dwordx4 v[88:91], v2, s[8:11], s51 offen offset:3072 sc1
    s_add_u32 s51, s51, 4096
    s_waitcnt vmcnt(21)
    v_mfma_f32_32x32x16_bf16 v[16:31], a[120:123], v[96:99], v[16:31]
    buffer_load_dwordx4 v[92:95], v2, s[8:11], s51 offen offset:0 sc1
    s_waitcnt vmcnt(21)
    v_mfma_f32_32x32x16_bf16 v[16:31], a[124:127], v[100:103], v[16:31]
    buffer_load_dwordx4 v[96:99], v2, s[8:11], s51 offen offset:1024 sc1
    s_waitcnt vmcnt(21)
    v_mfma_f32_32x32x16_bf16 v[16:31], a[128:131], v[104:107], v[16:31]
    buffer_load_dwordx4 v[100:103], v2, s[8:11], s51 offen offset:2048 sc1
    s_waitcnt vmcnt(21)
    v_mfma_f32_32x32x16_bf16 v[16:31], a[132:135], v[108:111], v[16:31]
    buffer_load_dwordx4 v[104:107], v2, s[8:11], s51 offen offset:3072 sc1
    s_add_u32 s51, s51, 12288
    s_waitcnt vmcnt(21)
    v_mfma_f32_32x32x16_bf16 v[16:31], a[136:139], v[112:115], v[16:31]
    buffer_load_dwordx4 v[108:111], v2, s[8:11], s51 offen offset:0 sc1
    s_waitcnt vmcnt(21)
    v_mfma_f32_32x32x16_bf16 v[16:31], a[140:143], v[116:119], v[16:31]
    buffer_load_dwordx4 v[112:115], v2, s[8:11], s51 offen offset:1024 sc1
    s_waitcnt vmcnt(21)
    v_mfma_f32_32x32x16_bf16 v[16:31], a[144:147], v[120:123], v[16:31]
    buffer_load_dwordx4 v[116:119], v2, s[8:11], s51 offen offset:2048 sc1
    s_waitcnt vmcnt(21)
    v_mfma_f32_32x32x16_bf16 v[16:31], a[148:151], v[124:127], v[16:31]
    buffer_load_dwordx4 v[120:123], v2, s[8:11], s51 offen offset:3072 sc1
    s_add_u32 s51, s51, 4096
    s_waitcnt vmcnt(21)
    v_mfma_f32_32x32x16_bf16 v[16:31], a[152:155], v[128:131], v[16:31]
    buffer_load_dwordx4 v[124:127], v2, s[8:11], s51 offen offset:0 sc1
    s_waitcnt vmcnt(21)
    v_mfma_f32_32x32x16_bf16 v[16:31], a[156:159], v[132:135], v[16:31]
    buffer_load_dwordx4 v[128:131], v2, s[8:11], s51 offen offset:1024 sc1
    s_waitcnt vmcnt(21)
    v_mfma_f32_32x32x16_bf16 v[16:31], a[160:163], v[136:139], v[16:31]
    buffer_load_dwordx4 v[132:135], v2, s[8:11], s51 offen offset:2048 sc1
    s_waitcnt vmcnt(21)
    v_mfma_f32_32x32x16_bf16 v[16:31], a[164:167], v[48:51], v[16:31]
    buffer_load_dwordx4 v[136:139], v2, s[8:11], s51 offen offset:3072 sc1
    s_add_u32 s51, s51, 12288
    s_waitcnt vmcnt(21)
    v_mfma_f32_32x32x16_bf16 v[16:31], a[168:171], v[52:55], v[16:31]
    s_add_u32 s54, s54, 6
    buffer_load_dword v3, off, s[8:11], s29 sc1
    buffer_load_dword v4, off, s[8:11], s29 offset:128 sc1
    s_cmp_lt_u32 s54, 64
    s_cselect_b32 s25, s54, s28
    s_mul_i32 s52, s25, 110592
    s_mul_i32 s24, s5, 27648
    s_add_u32 s52, s52, s24
    s_add_u32 s52, s52, 0x4000000
    s_lshl_b32 s26, s25, 7
    s_add_u32 s26, s26, 0x5000000
    buffer_load_dword v48, v9, s[8:11], s26 offen sc1
    s_waitcnt vmcnt(23)
    v_mfma_f32_32x32x16_bf16 v[16:31], a[172:175], v[56:59], v[16:31]
    buffer_load_dwordx4 v[52:55], v2, s[8:11], s52 offen offset:0 sc1
    s_waitcnt vmcnt(23)
    v_mfma_f32_32x32x16_bf16 v[16:31], a[176:179], v[60:63], v[16:31]
    buffer_load_dwordx4 v[56:59], v2, s[8:11], s52 offen offset:1024 sc1
    s_waitcnt vmcnt(23)
    v_mfma_f32_32x32x16_bf16 v[16:31], a[180:183], v[64:67], v[16:31]
    buffer_load_dwordx4 v[60:63], v2, s[8:11], s52 offen offset:2048 sc1
    s_waitcnt vmcnt(23)
    v_mfma_f32_32x32x16_bf16 v[16:31], a[184:187], v[68:71], v[16:31]
    buffer_load_dwordx4 v[64:67], v2, s[8:11], s52 offen offset:3072 sc1
    s_add_u32 s52, s52, 4096
    s_waitcnt vmcnt(23)
    v_mfma_f32_32x32x16_bf16 v[16:31], a[188:191], v[72:75], v[16:31]
    buffer_load_dwordx4 v[68:71], v2, s[8:11], s52 offen offset:0 sc1
    s_waitcnt vmcnt(23)
    v_mfma_f32_32x32x16_bf16 v[16:31], a[192:195], v[76:79], v[16:31]
    buffer_load_dwordx4 v[72:75], v2, s[8:11], s52 offen offset:1024 sc1
    s_waitcnt vmcnt(23)
    v_mfma_f32_32x32x16_bf16 v[16:31], a[196:199], v[80:83], v[16:31]
    buffer_load_dwordx4 v[76:79], v2, s[8:11], s52 offen offset:2048 sc1
    s_waitcnt vmcnt(23)
    v_mfma_f32_32x32x16_bf16 v[16:31], a[200:203], v[84:87], v[16:31]
    buffer_load_dwordx4 v[80:83], v2, s[8:11], s52 offen offset:3072 sc1
    s_add_u32 s52, s52, 4096
    s_waitcnt vmcnt(23)
    v_mfma_f32_32x32x16_bf16 v[16:31], a[204:207], v[88:91], v[16:31]
    buffer_load_dwordx4 v[84:87], v2, s[8:11], s52 offen offset:0 sc1
    s_waitcnt vmcnt(23)
    v_mfma_f32_32x32x16_bf16 v[16:31], a[208:211], v[92:95], v[16:31]
    buffer_load_dwordx4 v[88:91], v2, s[8:11], s52 offen offset:1024 sc1
    s_waitcnt vmcnt(23)
    v_mfma_f32_32x32x16_bf16 v[16:31], a[212:215], v[96:99], v[16:31]
    buffer_load_dwordx4 v[92:95], v2, s[8:11], s52 offen offset:2048 sc1
    s_waitcnt vmcnt(23)
    v_mfma_f32_32x32x16_bf16 v[16:31], a[216:219], v[100:103], v[16:31]
    buffer_load_dwordx4 v[96:99], v2, s[8:11], s52 offen offset:3072 sc1
    s_add_u32 s52, s52, 4096
    s_waitcnt vmcnt(23)
    v_mfma_f32_32x32x16_bf16 v[16:31], a[220:223], v[104:107], v[16:31]
    buffer_load_dwordx4 v[100:103], v2, s[8:11], s52 offen offset:0 sc1
    s_waitcnt vmcnt(23)
    v_mfma_f32_32x32x16_bf16 v[16:31], a[224:227], v[108:111], v[16:31]
    buffer_load_dwordx4 v[104:107], v2, s[8:11], s52 offen offset:1024 sc1
    s_waitcnt vmcnt(23)
    v_mfma_f32_32x32x16_bf16 v[16:31], a[228:231], v[112:115], v[16:31]
    buffer_load_dwordx4 v[108:111], v2, s[8:11], s52 offen offset:2048 sc1
    s_waitcnt vmcnt(23)
    v_mfma_f32_32x32x16_bf16 v[16:31], a[232:235], v[116:119], v[16:31]
    buffer_load_dwordx4 v[112:115], v2, s[8:11], s52 offen offset:3072 sc1
    s_add_u32 s52, s52, 4096
    s_waitcnt vmcnt(23)
    v_mfma_f32_32x32x16_bf16 v[16:31], a[236:239], v[120:123], v[16:31]
    buffer_load_dwordx4 v[116:119], v2, s[8:11], s52 offen offset:0 sc1
    s_waitcnt vmcnt(23)
    v_mfma_f32_32x32x16_bf16 v[16:31], a[240:243], v[124:127], v[16:31]
    buffer_load_dwordx4 v[120:123], v2, s[8:11], s52 offen offset:1024 sc1
    s_waitcnt vmcnt(23)
    v_mfma_f32_32x32x16_bf16 v[16:31], a[244:247], v[128:131], v[16:31]
    buffer_load_dwordx4 v[124:127], v2, s[8:11], s52 offen offset:2048 sc1
    s_waitcnt vmcnt(23)
    v_mfma_f32_32x32x16_bf16 v[16:31], a[248:251], v[132:135], v[16:31]
    buffer_load_dwordx4 v[128:131], v2, s[8:11], s52 offen offset:3072 sc1
    s_add_u32 s52, s52, 4096
    s_waitcnt vmcnt(23)
    v_mfma_f32_32x32x16_bf16 v[16:31], a[252:255], v[136:139], v[16:31]
    buffer_load_dwordx4 v[132:135], v2, s[8:11], s52 offen offset:0 sc1
    v_sub_f32 v13, 1.0, v12
    v_mul_f32 v32, v32, v13
    v_mul_f32 v33, v33, v13
    v_mul_f32 v34, v34, v13
    v_mul_f32 v35, v35, v13
    v_mul_f32 v36, v36, v13
    v_mul_f32 v37, v37, v13
    v_mul_f32 v38, v38, v13
    v_mul_f32 v39, v39, v13
    v_mul_f32 v40, v40, v13
    v_mul_f32 v41, v41, v13
    v_mul_f32 v42, v42, v13
    v_mul_f32 v43, v43, v13
    v_mul_f32 v44, v44, v13
    v_mul_f32 v45, v45, v13
    v_mul_f32 v46, v46, v13
    v_mul_f32 v47, v47, v13
    v_fmac_f32 v32, v16, v12
    v_fmac_f32 v33, v17, v12
    v_fmac_f32 v34, v18, v12
    v_fmac_f32 v35, v19, v12
    v_fmac_f32 v36, v20, v12
    v_fmac_f32 v37, v21, v12
    v_fmac_f32 v38, v22, v12
    v_fmac_f32 v39, v23, v12
    v_fmac_f32 v40, v24, v12
    v_fmac_f32 v41, v25, v12
    v_fmac_f32 v42, v26, v12
    v_fmac_f32 v43, v27, v12
    v_fmac_f32 v44, v28, v12
    v_fmac_f32 v45, v29, v12
    v_fmac_f32 v46, v30, v12
    v_fmac_f32 v47, v31, v12
    ds_write_b128 v10, v[32:35] offset:0
    ds_write_b128 v10, v[36:39] offset:1024
    ds_write_b128 v10, v[40:43] offset:2048
    ds_write_b128 v10, v[44:47] offset:3072
    s_waitcnt lgkmcnt(0)
    s_barrier
    ds_read_b128 v[16:19], v11 offset:0
    ds_read_b128 v[20:23], v11 offset:4096
    ds_read_b128 v[24:27], v11 offset:8192
    ds_read_b128 v[28:31], v11 offset:12288
    v_xor_b32 v10, 0x4000, v10
    v_xor_b32 v11, 0x4000, v11
    s_mul_i32 s24, s28, 40960
    s_waitcnt lgkmcnt(0)
    v_add_f32 v16, v16, v20
    v_add_f32 v24, v24, v28
    v_add_f32 v17, v17, v21
    v_add_f32 v25, v25, v29
    v_add_f32 v18, v18, v22
    v_add_f32 v26, v26, v30
    v_add_f32 v19, v19, v23
    v_add_f32 v27, v27, v31
    v_add_f32 v16, v16, v24
    v_add_f32 v17, v17, v25
    v_add_f32 v18, v18, v26
    v_add_f32 v19, v19, v27
    v_cvt_pk_bf16_f32 v14, v16, v17
    v_cvt_pk_bf16_f32 v15, v18, v19
    buffer_store_dwordx2 v[14:15], v8, s[40:43], s24 offen
    s_mov_b32 s28, s54
    s_cmp_lt_u32 s28, 64
    s_cbranch_scc1 F_OP_LOOP
    s_branch F_END
F_AT:
    s_sub_u32 s30, s4, 20
    s_lshl_b32 s30, s30, 2
    s_add_u32 s30, s30, s5
    s_lshl_b32 s33, s30, 14
    s_add_u32 s33, s33, 0x5400800
    v_and_b32 v3, 1, v1
    v_bfe_u32 v4, v1, 1, 1
    v_lshlrev_b32 v3, 20, v3
    v_lshl_add_u32 v255, v4, 12, v3
    s_and_b32 s24, s60, 1
    s_lshl_b32 s24, s24, 13
    s_add_u32 s33, s33, s24
    v_and_b32 v3, 31, v1
    v_lshrrev_b32 v4, 5, v1
    v_lshlrev_b32 v5, 4, v3
    v_and_b32 v251, 15, v1
    v_lshlrev_b32 v251, 2, v251
    v_lshl_add_u32 v251, v4, 7, v251
    v_bfe_u32 v250, v1, 4, 1
    v_lshl_add_u32 v251, v250, 8, v251
    v_lshrrev_b32 v250, 1, v3
    v_lshlrev_b32 v250, 6, v250
    v_lshl_add_u32 v250, v4, 5, v250
    v_mov_b32 v254, 0x05040100
    v_mov_b32 v5, 0x07060302
    v_and_b32 v252, 1, v1
    v_cmp_eq_u32 vcc, 1, v252
    s_nop 1
    v_cndmask_b32 v254, v254, v5, vcc
    v_mov_b32 v5, 0x80000000
    v_cmp_gt_u32 vcc, 8, v3
    s_nop 1
    v_cndmask_b32 v250, v5, v250, vcc
    v_lshlrev_b32 v4, 2, v4
    v_sub_u32 v3, v3, v4
    v_mov_b32 v4, 0xf149f2ca
    v_mov_b32 v5, 0
    v_cmp_gt_i32 vcc, 0, v3
    s_nop 1
    v_cndmask_b32 v152, v5, v4, vcc
    v_cmp_gt_i32 vcc, 1, v3
    s_nop 1
    v_cndmask_b32 v153, v5, v4, vcc
    v_cmp_gt_i32 vcc, 2, v3
    s_nop 1
    v_cndmask_b32 v154, v5, v4, vcc
    v_cmp_gt_i32 vcc, 3, v3
    s_nop 1
    v_cndmask_b32 v155, v5, v4, vcc
    v_cmp_gt_i32 vcc, 8, v3
    s_nop 1
    v_cndmask_b32 v156, v5, v4, vcc
    v_cmp_gt_i32 vcc, 9, v3
    s_nop 1
    v_cndmask_b32 v157, v5, v4, vcc
    v_cmp_gt_i32 vcc, 10, v3
    s_nop 1
    v_cndmask_b32 v158, v5, v4, vcc
    v_cmp_gt_i32 vcc, 11, v3
    s_nop 1
    v_cndmask_b32 v159, v5, v4, vcc
    v_cmp_gt_i32 vcc, 16, v3
    s_nop 1
    v_cndmask_b32 v160, v5, v4, vcc
    v_cmp_gt_i32 vcc, 17, v3
    s_nop 1
    v_cndmask_b32 v161, v5, v4, vcc
    v_cmp_gt_i32 vcc, 18, v3
    s_nop 1
    v_cndmask_b32 v162, v5, v4, vcc
    v_cmp_gt_i32 vcc, 19, v3
    s_nop 1
    v_cndmask_b32 v163, v5, v4, vcc
    v_cmp_gt_i32 vcc, 24, v3
    s_nop 1
    v_cndmask_b32 v164, v5, v4, vcc
    v_cmp_gt_i32 vcc, 25, v3
    s_nop 1
    v_cndmask_b32 v165, v5, v4, vcc
    v_cmp_gt_i32 vcc, 26, v3
    s_nop 1
    v_cndmask_b32 v166, v5, v4, vcc
    v_cmp_gt_i32 vcc, 27, v3
    s_nop 1
    v_cndmask_b32 v167, v5, v4, vcc
F_ATW:
    buffer_load_dword v3, off, s[12:15], 0 offset:0 sc1
    buffer_load_dword v4, off, s[12:15], 0 offset:16 sc1
    s_waitcnt vmcnt(0)
    v_readfirstlane_b32 s24, v3
    v_readfirstlane_b32 s25, v4
    s_cmp_ge_u32 s24, 64
    s_cselect_b32 s25, s25, 0
    s_cmp_ge_u32 s25, 192
    s_cbranch_scc1 F_ATW_OK
    s_sleep 8
    s_sub_u32 s27, s27, 1
    s_cbranch_scc0 F_ATW
    s_branch F_FAIL
F_ATW_OK:
    s_mov_b32 s28, s3
F_AT_LOOP:
    s_lshl_b32 s24, s28, 5
    s_add_u32 s24, s24, s30
    s_lshl_b32 s31, s24, 14
    s_lshr_b32 s24, s28, 2
    s_xor_b32 s24, s24, s60
    s_and_b32 s24, s24, 1
    s_lshl_b32 s24, s24, 13
    s_xor_b32 s31, s31, s24
    s_xor_b32 s34, s31, 8192
    s_add_u32 s32, s31, 0x6001000
    s_add_u32 s24, s31, 0x0
    buffer_load_dwordx4 v[48:51], v2, s[8:11], s24 offen offset:0 sc1
    buffer_load_dwordx4 v[52:55], v2, s[8:11], s24 offen offset:1024 sc1
    buffer_load_dwordx4 v[56:59], v2, s[8:11], s24 offen offset:2048 sc1
    buffer_load_dwordx4 v[60:63], v2, s[8:11], s24 offen offset:3072 sc1
    s_add_u32 s24, s31, 0x1000
    buffer_load_dwordx4 v[64:67], v2, s[8:11], s24 offen offset:0 sc1
    buffer_load_dwordx4 v[68:71], v2, s[8:11], s24 offen offset:1024 sc1
    buffer_load_dwordx4 v[72:75], v2, s[8:11], s24 offen offset:2048 sc1
    buffer_load_dwordx4 v[76:79], v2, s[8:11], s24 offen offset:3072 sc1
    s_add_u32 s24, s34, 0x0
    buffer_load_dwordx4 v[16:19], v2, s[8:11], s24 offen offset:0 sc1
    buffer_load_dwordx4 v[20:23], v2, s[8:11], s24 offen offset:1024 sc1
    buffer_load_dwordx4 v[24:27], v2, s[8:11], s24 offen offset:2048 sc1
    buffer_load_dwordx4 v[28:31], v2, s[8:11], s24 offen offset:3072 sc1
    s_add_u32 s24, s34, 0x1000
    buffer_load_dwordx4 v[32:35], v2, s[8:11], s24 offen offset:0 sc1
    buffer_load_dwordx4 v[36:39], v2, s[8:11], s24 offen offset:1024 sc1
    buffer_load_dwordx4 v[40:43], v2, s[8:11], s24 offen offset:2048 sc1
    buffer_load_dwordx4 v[44:47], v2, s[8:11], s24 offen offset:3072 sc1
    s_add_u32 s24, s31, 0x2000000
    buffer_load_dwordx4 v[80:83], v2, s[8:11], s24 offen offset:0 sc1
    buffer_load_dwordx4 v[84:87], v2, s[8:11], s24 offen offset:1024 sc1
    buffer_load_dwordx4 v[88:91], v2, s[8:11], s24 offen offset:2048 sc1
    buffer_load_dwordx4 v[92:95], v2, s[8:11], s24 offen offset:3072 sc1
    s_add_u32 s24, s31, 0x2001000
    buffer_load_dwordx4 v[96:99], v2, s[8:11], s24 offen offset:0 sc1
    buffer_load_dwordx4 v[100:103], v2, s[8:11], s24 offen offset:1024 sc1
    buffer_load_dwordx4 v[104:107], v2, s[8:11], s24 offen offset:2048 sc1
    buffer_load_dwordx4 v[108:111], v2, s[8:11], s24 offen offset:3072 sc1
    s_waitcnt vmcnt(8)
    v_mfma_f32_32x32x16_bf16 v[168:183], v[48:51], v[16:19], v[152:167]
    v_mfma_f32_32x32x16_bf16 v[168:183], v[52:55], v[20:23], v[168:183]
    v_mfma_f32_32x32x16_bf16 v[168:183], v[56:59], v[24:27], v[168:183]
    v_mfma_f32_32x32x16_bf16 v[168:183], v[60:63], v[28:31], v[168:183]
    v_mfma_f32_32x32x16_bf16 v[168:183], v[64:67], v[32:35], v[168:183]
    v_mfma_f32_32x32x16_bf16 v[168:183], v[68:71], v[36:39], v[168:183]
    v_mfma_f32_32x32x16_bf16 v[168:183], v[72:75], v[40:43], v[168:183]
    v_mfma_f32_32x32x16_bf16 v[168:183], v[76:79], v[44:47], v[168:183]
F_AT_POLL:
    s_mov_b64 exec, 15
    buffer_load_dword v3, v255, s[8:11], s33 offen sc1
    s_mov_b64 exec, -1
    s_waitcnt vmcnt(0)
    v_readlane_b32 s36, v3, 0
    v_readlane_b32 s37, v3, 1
    v_readlane_b32 s38, v3, 2
    v_readlane_b32 s39, v3, 3
    s_max_u32 s36, s36, s37
    s_max_u32 s38, s38, s39
    s_min_u32 s24, s36, s38
    s_lshr_b32 s24, s24, 1
    s_cmp_gt_u32 s24, s28
    s_cbranch_scc1 F_AT_GO
    s_sleep 2
    s_sub_u32 s27, s27, 1
    s_cbranch_scc0 F_AT_POLL
    s_branch F_FAIL
F_AT_GO:
    buffer_load_dwordx4 v[48:51], v250, s[8:11], s32 offen offset:0 sc1
    buffer_load_dwordx4 v[52:55], v250, s[8:11], s32 offen offset:16 sc1
    buffer_load_dwordx4 v[56:59], v250, s[8:11], s32 offen offset:256 sc1
    buffer_load_dwordx4 v[60:63], v250, s[8:11], s32 offen offset:272 sc1
    buffer_load_dwordx4 v[64:67], v250, s[8:11], s32 offen offset:512 sc1
    buffer_load_dwordx4 v[68:71], v250, s[8:11], s32 offen offset:528 sc1
    buffer_load_dwordx4 v[72:75], v250, s[8:11], s32 offen offset:768 sc1
    buffer_load_dwordx4 v[76:79], v250, s[8:11], s32 offen offset:784 sc1
    buffer_load_dwordx4 v[216:219], v250, s[8:11], s32 offen offset:1024 sc1
    buffer_load_dwordx4 v[220:223], v250, s[8:11], s32 offen offset:1040 sc1
    buffer_load_dwordx4 v[224:227], v250, s[8:11], s32 offen offset:1280 sc1
    buffer_load_dwordx4 v[228:231], v250, s[8:11], s32 offen offset:1296 sc1
    buffer_load_dwordx4 v[232:235], v250, s[8:11], s32 offen offset:1536 sc1
    buffer_load_dwordx4 v[236:239], v250, s[8:11], s32 offen offset:1552 sc1
    buffer_load_dwordx4 v[240:243], v250, s[8:11], s32 offen offset:1792 sc1
    buffer_load_dwordx4 v[244:247], v250, s[8:11], s32 offen offset:1808 sc1
    s_add_u32 s24, s31, 0x6000000
    buffer_load_dword v200, v251, s[8:11], s24 offen offset:0 sc1
    buffer_load_dword v201, v251, s[8:11], s24 offen offset:64 sc1
    buffer_load_dword v202, v251, s[8:11], s24 offen offset:2048 sc1
    buffer_load_dword v203, v251, s[8:11], s24 offen offset:2112 sc1
    buffer_load_dword v204, v251, s[8:11], s24 offen offset:512 sc1
    buffer_load_dword v205, v251, s[8:11], s24 offen offset:576 sc1
    buffer_load_dword v206, v251, s[8:11], s24 offen offset:2560 sc1
    buffer_load_dword v207, v251, s[8:11], s24 offen offset:2624 sc1
    buffer_load_dword v208, v251, s[8:11], s24 offen offset:1024 sc1
    buffer_load_dword v209, v251, s[8:11], s24 offen offset:1088 sc1
    buffer_load_dword v210, v251, s[8:11], s24 offen offset:3072 sc1
    buffer_load_dword v211, v251, s[8:11], s24 offen offset:3136 sc1
    buffer_load_dword v212, v251, s[8:11], s24 offen offset:1536 sc1
    buffer_load_dword v213, v251, s[8:11], s24 offen offset:1600 sc1
    buffer_load_dword v214, v251, s[8:11], s24 offen offset:3584 sc1
    buffer_load_dword v215, v251, s[8:11], s24 offen offset:3648 sc1
    v_max3_f32 v252, v168, v169, v170
    v_max3_f32 v252, v252, v171, v172
    v_max3_f32 v252, v252, v173, v174
    v_max3_f32 v252, v252, v175, v176
    v_max3_f32 v252, v252, v177, v178
    v_max3_f32 v252, v252, v179, v180
    v_max3_f32 v252, v252, v181, v182
    v_max_f32 v252, v252, v183
    s_waitcnt vmcnt(30)
    v_perm_b32 v112, v49, v48, v254
    v_perm_b32 v113, v51, v50, v254
    v_perm_b32 v114, v53, v52, v254
    v_perm_b32 v115, v55, v54, v254
    s_nop 1
    v_mfma_f32_32x32x16_bf16 v[184:199], v[112:115], v[16:19], 0
    s_waitcnt vmcnt(28)
    v_perm_b32 v116, v57, v56, v254
    v_perm_b32 v117, v59, v58, v254
    v_perm_b32 v118, v61, v60, v254
    v_perm_b32 v119, v63, v62, v254
    s_nop 1
    v_mfma_f32_32x32x16_bf16 v[184:199], v[116:119], v[20:23], v[184:199]
    s_waitcnt vmcnt(26)
    v_perm_b32 v120, v65, v64, v254
    v_perm_b32 v121, v67, v66, v254
    v_perm_b32 v122, v69, v68, v254
    v_perm_b32 v123, v71, v70, v254
    s_nop 1
    v_mfma_f32_32x32x16_bf16 v[184:199], v[120:123], v[24:27], v[184:199]
    s_waitcnt vmcnt(24)
    v_perm_b32 v124, v73, v72, v254
    v_perm_b32 v125, v75, v74, v254
    v_perm_b32 v126, v77, v76, v254
    v_perm_b32 v127, v79, v78, v254
    s_nop 1
    v_mfma_f32_32x32x16_bf16 v[184:199], v[124:127], v[28:31], v[184:199]
    s_waitcnt vmcnt(22)
    v_perm_b32 v128, v217, v216, v254
    v_perm_b32 v129, v219, v218, v254
    v_perm_b32 v130, v221, v220, v254
    v_perm_b32 v131, v223, v222, v254
    s_nop 1
    v_mfma_f32_32x32x16_bf16 v[184:199], v[128:131], v[32:35], v[184:199]
    s_waitcnt vmcnt(20)
    v_perm_b32 v132, v225, v224, v254
    v_perm_b32 v133, v227, v226, v254
    v_perm_b32 v134, v229, v228, v254
    v_perm_b32 v135, v231, v230, v254
    s_nop 1
    v_mfma_f32_32x32x16_bf16 v[184:199], v[132:135], v[36:39], v[184:199]
    s_waitcnt vmcnt(18)
    v_perm_b32 v136, v233, v232, v254
    v_perm_b32 v137, v235, v234, v254
    v_perm_b32 v138, v237, v236, v254
    v_perm_b32 v139, v239, v238, v254
    s_nop 1
    v_mfma_f32_32x32x16_bf16 v[184:199], v[136:139], v[40:43], v[184:199]
    s_waitcnt vmcnt(16)
    v_perm_b32 v140, v241, v240, v254
    v_perm_b32 v141, v243, v242, v254
    v_perm_b32 v142, v245, v244, v254
    v_perm_b32 v143, v247, v246, v254
    s_nop 1
    v_mfma_f32_32x32x16_bf16 v[184:199], v[140:143], v[44:47], v[184:199]
    s_nop 11
    v_max3_f32 v252, v252, v184, v185
    v_max3_f32 v252, v252, v186, v187
    v_mov_b32 v253, v252
    s_nop 1
    v_permlane32_swap_b32 v252, v253
    v_max_f32 v252, v252, v253
    v_sub_f32 v168, v168, v252
    v_sub_f32 v169, v169, v252
    v_sub_f32 v170, v170, v252
    v_sub_f32 v171, v171, v252
    v_sub_f32 v172, v172, v252
    v_sub_f32 v173, v173, v252
    v_sub_f32 v174, v174, v252
    v_sub_f32 v175, v175, v252
    v_sub_f32 v176, v176, v252
    v_sub_f32 v177, v177, v252
    v_sub_f32 v178, v178, v252
    v_sub_f32 v179, v179, v252
    v_sub_f32 v180, v180, v252
    v_sub_f32 v181, v181, v252
    v_sub_f32 v182, v182, v252
    v_sub_f32 v183, v183, v252
    v_sub_f32 v184, v184, v252
    v_sub_f32 v185, v185, v252
    v_sub_f32 v186, v186, v252
    v_sub_f32 v187, v187, v252
    v_exp_f32 v168, v168
    v_exp_f32 v169, v169
    v_exp_f32 v170, v170
    v_exp_f32 v171, v171
    v_exp_f32 v172, v172
    v_exp_f32 v173, v173
    v_exp_f32 v174, v174
    v_exp_f32 v175, v175
    v_exp_f32 v176, v176
    v_exp_f32 v177, v177
    v_exp_f32 v178, v178
    v_exp_f32 v179, v179
    v_exp_f32 v180, v180
    v_exp_f32 v181, v181
    v_exp_f32 v182, v182
    v_exp_f32 v183, v183
    v_exp_f32 v184, v184
    v_exp_f32 v185, v185
    v_exp_f32 v186, v186
    v_exp_f32 v187, v187
    v_cvt_pk_bf16_f32 v6, v168, v169
    v_cvt_pk_bf16_f32 v7, v170, v171
    v_cvt_pk_bf16_f32 v8, v172, v173
    v_cvt_pk_bf16_f32 v9, v174, v175
    v_cvt_pk_bf16_f32 v10, v176, v177
    v_cvt_pk_bf16_f32 v11, v178, v179
    v_cvt_pk_bf16_f32 v12, v180, v181
    v_cvt_pk_bf16_f32 v13, v182, v183
    v_cvt_pk_bf16_f32 v144, v184, v185
    v_cvt_pk_bf16_f32 v145, v186, v187
    v_cvt_pk_bf16_f32 v146, v184, v185
    v_cvt_pk_bf16_f32 v147, v186, v187
    s_waitcnt vmcnt(0)
    v_mfma_f32_32x32x16_bf16 v[16:31], v[80:83], v[6:9], 0
    v_mfma_f32_32x32x16_bf16 v[32:47], v[88:91], v[6:9], 0
    v_mfma_f32_32x32x16_bf16 v[48:63], v[96:99], v[6:9], 0
    v_mfma_f32_32x32x16_bf16 v[64:79], v[104:107], v[6:9], 0
    v_add_f32 v252, v168, v169
    v_mfma_f32_32x32x16_bf16 v[16:31], v[84:87], v[10:13], v[16:31]
    v_add_f32 v252, v252, v170
    v_add_f32 v252, v252, v171
    v_add_f32 v252, v252, v172
    v_add_f32 v252, v252, v173
    v_mfma_f32_32x32x16_bf16 v[32:47], v[92:95], v[10:13], v[32:47]
    v_add_f32 v252, v252, v174
    v_add_f32 v252, v252, v175
    v_add_f32 v252, v252, v176
    v_add_f32 v252, v252, v177
    v_mfma_f32_32x32x16_bf16 v[48:63], v[100:103], v[10:13], v[48:63]
    v_add_f32 v252, v252, v178
    v_add_f32 v252, v252, v179
    v_add_f32 v252, v252, v180
    v_add_f32 v252, v252, v181
    v_mfma_f32_32x32x16_bf16 v[64:79], v[108:111], v[10:13], v[64:79]
    v_add_f32 v252, v252, v182
    v_add_f32 v252, v252, v183
    v_add_f32 v252, v252, v184
    v_add_f32 v252, v252, v185
    v_mfma_f32_32x32x16_bf16 v[16:31], v[200:203], v[144:147], v[16:31]
    v_add_f32 v252, v252, v186
    v_add_f32 v252, v252, v187
    v_mov_b32 v253, v252
    v_mfma_f32_32x32x16_bf16 v[32:47], v[204:207], v[144:147], v[32:47]
    s_nop 0
    v_permlane32_swap_b32 v252, v253
    v_add_f32 v252, v252, v253
    v_rcp_f32 v252, v252
    v_mfma_f32_32x32x16_bf16 v[48:63], v[208:211], v[144:147], v[48:63]
    v_mfma_f32_32x32x16_bf16 v[64:79], v[212:215], v[144:147], v[64:79]
    s_add_u32 s24, s34, 0x2000000
    s_nop 0
    v_mul_f32 v16, v16, v252
    v_mul_f32 v17, v17, v252
    v_mul_f32 v18, v18, v252
    v_mul_f32 v19, v19, v252
    v_mul_f32 v20, v20, v252
    v_mul_f32 v21, v21, v252
    v_mul_f32 v22, v22, v252
    v_mul_f32 v23, v23, v252
    v_mul_f32 v24, v24, v252
    v_mul_f32 v25, v25, v252
    v_mul_f32 v26, v26, v252
    v_mul_f32 v27, v27, v252
    v_mul_f32 v28, v28, v252
    v_mul_f32 v29, v29, v252
    v_mul_f32 v30, v30, v252
    v_mul_f32 v31, v31, v252
    v_cvt_pk_bf16_f32 v112, v16, v17
    v_cvt_pk_bf16_f32 v113, v18, v19
    v_cvt_pk_bf16_f32 v114, v20, v21
    v_cvt_pk_bf16_f32 v115, v22, v23
    v_cvt_pk_bf16_f32 v116, v24, v25
    v_cvt_pk_bf16_f32 v117, v26, v27
    v_cvt_pk_bf16_f32 v118, v28, v29
    v_cvt_pk_bf16_f32 v119, v30, v31
    buffer_store_dwordx4 v[112:115], v2, s[8:11], s24 offen offset:0 sc1
    buffer_store_dwordx4 v[116:119], v2, s[8:11], s24 offen offset:1024 sc1
    v_mul_f32 v32, v32, v252
    v_mul_f32 v33, v33, v252
    v_mul_f32 v34, v34, v252
    v_mul_f32 v35, v35, v252
    v_mul_f32 v36, v36, v252
    v_mul_f32 v37, v37, v252
    v_mul_f32 v38, v38, v252
    v_mul_f32 v39, v39, v252
    v_mul_f32 v40, v40, v252
    v_mul_f32 v41, v41, v252
    v_mul_f32 v42, v42, v252
    v_mul_f32 v43, v43, v252
    v_mul_f32 v44, v44, v252
    v_mul_f32 v45, v45, v252
    v_mul_f32 v46, v46, v252
    v_mul_f32 v47, v47, v252
    v_cvt_pk_bf16_f32 v120, v32, v33
    v_cvt_pk_bf16_f32 v121, v34, v35
    v_cvt_pk_bf16_f32 v122, v36, v37
    v_cvt_pk_bf16_f32 v123, v38, v39
    v_cvt_pk_bf16_f32 v124, v40, v41
    v_cvt_pk_bf16_f32 v125, v42, v43
    v_cvt_pk_bf16_f32 v126, v44, v45
    v_cvt_pk_bf16_f32 v127, v46, v47
    buffer_store_dwordx4 v[120:123], v2, s[8:11], s24 offen offset:2048 sc1
    buffer_store_dwordx4 v[124:127], v2, s[8:11], s24 offen offset:3072 sc1
    v_mul_f32 v48, v48, v252
    v_mul_f32 v49, v49, v252
    v_mul_f32 v50, v50, v252
    v_mul_f32 v51, v51, v252
    v_mul_f32 v52, v52, v252
    v_mul_f32 v53, v53, v252
    v_mul_f32 v54, v54, v252
    v_mul_f32 v55, v55, v252
    v_mul_f32 v56, v56, v252
    v_mul_f32 v57, v57, v252
    v_mul_f32 v58, v58, v252
    v_mul_f32 v59, v59, v252
    v_mul_f32 v60, v60, v252
    v_mul_f32 v61, v61, v252
    v_mul_f32 v62, v62, v252
    v_mul_f32 v63, v63, v252
    v_cvt_pk_bf16_f32 v128, v48, v49
    v_cvt_pk_bf16_f32 v129, v50, v51
    v_cvt_pk_bf16_f32 v130, v52, v53
    v_cvt_pk_bf16_f32 v131, v54, v55
    v_cvt_pk_bf16_f32 v132, v56, v57
    v_cvt_pk_bf16_f32 v133, v58, v59
    v_cvt_pk_bf16_f32 v134, v60, v61
    v_cvt_pk_bf16_f32 v135, v62, v63
    s_add_u32 s24, s24, 4096
    buffer_store_dwordx4 v[128:131], v2, s[8:11], s24 offen offset:0 sc1
    buffer_store_dwordx4 v[132:135], v2, s[8:11], s24 offen offset:1024 sc1
    v_mul_f32 v64, v64, v252
    v_mul_f32 v65, v65, v252
    v_mul_f32 v66, v66, v252
    v_mul_f32 v67, v67, v252
    v_mul_f32 v68, v68, v252
    v_mul_f32 v69, v69, v252
    v_mul_f32 v70, v70, v252
    v_mul_f32 v71, v71, v252
    v_mul_f32 v72, v72, v252
    v_mul_f32 v73, v73, v252
    v_mul_f32 v74, v74, v252
    v_mul_f32 v75, v75, v252
    v_mul_f32 v76, v76, v252
    v_mul_f32 v77, v77, v252
    v_mul_f32 v78, v78, v252
    v_mul_f32 v79, v79, v252
    v_cvt_pk_bf16_f32 v136, v64, v65
    v_cvt_pk_bf16_f32 v137, v66, v67
    v_cvt_pk_bf16_f32 v138, v68, v69
    v_cvt_pk_bf16_f32 v139, v70, v71
    v_cvt_pk_bf16_f32 v140, v72, v73
    v_cvt_pk_bf16_f32 v141, v74, v75
    v_cvt_pk_bf16_f32 v142, v76, v77
    v_cvt_pk_bf16_f32 v143, v78, v79
    buffer_store_dwordx4 v[136:139], v2, s[8:11], s24 offen offset:2048 sc1
    buffer_store_dwordx4 v[140:143], v2, s[8:11], s24 offen offset:3072 sc1
    s_waitcnt vmcnt(0)
    s_barrier
    s_cmp_eq_u32 s5, 0
    s_cbranch_scc0 F_AT_NF
    s_add_u32 s24, s28, 1
    v_mov_b32 v3, s24
    s_mov_b64 exec, 1
    buffer_store_dword v3, off, s[8:11], s29 sc1
    s_mov_b64 exec, -1
F_AT_NF:
    s_add_u32 s28, s28, 6
    s_cmp_lt_u32 s28, 64
    s_cbranch_scc1 F_AT_LOOP
    s_branch F_END
F_FAIL:
    v_mov_b32 v3, 0x2000
    s_mov_b64 exec, 1
    buffer_store_dword v3, off, s[12:15], 0 offset:24 sc1
F_END:
    s_waitcnt vmcnt(0)
    s_endpgm
K_CHAIN:
    v_and_b32 v0, 63, v0
    v_lshlrev_b32 v1, 4, v0
    v_lshlrev_b32 v18, 3, v0
    v_lshlrev_b32 v35, 2, v0
    s_mul_i32 s52, s5, 30720
    s_add_u32 s52, s52, 40960
    s_mov_b32 s25, 0x5400000
    v_bfe_u32 v36, v0, 5, 1
    v_lshlrev_b32 v36, 16, v36
    v_bfe_u32 v103, v0, 4, 1
    v_lshl_add_u32 v36, v103, 13, v36
    v_bfe_u32 v100, v0, 4, 2
    v_lshlrev_b32 v100, 1, v100
    v_and_b32 v101, 15, v0
    v_xor_b32 v100, v100, v101
    v_lshl_add_u32 v36, v100, 4, v36
    v_xor_b32 v37, 128, v36
    v_bfe_u32 v102, v0, 4, 1
    v_lshlrev_b32 v102, 5, v102
    v_bfe_u32 v103, v0, 5, 1
    v_lshl_add_u32 v102, v103, 4, v102
    v_bfe_u32 v103, v0, 3, 1
    v_lshl_add_u32 v102, v103, 0, v102
    v_mul_u32_u24 v38, 1280, v102
    v_and_b32 v101, 7, v0
    v_bfe_u32 v100, v0, 4, 2
    v_lshlrev_b32 v100, 1, v100
    v_xor_b32 v100, v100, v101
    v_lshl_add_u32 v38, v100, 4, v38
    s_load_dwordx4 s[80:83], s[0:1], 16
    s_load_dwordx4 s[84:87], s[0:1], 32
    s_lshr_b32 s21, s5, 1
    s_and_b32 s22, s5, 1
    s_lshl_b32 s23, s21, 4
    s_add_u32 s23, s23, s22
    s_lshl_b32 s23, s23, 14
    s_lshl_b32 s90, s4, 8
    s_add_u32 s23, s23, s90
    s_mul_i32 s89, s3, 2621440
    s_sub_u32 s90, 2621440, s89
    s_add_u32 s89, s89, s23
    s_add_u32 s90, s90, s23
    s_lshl_b32 s21, s21, 2
    s_add_u32 s21, s21, s22
    s_mul_i32 s21, s21, 2560
    s_mul_i32 s91, s4, 163840
    s_add_u32 s91, s91, s21
    s_mul_i32 s21, s3, 640
    s_add_u32 s91, s91, s21
    s_lshl_b32 s88, s5, 12
    s_waitcnt lgkmcnt(0)
    s_mov_b32 s64, s80
    s_and_b32 s65, s81, 0xffff
    s_mov_b32 s66, 0x500000
    s_mov_b32 s67, 0x20000
    s_mov_b32 s68, s82
    s_and_b32 s69, s83, 0xffff
    s_mov_b32 s70, 0x500000
    s_mov_b32 s71, 0x20000
    s_mov_b32 s72, s84
    s_and_b32 s73, s85, 0xffff
    s_mov_b32 s74, 0x500000
    s_mov_b32 s75, 0x20000
    s_mov_b32 s76, s86
    s_and_b32 s77, s87, 0xffff
    s_mov_b32 s78, 0x500000
    s_mov_b32 s79, 0x20000
    s_add_u32 m0, s88, 81920
    s_add_u32 s21, s89, 0
    buffer_load_dwordx4 v36, s[64:67], s21 offen lds
    s_add_u32 m0, s88, 82944
    s_add_u32 s21, s89, 32768
    buffer_load_dwordx4 v37, s[64:67], s21 offen lds
    s_add_u32 m0, s88, 83968
    s_add_u32 s21, s89, 131072
    buffer_load_dwordx4 v36, s[64:67], s21 offen lds
    s_add_u32 m0, s88, 84992
    s_add_u32 s21, s89, 163840
    buffer_load_dwordx4 v37, s[64:67], s21 offen lds
    s_add_u32 m0, s88, 98304
    s_add_u32 s21, s89, 524288
    buffer_load_dwordx4 v36, s[64:67], s21 offen lds
    s_add_u32 m0, s88, 99328
    s_add_u32 s21, s89, 557056
    buffer_load_dwordx4 v37, s[64:67], s21 offen lds
    s_add_u32 m0, s88, 100352
    s_add_u32 s21, s89, 655360
    buffer_load_dwordx4 v36, s[64:67], s21 offen lds
    s_add_u32 m0, s88, 101376
    s_add_u32 s21, s89, 688128
    buffer_load_dwordx4 v37, s[64:67], s21 offen lds
    s_add_u32 m0, s88, 114688
    s_add_u32 s21, s89, 1048576
    buffer_load_dwordx4 v36, s[64:67], s21 offen lds
    s_add_u32 m0, s88, 115712
    s_add_u32 s21, s89, 1081344
    buffer_load_dwordx4 v37, s[64:67], s21 offen lds
    s_add_u32 m0, s88, 116736
    s_add_u32 s21, s89, 1179648
    buffer_load_dwordx4 v36, s[64:67], s21 offen lds
    s_add_u32 m0, s88, 117760
    s_add_u32 s21, s89, 1212416
    buffer_load_dwordx4 v37, s[64:67], s21 offen lds
    s_add_u32 m0, s88, 131072
    s_add_u32 s21, s89, 1572864
    buffer_load_dwordx4 v36, s[64:67], s21 offen lds
    s_add_u32 m0, s88, 132096
    s_add_u32 s21, s89, 1605632
    buffer_load_dwordx4 v37, s[64:67], s21 offen lds
    s_add_u32 m0, s88, 133120
    s_add_u32 s21, s89, 1703936
    buffer_load_dwordx4 v36, s[64:67], s21 offen lds
    s_add_u32 m0, s88, 134144
    s_add_u32 s21, s89, 1736704
    buffer_load_dwordx4 v37, s[64:67], s21 offen lds
    s_add_u32 m0, s88, 147456
    s_add_u32 s21, s89, 2097152
    buffer_load_dwordx4 v36, s[64:67], s21 offen lds
    s_add_u32 m0, s88, 148480
    s_add_u32 s21, s89, 2129920
    buffer_load_dwordx4 v37, s[64:67], s21 offen lds
    s_add_u32 m0, s88, 149504
    s_add_u32 s21, s89, 2228224
    buffer_load_dwordx4 v36, s[64:67], s21 offen lds
    s_add_u32 m0, s88, 150528
    s_add_u32 s21, s89, 2260992
    buffer_load_dwordx4 v37, s[64:67], s21 offen lds
    s_add_u32 m0, s88, 0
    s_add_u32 s21, s89, 0
    buffer_load_dwordx4 v36, s[68:71], s21 offen lds
    s_add_u32 m0, s88, 1024
    s_add_u32 s21, s89, 32768
    buffer_load_dwordx4 v37, s[68:71], s21 offen lds
    s_add_u32 m0, s88, 2048
    s_add_u32 s21, s89, 131072
    buffer_load_dwordx4 v36, s[68:71], s21 offen lds
    s_add_u32 m0, s88, 3072
    s_add_u32 s21, s89, 163840
    buffer_load_dwordx4 v37, s[68:71], s21 offen lds
    s_add_u32 m0, s88, 16384
    s_add_u32 s21, s89, 524288
    buffer_load_dwordx4 v36, s[68:71], s21 offen lds
    s_add_u32 m0, s88, 17408
    s_add_u32 s21, s89, 557056
    buffer_load_dwordx4 v37, s[68:71], s21 offen lds
    s_add_u32 m0, s88, 18432
    s_add_u32 s21, s89, 655360
    buffer_load_dwordx4 v36, s[68:71], s21 offen lds
    s_add_u32 m0, s88, 19456
    s_add_u32 s21, s89, 688128
    buffer_load_dwordx4 v37, s[68:71], s21 offen lds
    s_add_u32 m0, s88, 32768
    s_add_u32 s21, s89, 1048576
    buffer_load_dwordx4 v36, s[68:71], s21 offen lds
    s_add_u32 m0, s88, 33792
    s_add_u32 s21, s89, 1081344
    buffer_load_dwordx4 v37, s[68:71], s21 offen lds
    s_add_u32 m0, s88, 34816
    s_add_u32 s21, s89, 1179648
    buffer_load_dwordx4 v36, s[68:71], s21 offen lds
    s_add_u32 m0, s88, 35840
    s_add_u32 s21, s89, 1212416
    buffer_load_dwordx4 v37, s[68:71], s21 offen lds
    s_add_u32 m0, s88, 49152
    s_add_u32 s21, s89, 1572864
    buffer_load_dwordx4 v36, s[68:71], s21 offen lds
    s_add_u32 m0, s88, 50176
    s_add_u32 s21, s89, 1605632
    buffer_load_dwordx4 v37, s[68:71], s21 offen lds
    s_add_u32 m0, s88, 51200
    s_add_u32 s21, s89, 1703936
    buffer_load_dwordx4 v36, s[68:71], s21 offen lds
    s_add_u32 m0, s88, 52224
    s_add_u32 s21, s89, 1736704
    buffer_load_dwordx4 v37, s[68:71], s21 offen lds
    s_add_u32 m0, s88, 65536
    s_add_u32 s21, s89, 2097152
    buffer_load_dwordx4 v36, s[68:71], s21 offen lds
    s_add_u32 m0, s88, 66560
    s_add_u32 s21, s89, 2129920
    buffer_load_dwordx4 v37, s[68:71], s21 offen lds
    s_add_u32 m0, s88, 67584
    s_add_u32 s21, s89, 2228224
    buffer_load_dwordx4 v36, s[68:71], s21 offen lds
    s_add_u32 m0, s88, 68608
    s_add_u32 s21, s89, 2260992
    buffer_load_dwordx4 v37, s[68:71], s21 offen lds
    s_lshl_b32 s21, s5, 6
    v_bfe_u32 v42, v0, 2, 4
    v_lshlrev_b32 v42, 8, v42
    v_bfe_u32 v103, v0, 2, 3
    v_lshl_add_u32 v42, v103, 5, v42
    v_bfe_u32 v103, v0, 0, 2
    v_lshl_add_u32 v42, v103, 3, v42
    v_xor_b32 v42, s21, v42
    v_xor_b32 v43, 32, v42
    v_bfe_u32 v40, v0, 2, 4
    v_lshlrev_b32 v40, 8, v40
    v_bfe_u32 v103, v0, 2, 3
    v_lshl_add_u32 v40, v103, 5, v40
    v_bfe_u32 v103, v0, 0, 1
    v_lshl_add_u32 v40, v103, 4, v40
    v_bfe_u32 v103, v0, 1, 1
    v_lshl_add_u32 v40, v103, 3, v40
    v_xor_b32 v40, s21, v40
    v_xor_b32 v41, 32, v40
    v_bfe_u32 v102, v0, 2, 4
    v_lshlrev_b32 v102, 7, v102
    v_bfe_u32 v103, v0, 3, 2
    v_lshl_add_u32 v102, v103, 5, v102
    v_bfe_u32 v103, v0, 0, 2
    v_lshl_add_u32 v102, v103, 3, v102
    s_mul_i32 s21, s5, 5
    s_add_u32 s21, s21, 0
    s_and_b32 s22, s21, 3
    s_lshl_b32 s22, s22, 5
    v_xor_b32 v48, s22, v102
    s_lshr_b32 s21, s21, 2
    s_lshl_b32 s21, s21, 13
    s_add_u32 s21, s21, 81920
    v_add_u32 v48, s21, v48
    s_mul_i32 s21, s5, 5
    s_add_u32 s21, s21, 1
    s_and_b32 s22, s21, 3
    s_lshl_b32 s22, s22, 5
    v_xor_b32 v49, s22, v102
    s_lshr_b32 s21, s21, 2
    s_lshl_b32 s21, s21, 13
    s_add_u32 s21, s21, 81920
    v_add_u32 v49, s21, v49
    s_mul_i32 s21, s5, 5
    s_add_u32 s21, s21, 2
    s_and_b32 s22, s21, 3
    s_lshl_b32 s22, s22, 5
    v_xor_b32 v50, s22, v102
    s_lshr_b32 s21, s21, 2
    s_lshl_b32 s21, s21, 13
    s_add_u32 s21, s21, 81920
    v_add_u32 v50, s21, v50
    s_mul_i32 s21, s5, 5
    s_add_u32 s21, s21, 3
    s_and_b32 s22, s21, 3
    s_lshl_b32 s22, s22, 5
    v_xor_b32 v51, s22, v102
    s_lshr_b32 s21, s21, 2
    s_lshl_b32 s21, s21, 13
    s_add_u32 s21, s21, 81920
    v_add_u32 v51, s21, v51
    s_mul_i32 s21, s5, 5
    s_add_u32 s21, s21, 4
    s_and_b32 s22, s21, 3
    s_lshl_b32 s22, s22, 5
    v_xor_b32 v52, s22, v102
    s_lshr_b32 s21, s21, 2
    s_lshl_b32 s21, s21, 13
    s_add_u32 s21, s21, 81920
    v_add_u32 v52, s21, v52
    s_mov_b32 s35, 0x7f817f81
    s_mov_b32 s54, 0x3e0293ee
    s_mov_b32 s60, 0x33333333
    s_mov_b32 s61, 0x33333333
    v_mov_b32 v10, 0x3f803f80
    v_mov_b32 v14, s35
    v_mov_b32 v11, 0x3f803f80
    v_mov_b32 v15, s35
    v_mov_b32 v12, 0x3f803f80
    v_mov_b32 v16, s35
    v_mov_b32 v13, 0x3f803f80
    v_mov_b32 v17, s35
    v_mov_b32 v2, 0x3f803f80
    v_mov_b32 v3, 0
    v_mov_b32 v34, 0x4444
    v_mov_b32 v100, 0xeeee
    v_and_b32 v101, 2, v0
    v_cmp_ne_u32 vcc, 0, v101
    s_nop 1
    v_cndmask_b32 v34, v34, v100, vcc
    v_and_b32 v101, 15, v0
    v_mov_b32 v6, 0
    v_mov_b32 v100, 0x3f80
    v_cmp_eq_u32 vcc, 0, v101
    s_nop 1
    v_cndmask_b32 v6, v6, v100, vcc
    v_mov_b32 v100, 0x3f800000
    v_cmp_eq_u32 vcc, 4, v101
    s_nop 1
    v_cndmask_b32 v6, v6, v100, vcc
    v_mov_b32 v7, 0
    v_mov_b32 v100, 0x3f80
    v_cmp_eq_u32 vcc, 1, v101
    s_nop 1
    v_cndmask_b32 v7, v7, v100, vcc
    v_mov_b32 v100, 0x3f800000
    v_cmp_eq_u32 vcc, 5, v101
    s_nop 1
    v_cndmask_b32 v7, v7, v100, vcc
    v_mov_b32 v8, 0
    v_mov_b32 v100, 0x3f80
    v_cmp_eq_u32 vcc, 2, v101
    s_nop 1
    v_cndmask_b32 v8, v8, v100, vcc
    v_mov_b32 v100, 0x3f800000
    v_cmp_eq_u32 vcc, 6, v101
    s_nop 1
    v_cndmask_b32 v8, v8, v100, vcc
    v_mov_b32 v9, 0
    v_mov_b32 v100, 0x3f80
    v_cmp_eq_u32 vcc, 3, v101
    s_nop 1
    v_cndmask_b32 v9, v9, v100, vcc
    v_mov_b32 v100, 0x3f800000
    v_cmp_eq_u32 vcc, 7, v101
    s_nop 1
    v_cndmask_b32 v9, v9, v100, vcc
    s_lshl_b32 s21, s5, 10
    s_add_u32 s21, s21, 30720
    v_bfe_u32 v20, v0, 2, 1
    v_lshlrev_b32 v20, 9, v20
    v_bfe_u32 v103, v0, 3, 1
    v_lshl_add_u32 v20, v103, 7, v20
    v_bfe_u32 v103, v0, 0, 2
    v_lshl_add_u32 v20, v103, 5, v20
    v_add_u32 v20, s21, v20
    v_bfe_u32 v100, v0, 2, 2
    v_bfe_u32 v101, v0, 4, 2
    v_xor_b32 v100, v100, v101
    v_lshl_add_u32 v20, v100, 3, v20
    v_add_u32 v19, s52, v1
    v_xor_b32 v23, 8192, v1
    s_lshr_b32 s21, s5, 1
    s_lshl_b32 s21, s21, 10
    s_and_b32 s22, s5, 1
    s_lshl_b32 s22, s22, 7
    s_add_u32 s21, s21, s22
    s_add_u32 s21, s21, 34816
    v_bfe_u32 v24, v0, 4, 2
    v_lshlrev_b32 v24, 8, v24
    v_bfe_u32 v103, v0, 2, 2
    v_lshl_add_u32 v24, v103, 5, v24
    v_bfe_u32 v103, v0, 0, 1
    v_lshl_add_u32 v24, v103, 4, v24
    v_bfe_u32 v103, v0, 1, 1
    v_lshl_add_u32 v24, v103, 11, v24
    v_bfe_u32 v103, v0, 1, 1
    v_lshl_add_u32 v24, v103, 3, v24
    v_add_u32 v24, s21, v24
    v_bfe_u32 v25, v0, 4, 2
    v_lshlrev_b32 v25, 8, v25
    v_bfe_u32 v103, v0, 2, 2
    v_lshl_add_u32 v25, v103, 5, v25
    v_bfe_u32 v103, v0, 0, 1
    v_lshl_add_u32 v25, v103, 4, v25
    v_bfe_u32 v103, v0, 1, 1
    v_lshl_add_u32 v25, v103, 7, v25
    v_add_u32 v25, 34816, v25
    s_lshl_b32 s21, s5, 11
    v_bfe_u32 v30, v0, 4, 2
    v_lshlrev_b32 v30, 9, v30
    v_bfe_u32 v103, v0, 3, 1
    v_lshl_add_u32 v30, v103, 8, v30
    v_bfe_u32 v103, v0, 0, 3
    v_lshl_add_u32 v30, v103, 4, v30
    v_add_u32 v30, s21, v30
    v_bfe_u32 v31, v0, 4, 2
    v_lshlrev_b32 v31, 9, v31
    v_bfe_u32 v103, v0, 0, 4
    v_lshl_add_u32 v31, v103, 4, v31
    v_add_u32 v31, s21, v31
    s_lshl_b32 s21, s5, 10
    v_add_u32 v26, s21, v1
    s_lshl_b32 s21, s5, 8
    s_add_u32 s21, s21, 4096
    v_add_u32 v27, s21, v35
    s_lshl_b32 s21, s4, 1
    s_add_u32 s21, s21, s5
    s_add_u32 s22, s4, 64
    s_cmp_ge_u32 s5, 2
    s_cselect_b32 s21, s22, s21
    s_cmp_lt_u32 s21, 80
    s_cselect_b32 s33, 1, 0
    s_cselect_b32 s21, s21, 0
    s_cmp_eq_u32 s5, 3
    s_cselect_b32 s33, 0, s33
    s_lshl_b32 s92, s21, 6
    s_mov_b32 s93, s92
    s_and_b32 s97, s21, 3
    s_lshr_b32 s94, s21, 2
    s_lshl_b32 s94, s94, 4
    s_mov_b32 s95, 1
    s_mov_b32 s96, 4
    v_bfe_u32 v28, v0, 4, 2
    v_lshlrev_b32 v28, 11, v28
    v_bfe_u32 v103, v0, 0, 4
    v_lshl_add_u32 v28, v103, 2, v28
    v_bfe_u32 v4, v0, 4, 2
    v_lshlrev_b32 v4, 8, v4
    v_bfe_u32 v103, v0, 0, 2
    v_lshl_add_u32 v4, v103, 6, v4
    v_bfe_u32 v103, v0, 2, 2
    v_lshl_add_u32 v4, v103, 4, v4
    s_lshl_b32 s48, s92, 5
    v_bfe_u32 v29, v0, 5, 1
    v_lshlrev_b32 v29, 5, v29
    v_bfe_u32 v103, v0, 2, 1
    v_lshl_add_u32 v29, v103, 4, v29
    v_bfe_u32 v103, v0, 4, 1
    v_lshl_add_u32 v29, v103, 3, v29
    v_bfe_u32 v103, v0, 1, 1
    v_lshl_add_u32 v29, v103, 2, v29
    v_add_u32 v29, s93, v29
    v_mov_b32 v100, 0x80000000
    v_and_b32 v101, 9, v0
    v_cmp_eq_u32 vcc, 0, v101
    s_nop 1
    v_cndmask_b32 v29, v100, v29, vcc
    s_cmp_eq_u32 s33, 0
    s_cbranch_scc0 C_RED_K
    v_mov_b32 v29, 0x80000000
C_RED_K:
    v_and_b32 v100, 3, v0
    v_mul_lo_u32 v100, v100, s95
    v_lshrrev_b32 v101, 4, v0
    v_mul_lo_u32 v101, v101, s96
    v_add3_u32 v100, v100, v101, s94
    v_bfe_u32 v101, v0, 2, 1
    s_lshl_b32 s21, s97, 1
    v_add_u32 v101, s21, v101
    v_mul_u32_u24 v101, 640, v101
    s_mul_i32 s21, s3, 320
    v_add3_u32 v100, v100, v101, s21
    v_lshlrev_b32 v33, 1, v100
    s_load_dwordx2 s[36:37], s[0:1], 8
    s_waitcnt lgkmcnt(0)
    s_mov_b32 s16, s36
    s_and_b32 s17, s37, 0xffff
    s_mov_b32 s18, 0x2800
    s_mov_b32 s19, 0x20000
    buffer_load_ushort v33, v33, s[16:19], 0 offen
    s_lshl_b32 s21, s3, 15
    s_add_u32 s26, s21, 0x5200000
    s_lshl_b32 s21, s3, 14
    s_add_u32 s27, s21, 524288
    s_xor_b32 s28, s27, 0x4000
    s_lshl_b32 s29, s4, 14
    s_lshl_b32 s21, s3, 12
    s_add_u32 s29, s29, s21
    s_lshl_b32 s21, s5, 9
    s_add_u32 s29, s29, s21
    s_xor_b32 s30, s29, 0x1000
    s_add_u32 s27, s27, s25
    s_add_u32 s28, s28, s25
    s_add_u32 s29, s29, s25
    s_add_u32 s30, s30, s25
    s_mul_i32 s31, s3, 327680
    s_add_u32 s31, s31, 0x5100000
    s_mul_i32 s32, s4, 5120
    s_mul_i32 s21, s5, 1280
    s_add_u32 s32, s32, s21
    s_lshl_b32 s40, s4, 14
    s_lshl_b32 s34, s3, 2
    s_add_u32 s34, s34, s5
    s_lshl_b32 s34, s34, 9
    s_add_u32 s34, s34, 0x6000000
    s_mov_b32 s62, 0x00010001
    s_mov_b32 s63, 0x00010001
    s_xor_b32 s21, s5, 3
    v_or_b32 v101, s21, v0
    v_mov_b32 v100, 0x80000000
    v_cmp_eq_u32 vcc, 0, v101
    s_nop 1
    v_cndmask_b32 v0, v100, v0, vcc
    s_sub_u32 s56, s27, s29
    s_add_u32 s56, s56, s93
    s_lshl_b32 s57, s4, 7
    s_add_u32 s57, s57, 0x5030000
    s_add_u32 s21, s31, s32
    buffer_store_dwordx4 v[14:17], v1, s[8:11], s21 offen sc1
    buffer_store_dword v14, v35, s[8:11], s21 offen offset:1024 sc1
    s_add_u32 s21, s31, s32
    s_add_u32 s21, s21, 163840
    buffer_store_dwordx4 v[14:17], v1, s[8:11], s21 offen sc1
    buffer_store_dword v14, v35, s[8:11], s21 offen offset:1024 sc1
    s_add_u32 s21, s29, 0
    buffer_store_dwordx2 v[14:15], v18, s[8:11], s21 offen sc1
    s_add_u32 s21, s29, 8192
    buffer_store_dwordx2 v[14:15], v18, s[8:11], s21 offen sc1
    s_add_u32 s21, s29, 1048576
    buffer_store_dwordx2 v[14:15], v18, s[8:11], s21 offen sc1
    s_add_u32 s21, s29, 1056768
    buffer_store_dwordx2 v[14:15], v18, s[8:11], s21 offen sc1
    s_add_u32 s21, s26, 0
    buffer_store_dword v14, v29, s[8:11], s21 offen sc1
    s_add_u32 s21, s27, 0
    buffer_store_dword v14, v29, s[8:11], s21 offen sc1
    s_add_u32 s21, s27, 8192
    buffer_store_dword v14, v29, s[8:11], s21 offen sc1
    s_add_u32 s21, s26, 8192
    buffer_store_dword v14, v29, s[8:11], s21 offen sc1
    s_add_u32 s21, s27, 1048576
    buffer_store_dword v14, v29, s[8:11], s21 offen sc1
    s_add_u32 s21, s27, 1056768
    buffer_store_dword v14, v29, s[8:11], s21 offen sc1
    v_mov_b32 v100, 0
    s_add_u32 s21, s29, 0
    buffer_store_dword v100, v0, s[8:11], s21 offen offset:512 sc1
    s_add_u32 s21, s29, 8192
    buffer_store_dword v100, v0, s[8:11], s21 offen offset:512 sc1
    s_add_u32 s21, s29, 1048576
    buffer_store_dword v100, v0, s[8:11], s21 offen offset:512 sc1
    s_add_u32 s21, s29, 1056768
    buffer_store_dword v100, v0, s[8:11], s21 offen offset:512 sc1
    s_or_b32 s21, s3, s5
    s_cmp_eq_u32 s21, 0
    s_cselect_b32 s21, 64, 0
    v_mov_b32 v101, 0x80000000
    v_cmp_gt_u32 vcc, s21, v35
    s_nop 1
    v_cndmask_b32 v101, v101, v35, vcc
    buffer_store_dword v100, v101, s[8:11], s57 offen sc1
    s_getreg_b32 s21, hwreg(HW_REG_XCC_ID, 0, 4)
    s_lshl_b32 s21, 1, s21
    v_mov_b32 v101, s21
    s_lshl_b32 s22, s3, 2
    buffer_atomic_or v101, v0, s[12:15], s22 offen offset:4 sc1
    s_waitcnt vmcnt(41)
    s_barrier
    s_xor_b32 s21, s5, 0
    s_lshl_b32 s21, s21, 14
    s_add_u32 s21, s21, 81920
    v_add_u32 v44, s21, v40
    v_add_u32 v45, s21, v41
    ds_read_b64_tr_b16 a[0:1], v44 offset:0
    ds_read_b64_tr_b16 a[2:3], v44 offset:4096
    ds_read_b64_tr_b16 a[4:5], v44 offset:8192
    ds_read_b64_tr_b16 a[6:7], v44 offset:12288
    ds_read_b64_tr_b16 a[16:17], v45 offset:0
    ds_read_b64_tr_b16 a[18:19], v45 offset:4096
    ds_read_b64_tr_b16 a[20:21], v45 offset:8192
    ds_read_b64_tr_b16 a[22:23], v45 offset:12288
    s_xor_b32 s21, s5, 1
    s_lshl_b32 s21, s21, 14
    s_add_u32 s21, s21, 81920
    v_add_u32 v44, s21, v40
    v_add_u32 v45, s21, v41
    ds_read_b64_tr_b16 a[32:33], v44 offset:0
    ds_read_b64_tr_b16 a[34:35], v44 offset:4096
    ds_read_b64_tr_b16 a[36:37], v44 offset:8192
    ds_read_b64_tr_b16 a[38:39], v44 offset:12288
    ds_read_b64_tr_b16 a[48:49], v45 offset:0
    ds_read_b64_tr_b16 a[50:51], v45 offset:4096
    ds_read_b64_tr_b16 a[52:53], v45 offset:8192
    ds_read_b64_tr_b16 a[54:55], v45 offset:12288
    s_xor_b32 s21, s5, 2
    s_lshl_b32 s21, s21, 14
    s_add_u32 s21, s21, 81920
    v_add_u32 v44, s21, v40
    v_add_u32 v45, s21, v41
    ds_read_b64_tr_b16 a[64:65], v44 offset:0
    ds_read_b64_tr_b16 a[66:67], v44 offset:4096
    ds_read_b64_tr_b16 a[68:69], v44 offset:8192
    ds_read_b64_tr_b16 a[70:71], v44 offset:12288
    ds_read_b64_tr_b16 a[80:81], v45 offset:0
    ds_read_b64_tr_b16 a[82:83], v45 offset:4096
    ds_read_b64_tr_b16 a[84:85], v45 offset:8192
    ds_read_b64_tr_b16 a[86:87], v45 offset:12288
    s_xor_b32 s21, s5, 3
    s_lshl_b32 s21, s21, 14
    s_add_u32 s21, s21, 81920
    v_add_u32 v44, s21, v40
    v_add_u32 v45, s21, v41
    ds_read_b64_tr_b16 a[96:97], v44 offset:0
    ds_read_b64_tr_b16 a[98:99], v44 offset:4096
    ds_read_b64_tr_b16 a[100:101], v44 offset:8192
    ds_read_b64_tr_b16 a[102:103], v44 offset:12288
    ds_read_b64_tr_b16 a[112:113], v45 offset:0
    ds_read_b64_tr_b16 a[114:115], v45 offset:4096
    ds_read_b64_tr_b16 a[116:117], v45 offset:8192
    ds_read_b64_tr_b16 a[118:119], v45 offset:12288
    s_mov_b32 s21, 147456
    v_add_u32 v44, s21, v40
    v_add_u32 v45, s21, v41
    ds_read_b64_tr_b16 a[128:129], v44 offset:0
    ds_read_b64_tr_b16 a[130:131], v44 offset:4096
    ds_read_b64_tr_b16 a[132:133], v44 offset:8192
    ds_read_b64_tr_b16 a[134:135], v44 offset:12288
    ds_read_b64_tr_b16 a[144:145], v45 offset:0
    ds_read_b64_tr_b16 a[146:147], v45 offset:4096
    ds_read_b64_tr_b16 a[148:149], v45 offset:8192
    ds_read_b64_tr_b16 a[150:151], v45 offset:12288
    s_waitcnt lgkmcnt(0)
    s_barrier
    s_add_u32 m0, s88, 81920
    s_add_u32 s21, s90, 0
    buffer_load_dwordx4 v36, s[64:67], s21 offen lds
    s_add_u32 m0, s88, 82944
    s_add_u32 s21, s90, 32768
    buffer_load_dwordx4 v37, s[64:67], s21 offen lds
    s_add_u32 m0, s88, 83968
    s_add_u32 s21, s90, 131072
    buffer_load_dwordx4 v36, s[64:67], s21 offen lds
    s_add_u32 m0, s88, 84992
    s_add_u32 s21, s90, 163840
    buffer_load_dwordx4 v37, s[64:67], s21 offen lds
    s_add_u32 m0, s88, 98304
    s_add_u32 s21, s90, 524288
    buffer_load_dwordx4 v36, s[64:67], s21 offen lds
    s_add_u32 m0, s88, 99328
    s_add_u32 s21, s90, 557056
    buffer_load_dwordx4 v37, s[64:67], s21 offen lds
    s_add_u32 m0, s88, 100352
    s_add_u32 s21, s90, 655360
    buffer_load_dwordx4 v36, s[64:67], s21 offen lds
    s_add_u32 m0, s88, 101376
    s_add_u32 s21, s90, 688128
    buffer_load_dwordx4 v37, s[64:67], s21 offen lds
    s_add_u32 m0, s88, 114688
    s_add_u32 s21, s90, 1048576
    buffer_load_dwordx4 v36, s[64:67], s21 offen lds
    s_add_u32 m0, s88, 115712
    s_add_u32 s21, s90, 1081344
    buffer_load_dwordx4 v37, s[64:67], s21 offen lds
    s_add_u32 m0, s88, 116736
    s_add_u32 s21, s90, 1179648
    buffer_load_dwordx4 v36, s[64:67], s21 offen lds
    s_add_u32 m0, s88, 117760
    s_add_u32 s21, s90, 1212416
    buffer_load_dwordx4 v37, s[64:67], s21 offen lds
    s_add_u32 m0, s88, 131072
    s_add_u32 s21, s90, 1572864
    buffer_load_dwordx4 v36, s[64:67], s21 offen lds
    s_add_u32 m0, s88, 132096
    s_add_u32 s21, s90, 1605632
    buffer_load_dwordx4 v37, s[64:67], s21 offen lds
    s_add_u32 m0, s88, 133120
    s_add_u32 s21, s90, 1703936
    buffer_load_dwordx4 v36, s[64:67], s21 offen lds
    s_add_u32 m0, s88, 134144
    s_add_u32 s21, s90, 1736704
    buffer_load_dwordx4 v37, s[64:67], s21 offen lds
    s_add_u32 m0, s88, 147456
    s_add_u32 s21, s90, 2097152
    buffer_load_dwordx4 v36, s[64:67], s21 offen lds
    s_add_u32 m0, s88, 148480
    s_add_u32 s21, s90, 2129920
    buffer_load_dwordx4 v37, s[64:67], s21 offen lds
    s_add_u32 m0, s88, 149504
    s_add_u32 s21, s90, 2228224
    buffer_load_dwordx4 v36, s[64:67], s21 offen lds
    s_add_u32 m0, s88, 150528
    s_add_u32 s21, s90, 2260992
    buffer_load_dwordx4 v37, s[64:67], s21 offen lds
    s_waitcnt vmcnt(41)
    s_barrier
    s_xor_b32 s21, s5, 0
    s_lshl_b32 s21, s21, 14
    s_add_u32 s21, s21, 0
    v_add_u32 v44, s21, v40
    v_add_u32 v45, s21, v41
    ds_read_b64_tr_b16 a[8:9], v44 offset:0
    ds_read_b64_tr_b16 a[10:11], v44 offset:4096
    ds_read_b64_tr_b16 a[12:13], v44 offset:8192
    ds_read_b64_tr_b16 a[14:15], v44 offset:12288
    ds_read_b64_tr_b16 a[24:25], v45 offset:0
    ds_read_b64_tr_b16 a[26:27], v45 offset:4096
    ds_read_b64_tr_b16 a[28:29], v45 offset:8192
    ds_read_b64_tr_b16 a[30:31], v45 offset:12288
    s_xor_b32 s21, s5, 1
    s_lshl_b32 s21, s21, 14
    s_add_u32 s21, s21, 0
    v_add_u32 v44, s21, v40
    v_add_u32 v45, s21, v41
    ds_read_b64_tr_b16 a[40:41], v44 offset:0
    ds_read_b64_tr_b16 a[42:43], v44 offset:4096
    ds_read_b64_tr_b16 a[44:45], v44 offset:8192
    ds_read_b64_tr_b16 a[46:47], v44 offset:12288
    ds_read_b64_tr_b16 a[56:57], v45 offset:0
    ds_read_b64_tr_b16 a[58:59], v45 offset:4096
    ds_read_b64_tr_b16 a[60:61], v45 offset:8192
    ds_read_b64_tr_b16 a[62:63], v45 offset:12288
    s_xor_b32 s21, s5, 2
    s_lshl_b32 s21, s21, 14
    s_add_u32 s21, s21, 0
    v_add_u32 v44, s21, v40
    v_add_u32 v45, s21, v41
    ds_read_b64_tr_b16 a[72:73], v44 offset:0
    ds_read_b64_tr_b16 a[74:75], v44 offset:4096
    ds_read_b64_tr_b16 a[76:77], v44 offset:8192
    ds_read_b64_tr_b16 a[78:79], v44 offset:12288
    ds_read_b64_tr_b16 a[88:89], v45 offset:0
    ds_read_b64_tr_b16 a[90:91], v45 offset:4096
    ds_read_b64_tr_b16 a[92:93], v45 offset:8192
    ds_read_b64_tr_b16 a[94:95], v45 offset:12288
    s_xor_b32 s21, s5, 3
    s_lshl_b32 s21, s21, 14
    s_add_u32 s21, s21, 0
    v_add_u32 v44, s21, v40
    v_add_u32 v45, s21, v41
    ds_read_b64_tr_b16 a[104:105], v44 offset:0
    ds_read_b64_tr_b16 a[106:107], v44 offset:4096
    ds_read_b64_tr_b16 a[108:109], v44 offset:8192
    ds_read_b64_tr_b16 a[110:111], v44 offset:12288
    ds_read_b64_tr_b16 a[120:121], v45 offset:0
    ds_read_b64_tr_b16 a[122:123], v45 offset:4096
    ds_read_b64_tr_b16 a[124:125], v45 offset:8192
    ds_read_b64_tr_b16 a[126:127], v45 offset:12288
    s_mov_b32 s21, 65536
    v_add_u32 v44, s21, v40
    v_add_u32 v45, s21, v41
    ds_read_b64_tr_b16 a[136:137], v44 offset:0
    ds_read_b64_tr_b16 a[138:139], v44 offset:4096
    ds_read_b64_tr_b16 a[140:141], v44 offset:8192
    ds_read_b64_tr_b16 a[142:143], v44 offset:12288
    ds_read_b64_tr_b16 a[152:153], v45 offset:0
    ds_read_b64_tr_b16 a[154:155], v45 offset:4096
    ds_read_b64_tr_b16 a[156:157], v45 offset:8192
    ds_read_b64_tr_b16 a[158:159], v45 offset:12288
    s_waitcnt lgkmcnt(0)
    s_barrier
    s_add_u32 m0, s88, 0
    s_add_u32 s21, s90, 0
    buffer_load_dwordx4 v36, s[68:71], s21 offen lds
    s_add_u32 m0, s88, 1024
    s_add_u32 s21, s90, 32768
    buffer_load_dwordx4 v37, s[68:71], s21 offen lds
    s_add_u32 m0, s88, 2048
    s_add_u32 s21, s90, 131072
    buffer_load_dwordx4 v36, s[68:71], s21 offen lds
    s_add_u32 m0, s88, 3072
    s_add_u32 s21, s90, 163840
    buffer_load_dwordx4 v37, s[68:71], s21 offen lds
    s_add_u32 m0, s88, 16384
    s_add_u32 s21, s90, 524288
    buffer_load_dwordx4 v36, s[68:71], s21 offen lds
    s_add_u32 m0, s88, 17408
    s_add_u32 s21, s90, 557056
    buffer_load_dwordx4 v37, s[68:71], s21 offen lds
    s_add_u32 m0, s88, 18432
    s_add_u32 s21, s90, 655360
    buffer_load_dwordx4 v36, s[68:71], s21 offen lds
    s_add_u32 m0, s88, 19456
    s_add_u32 s21, s90, 688128
    buffer_load_dwordx4 v37, s[68:71], s21 offen lds
    s_add_u32 m0, s88, 32768
    s_add_u32 s21, s90, 1048576
    buffer_load_dwordx4 v36, s[68:71], s21 offen lds
    s_add_u32 m0, s88, 33792
    s_add_u32 s21, s90, 1081344
    buffer_load_dwordx4 v37, s[68:71], s21 offen lds
    s_add_u32 m0, s88, 34816
    s_add_u32 s21, s90, 1179648
    buffer_load_dwordx4 v36, s[68:71], s21 offen lds
    s_add_u32 m0, s88, 35840
    s_add_u32 s21, s90, 1212416
    buffer_load_dwordx4 v37, s[68:71], s21 offen lds
    s_add_u32 m0, s88, 49152
    s_add_u32 s21, s90, 1572864
    buffer_load_dwordx4 v36, s[68:71], s21 offen lds
    s_add_u32 m0, s88, 50176
    s_add_u32 s21, s90, 1605632
    buffer_load_dwordx4 v37, s[68:71], s21 offen lds
    s_add_u32 m0, s88, 51200
    s_add_u32 s21, s90, 1703936
    buffer_load_dwordx4 v36, s[68:71], s21 offen lds
    s_add_u32 m0, s88, 52224
    s_add_u32 s21, s90, 1736704
    buffer_load_dwordx4 v37, s[68:71], s21 offen lds
    s_add_u32 m0, s88, 65536
    s_add_u32 s21, s90, 2097152
    buffer_load_dwordx4 v36, s[68:71], s21 offen lds
    s_add_u32 m0, s88, 66560
    s_add_u32 s21, s90, 2129920
    buffer_load_dwordx4 v37, s[68:71], s21 offen lds
    s_add_u32 m0, s88, 67584
    s_add_u32 s21, s90, 2228224
    buffer_load_dwordx4 v36, s[68:71], s21 offen lds
    s_add_u32 m0, s88, 68608
    s_add_u32 s21, s90, 2260992
    buffer_load_dwordx4 v37, s[68:71], s21 offen lds
    s_waitcnt vmcnt(20)
    s_barrier
    v_mov_b32 v100, 1
    buffer_atomic_add v100, v0, s[12:15], 0 offen offset:0 sc1
    s_mov_b32 s21, 81920
    v_add_u32 v44, s21, v40
    v_add_u32 v45, s21, v41
    ds_read_b64_tr_b16 a[160:161], v44 offset:0
    ds_read_b64_tr_b16 a[162:163], v44 offset:4096
    ds_read_b64_tr_b16 a[164:165], v44 offset:8192
    ds_read_b64_tr_b16 a[166:167], v44 offset:12288
    ds_read_b64_tr_b16 a[176:177], v45 offset:0
    ds_read_b64_tr_b16 a[178:179], v45 offset:4096
    ds_read_b64_tr_b16 a[180:181], v45 offset:8192
    ds_read_b64_tr_b16 a[182:183], v45 offset:12288
    s_mov_b32 s21, 98304
    v_add_u32 v44, s21, v40
    v_add_u32 v45, s21, v41
    ds_read_b64_tr_b16 a[192:193], v44 offset:0
    ds_read_b64_tr_b16 a[194:195], v44 offset:4096
    ds_read_b64_tr_b16 a[196:197], v44 offset:8192
    ds_read_b64_tr_b16 a[198:199], v44 offset:12288
    ds_read_b64_tr_b16 a[208:209], v45 offset:0
    ds_read_b64_tr_b16 a[210:211], v45 offset:4096
    ds_read_b64_tr_b16 a[212:213], v45 offset:8192
    ds_read_b64_tr_b16 a[214:215], v45 offset:12288
    s_mov_b32 s21, 114688
    v_add_u32 v44, s21, v40
    v_add_u32 v45, s21, v41
    ds_read_b64_tr_b16 a[224:225], v44 offset:0
    ds_read_b64_tr_b16 a[226:227], v44 offset:4096
    ds_read_b64_tr_b16 a[228:229], v44 offset:8192
    ds_read_b64_tr_b16 a[230:231], v44 offset:12288
    ds_read_b64_tr_b16 a[240:241], v45 offset:0
    ds_read_b64_tr_b16 a[242:243], v45 offset:4096
    ds_read_b64_tr_b16 a[244:245], v45 offset:8192
    ds_read_b64_tr_b16 a[246:247], v45 offset:12288
    s_mov_b32 s21, 131072
    v_add_u32 v44, s21, v40
    v_add_u32 v45, s21, v41
    ds_read_b64_tr_b16 v[152:153], v44 offset:0
    ds_read_b64_tr_b16 v[154:155], v44 offset:4096
    ds_read_b64_tr_b16 v[156:157], v44 offset:8192
    ds_read_b64_tr_b16 v[158:159], v44 offset:12288
    ds_read_b64_tr_b16 v[168:169], v45 offset:0
    ds_read_b64_tr_b16 v[170:171], v45 offset:4096
    ds_read_b64_tr_b16 v[172:173], v45 offset:8192
    ds_read_b64_tr_b16 v[174:175], v45 offset:12288
    s_mov_b32 s21, 147456
    v_add_u32 v44, s21, v40
    v_add_u32 v45, s21, v41
    ds_read_b64_tr_b16 v[184:185], v44 offset:0
    ds_read_b64_tr_b16 v[186:187], v44 offset:4096
    ds_read_b64_tr_b16 v[188:189], v44 offset:8192
    ds_read_b64_tr_b16 v[190:191], v44 offset:12288
    ds_read_b64_tr_b16 v[200:201], v45 offset:0
    ds_read_b64_tr_b16 v[202:203], v45 offset:4096
    ds_read_b64_tr_b16 v[204:205], v45 offset:8192
    ds_read_b64_tr_b16 v[206:207], v45 offset:12288
    s_waitcnt lgkmcnt(0)
    s_barrier
    s_lshr_b32 s22, s88, 1
    s_add_u32 m0, s22, 81920
    s_add_u32 s21, s91, 0
    buffer_load_dwordx4 v38, s[76:79], s21 offen lds
    s_add_u32 m0, s22, 82944
    s_add_u32 s21, s91, 5120
    buffer_load_dwordx4 v38, s[76:79], s21 offen lds
    s_add_u32 m0, s22, 90112
    s_add_u32 s21, s91, 128
    buffer_load_dwordx4 v38, s[76:79], s21 offen lds
    s_add_u32 m0, s22, 91136
    s_add_u32 s21, s91, 5248
    buffer_load_dwordx4 v38, s[76:79], s21 offen lds
    s_add_u32 m0, s22, 98304
    s_add_u32 s21, s91, 256
    buffer_load_dwordx4 v38, s[76:79], s21 offen lds
    s_add_u32 m0, s22, 99328
    s_add_u32 s21, s91, 5376
    buffer_load_dwordx4 v38, s[76:79], s21 offen lds
    s_add_u32 m0, s22, 106496
    s_add_u32 s21, s91, 384
    buffer_load_dwordx4 v38, s[76:79], s21 offen lds
    s_add_u32 m0, s22, 107520
    s_add_u32 s21, s91, 5504
    buffer_load_dwordx4 v38, s[76:79], s21 offen lds
    s_add_u32 m0, s22, 114688
    s_add_u32 s21, s91, 512
    buffer_load_dwordx4 v38, s[76:79], s21 offen lds
    s_add_u32 m0, s22, 115712
    s_add_u32 s21, s91, 5632
    buffer_load_dwordx4 v38, s[76:79], s21 offen lds
    s_add_u32 m0, s22, 122880
    s_add_u32 s21, s91, 81920
    buffer_load_dwordx4 v38, s[76:79], s21 offen lds
    s_add_u32 m0, s22, 123904
    s_add_u32 s21, s91, 87040
    buffer_load_dwordx4 v38, s[76:79], s21 offen lds
    s_add_u32 m0, s22, 131072
    s_add_u32 s21, s91, 82048
    buffer_load_dwordx4 v38, s[76:79], s21 offen lds
    s_add_u32 m0, s22, 132096
    s_add_u32 s21, s91, 87168
    buffer_load_dwordx4 v38, s[76:79], s21 offen lds
    s_add_u32 m0, s22, 139264
    s_add_u32 s21, s91, 82176
    buffer_load_dwordx4 v38, s[76:79], s21 offen lds
    s_add_u32 m0, s22, 140288
    s_add_u32 s21, s91, 87296
    buffer_load_dwordx4 v38, s[76:79], s21 offen lds
    s_add_u32 m0, s22, 147456
    s_add_u32 s21, s91, 82304
    buffer_load_dwordx4 v38, s[76:79], s21 offen lds
    s_add_u32 m0, s22, 148480
    s_add_u32 s21, s91, 87424
    buffer_load_dwordx4 v38, s[76:79], s21 offen lds
    s_add_u32 m0, s22, 155648
    s_add_u32 s21, s91, 82432
    buffer_load_dwordx4 v38, s[76:79], s21 offen lds
    s_add_u32 m0, s22, 156672
    s_add_u32 s21, s91, 87552
    buffer_load_dwordx4 v38, s[76:79], s21 offen lds
    s_waitcnt vmcnt(21)
    s_barrier
    s_mov_b32 s21, 0
    v_add_u32 v44, s21, v40
    v_add_u32 v45, s21, v41
    ds_read_b64_tr_b16 a[168:169], v44 offset:0
    ds_read_b64_tr_b16 a[170:171], v44 offset:4096
    ds_read_b64_tr_b16 a[172:173], v44 offset:8192
    ds_read_b64_tr_b16 a[174:175], v44 offset:12288
    ds_read_b64_tr_b16 a[184:185], v45 offset:0
    ds_read_b64_tr_b16 a[186:187], v45 offset:4096
    ds_read_b64_tr_b16 a[188:189], v45 offset:8192
    ds_read_b64_tr_b16 a[190:191], v45 offset:12288
    s_mov_b32 s21, 16384
    v_add_u32 v44, s21, v40
    v_add_u32 v45, s21, v41
    ds_read_b64_tr_b16 a[200:201], v44 offset:0
    ds_read_b64_tr_b16 a[202:203], v44 offset:4096
    ds_read_b64_tr_b16 a[204:205], v44 offset:8192
    ds_read_b64_tr_b16 a[206:207], v44 offset:12288
    ds_read_b64_tr_b16 a[216:217], v45 offset:0
    ds_read_b64_tr_b16 a[218:219], v45 offset:4096
    ds_read_b64_tr_b16 a[220:221], v45 offset:8192
    ds_read_b64_tr_b16 a[222:223], v45 offset:12288
    s_mov_b32 s21, 32768
    v_add_u32 v44, s21, v40
    v_add_u32 v45, s21, v41
    ds_read_b64_tr_b16 a[232:233], v44 offset:0
    ds_read_b64_tr_b16 a[234:235], v44 offset:4096
    ds_read_b64_tr_b16 a[236:237], v44 offset:8192
    ds_read_b64_tr_b16 a[238:239], v44 offset:12288
    ds_read_b64_tr_b16 a[248:249], v45 offset:0
    ds_read_b64_tr_b16 a[250:251], v45 offset:4096
    ds_read_b64_tr_b16 a[252:253], v45 offset:8192
    ds_read_b64_tr_b16 a[254:255], v45 offset:12288
    s_mov_b32 s21, 49152
    v_add_u32 v44, s21, v40
    v_add_u32 v45, s21, v41
    ds_read_b64_tr_b16 v[160:161], v44 offset:0
    ds_read_b64_tr_b16 v[162:163], v44 offset:4096
    ds_read_b64_tr_b16 v[164:165], v44 offset:8192
    ds_read_b64_tr_b16 v[166:167], v44 offset:12288
    ds_read_b64_tr_b16 v[176:177], v45 offset:0
    ds_read_b64_tr_b16 v[178:179], v45 offset:4096
    ds_read_b64_tr_b16 v[180:181], v45 offset:8192
    ds_read_b64_tr_b16 v[182:183], v45 offset:12288
    s_mov_b32 s21, 65536
    v_add_u32 v44, s21, v40
    v_add_u32 v45, s21, v41
    ds_read_b64_tr_b16 v[192:193], v44 offset:0
    ds_read_b64_tr_b16 v[194:195], v44 offset:4096
    ds_read_b64_tr_b16 v[196:197], v44 offset:8192
    ds_read_b64_tr_b16 v[198:199], v44 offset:12288
    ds_read_b64_tr_b16 v[208:209], v45 offset:0
    ds_read_b64_tr_b16 v[210:211], v45 offset:4096
    ds_read_b64_tr_b16 v[212:213], v45 offset:8192
    ds_read_b64_tr_b16 v[214:215], v45 offset:12288
    s_waitcnt lgkmcnt(0)
    s_barrier
    s_add_u32 m0, s88, 0
    s_add_u32 s21, s89, 0
    buffer_load_dwordx4 v36, s[72:75], s21 offen lds
    s_add_u32 m0, s88, 1024
    s_add_u32 s21, s89, 32768
    buffer_load_dwordx4 v37, s[72:75], s21 offen lds
    s_add_u32 m0, s88, 2048
    s_add_u32 s21, s89, 131072
    buffer_load_dwordx4 v36, s[72:75], s21 offen lds
    s_add_u32 m0, s88, 3072
    s_add_u32 s21, s89, 163840
    buffer_load_dwordx4 v37, s[72:75], s21 offen lds
    s_add_u32 m0, s88, 16384
    s_add_u32 s21, s89, 524288
    buffer_load_dwordx4 v36, s[72:75], s21 offen lds
    s_add_u32 m0, s88, 17408
    s_add_u32 s21, s89, 557056
    buffer_load_dwordx4 v37, s[72:75], s21 offen lds
    s_add_u32 m0, s88, 18432
    s_add_u32 s21, s89, 655360
    buffer_load_dwordx4 v36, s[72:75], s21 offen lds
    s_add_u32 m0, s88, 19456
    s_add_u32 s21, s89, 688128
    buffer_load_dwordx4 v37, s[72:75], s21 offen lds
    s_add_u32 m0, s88, 32768
    s_add_u32 s21, s89, 1048576
    buffer_load_dwordx4 v36, s[72:75], s21 offen lds
    s_add_u32 m0, s88, 33792
    s_add_u32 s21, s89, 1081344
    buffer_load_dwordx4 v37, s[72:75], s21 offen lds
    s_add_u32 m0, s88, 34816
    s_add_u32 s21, s89, 1179648
    buffer_load_dwordx4 v36, s[72:75], s21 offen lds
    s_add_u32 m0, s88, 35840
    s_add_u32 s21, s89, 1212416
    buffer_load_dwordx4 v37, s[72:75], s21 offen lds
    s_add_u32 m0, s88, 49152
    s_add_u32 s21, s89, 1572864
    buffer_load_dwordx4 v36, s[72:75], s21 offen lds
    s_add_u32 m0, s88, 50176
    s_add_u32 s21, s89, 1605632
    buffer_load_dwordx4 v37, s[72:75], s21 offen lds
    s_add_u32 m0, s88, 51200
    s_add_u32 s21, s89, 1703936
    buffer_load_dwordx4 v36, s[72:75], s21 offen lds
    s_add_u32 m0, s88, 52224
    s_add_u32 s21, s89, 1736704
    buffer_load_dwordx4 v37, s[72:75], s21 offen lds
    s_add_u32 m0, s88, 65536
    s_add_u32 s21, s89, 2097152
    buffer_load_dwordx4 v36, s[72:75], s21 offen lds
    s_add_u32 m0, s88, 66560
    s_add_u32 s21, s89, 2129920
    buffer_load_dwordx4 v37, s[72:75], s21 offen lds
    s_add_u32 m0, s88, 67584
    s_add_u32 s21, s89, 2228224
    buffer_load_dwordx4 v36, s[72:75], s21 offen lds
    s_add_u32 m0, s88, 68608
    s_add_u32 s21, s89, 2260992
    buffer_load_dwordx4 v37, s[72:75], s21 offen lds
    s_waitcnt vmcnt(20)
    s_barrier
    ds_read_b64_tr_b16 v[56:57], v48 offset:0
    ds_read_b64_tr_b16 v[58:59], v48 offset:2048
    ds_read_b64_tr_b16 v[60:61], v48 offset:4096
    ds_read_b64_tr_b16 v[62:63], v48 offset:6144
    ds_read_b64_tr_b16 v[64:65], v49 offset:0
    ds_read_b64_tr_b16 v[66:67], v49 offset:2048
    ds_read_b64_tr_b16 v[68:69], v49 offset:4096
    ds_read_b64_tr_b16 v[70:71], v49 offset:6144
    ds_read_b64_tr_b16 v[72:73], v50 offset:0
    ds_read_b64_tr_b16 v[74:75], v50 offset:2048
    ds_read_b64_tr_b16 v[76:77], v50 offset:4096
    ds_read_b64_tr_b16 v[78:79], v50 offset:6144
    ds_read_b64_tr_b16 v[80:81], v51 offset:0
    ds_read_b64_tr_b16 v[82:83], v51 offset:2048
    ds_read_b64_tr_b16 v[84:85], v51 offset:4096
    ds_read_b64_tr_b16 v[86:87], v51 offset:6144
    ds_read_b64_tr_b16 v[88:89], v52 offset:0
    ds_read_b64_tr_b16 v[90:91], v52 offset:2048
    ds_read_b64_tr_b16 v[92:93], v52 offset:4096
    ds_read_b64_tr_b16 v[94:95], v52 offset:6144
    ds_read_b64_tr_b16 v[216:217], v48 offset:40960
    ds_read_b64_tr_b16 v[218:219], v48 offset:43008
    ds_read_b64_tr_b16 v[220:221], v48 offset:45056
    ds_read_b64_tr_b16 v[222:223], v48 offset:47104
    ds_read_b64_tr_b16 v[224:225], v49 offset:40960
    ds_read_b64_tr_b16 v[226:227], v49 offset:43008
    ds_read_b64_tr_b16 v[228:229], v49 offset:45056
    ds_read_b64_tr_b16 v[230:231], v49 offset:47104
    ds_read_b64_tr_b16 v[232:233], v50 offset:40960
    ds_read_b64_tr_b16 v[234:235], v50 offset:43008
    ds_read_b64_tr_b16 v[236:237], v50 offset:45056
    ds_read_b64_tr_b16 v[238:239], v50 offset:47104
    ds_read_b64_tr_b16 v[240:241], v51 offset:40960
    ds_read_b64_tr_b16 v[242:243], v51 offset:43008
    ds_read_b64_tr_b16 v[244:245], v51 offset:45056
    ds_read_b64_tr_b16 v[246:247], v51 offset:47104
    ds_read_b64_tr_b16 v[248:249], v52 offset:40960
    ds_read_b64_tr_b16 v[250:251], v52 offset:43008
    ds_read_b64_tr_b16 v[252:253], v52 offset:45056
    ds_read_b64_tr_b16 v[254:255], v52 offset:47104
    s_waitcnt lgkmcnt(0)
    buffer_load_dwordx4 v[148:151], off, s[12:15], 0 sc1
    s_waitcnt vmcnt(0)
    s_barrier
    s_mov_b32 s21, 32768
    v_add_u32 v44, s21, v42
    v_add_u32 v45, s21, v43
    ds_read_b64_tr_b16 v[100:101], v44 offset:0
    ds_read_b64_tr_b16 v[102:103], v44 offset:4096
    ds_read_b64_tr_b16 v[104:105], v44 offset:8192
    ds_read_b64_tr_b16 v[106:107], v44 offset:12288
    ds_read_b64_tr_b16 v[108:109], v45 offset:0
    ds_read_b64_tr_b16 v[110:111], v45 offset:4096
    ds_read_b64_tr_b16 v[112:113], v45 offset:8192
    ds_read_b64_tr_b16 v[114:115], v45 offset:12288
    s_mov_b32 s21, 49152
    v_add_u32 v44, s21, v42
    v_add_u32 v45, s21, v43
    ds_read_b64_tr_b16 v[116:117], v44 offset:0
    ds_read_b64_tr_b16 v[118:119], v44 offset:4096
    ds_read_b64_tr_b16 v[120:121], v44 offset:8192
    ds_read_b64_tr_b16 v[122:123], v44 offset:12288
    ds_read_b64_tr_b16 v[124:125], v45 offset:0
    ds_read_b64_tr_b16 v[126:127], v45 offset:4096
    ds_read_b64_tr_b16 v[128:129], v45 offset:8192
    ds_read_b64_tr_b16 v[130:131], v45 offset:12288
    s_mov_b32 s21, 65536
    v_add_u32 v44, s21, v42
    v_add_u32 v45, s21, v43
    ds_read_b64_tr_b16 v[132:133], v44 offset:0
    ds_read_b64_tr_b16 v[134:135], v44 offset:4096
    ds_read_b64_tr_b16 v[136:137], v44 offset:8192
    ds_read_b64_tr_b16 v[138:139], v44 offset:12288
    ds_read_b64_tr_b16 v[140:141], v45 offset:0
    ds_read_b64_tr_b16 v[142:143], v45 offset:4096
    ds_read_b64_tr_b16 v[144:145], v45 offset:8192
    ds_read_b64_tr_b16 v[146:147], v45 offset:12288
    s_waitcnt lgkmcnt(0)
    s_barrier
    ds_write_b128 v19, v[56:59] offset:20480
    ds_write_b128 v19, v[60:63] offset:21504
    ds_write_b128 v19, v[64:67] offset:22528
    ds_write_b128 v19, v[68:71] offset:23552
    ds_write_b128 v19, v[72:75] offset:24576
    ds_write_b128 v19, v[76:79] offset:25600
    ds_write_b128 v19, v[80:83] offset:26624
    ds_write_b128 v19, v[84:87] offset:27648
    ds_write_b128 v19, v[88:91] offset:28672
    ds_write_b128 v19, v[92:95] offset:29696
    s_waitcnt lgkmcnt(0)
    s_mov_b32 s21, 0
    v_add_u32 v44, s21, v42
    v_add_u32 v45, s21, v43
    ds_read_b64_tr_b16 v[56:57], v44 offset:0
    ds_read_b64_tr_b16 v[58:59], v44 offset:4096
    ds_read_b64_tr_b16 v[60:61], v44 offset:8192
    ds_read_b64_tr_b16 v[62:63], v44 offset:12288
    ds_read_b64_tr_b16 v[64:65], v45 offset:0
    ds_read_b64_tr_b16 v[66:67], v45 offset:4096
    ds_read_b64_tr_b16 v[68:69], v45 offset:8192
    ds_read_b64_tr_b16 v[70:71], v45 offset:12288
    s_mov_b32 s21, 16384
    v_add_u32 v44, s21, v42
    v_add_u32 v45, s21, v43
    ds_read_b64_tr_b16 v[72:73], v44 offset:0
    ds_read_b64_tr_b16 v[74:75], v44 offset:4096
    ds_read_b64_tr_b16 v[76:77], v44 offset:8192
    ds_read_b64_tr_b16 v[78:79], v44 offset:12288
    ds_read_b64_tr_b16 v[80:81], v45 offset:0
    ds_read_b64_tr_b16 v[82:83], v45 offset:4096
    ds_read_b64_tr_b16 v[84:85], v45 offset:8192
    ds_read_b64_tr_b16 v[86:87], v45 offset:12288
    s_xor_b32 s21, s5, 2
    s_lshl_b32 s21, s21, 12
    v_add_u32 v44, s21, v19
    ds_write_b128 v44, v[100:103] offset:0
    ds_write_b128 v44, v[104:107] offset:1024
    ds_write_b128 v44, v[108:111] offset:2048
    ds_write_b128 v44, v[112:115] offset:3072
    s_xor_b32 s21, s5, 3
    s_lshl_b32 s21, s21, 12
    v_add_u32 v44, s21, v19
    ds_write_b128 v44, v[116:119] offset:0
    ds_write_b128 v44, v[120:123] offset:1024
    ds_write_b128 v44, v[124:127] offset:2048
    ds_write_b128 v44, v[128:131] offset:3072
    s_mov_b32 s21, 16384
    v_add_u32 v44, s21, v19
    ds_write_b128 v44, v[132:135] offset:0
    ds_write_b128 v44, v[136:139] offset:1024
    ds_write_b128 v44, v[140:143] offset:2048
    ds_write_b128 v44, v[144:147] offset:3072
    s_waitcnt lgkmcnt(0)
    s_xor_b32 s21, s5, 0
    s_lshl_b32 s21, s21, 12
    v_add_u32 v44, s21, v19
    ds_write_b128 v44, v[56:59] offset:0
    ds_write_b128 v44, v[60:63] offset:1024
    ds_write_b128 v44, v[64:67] offset:2048
    ds_write_b128 v44, v[68:71] offset:3072
    s_xor_b32 s21, s5, 1
    s_lshl_b32 s21, s21, 12
    v_add_u32 v44, s21, v19
    ds_write_b128 v44, v[72:75] offset:0
    ds_write_b128 v44, v[76:79] offset:1024
    ds_write_b128 v44, v[80:83] offset:2048
    ds_write_b128 v44, v[84:87] offset:3072
    s_waitcnt lgkmcnt(0)
    v_lshlrev_b32 v32, 16, v33
    s_mov_b32 s24, 200000
C_TEAM:
    v_readfirstlane_b32 s21, v148
    v_readfirstlane_b32 s22, v151
    s_nop 0
    s_cmp_lg_u32 s22, 0
    s_cselect_b32 s21, s21, 0
    s_cmp_ge_u32 s21, 64
    s_cbranch_scc1 C_TEAM_OK
    s_sleep 8
    buffer_load_dwordx4 v[148:151], off, s[12:15], 0 sc1
    s_waitcnt vmcnt(0)
    s_sub_u32 s24, s24, 1
    s_cbranch_scc0 C_TEAM
    s_branch C_FAIL
C_TEAM_OK:
    s_mov_b32 s47, 0
    v_readfirstlane_b32 s21, v149
    v_readfirstlane_b32 s22, v150
    v_readfirstlane_b32 s23, v151
    s_cmp_eq_u32 s3, 0
    s_cselect_b32 s21, s21, s22
    s_bcnt1_i32_b32 s58, s21
    s_and_b32 s23, s23, 1
    s_lshl_b32 s23, s23, 13
    s_add_u32 s27, s27, s23
    s_add_u32 s28, s28, s23
    s_add_u32 s29, s29, s23
    s_add_u32 s30, s30, s23
    s_add_u32 s40, s40, s23
    s_add_u32 s59, s40, s34
    s_lshl_b32 s53, s5, 11
    s_cmp_eq_u32 s5, 3
    s_cselect_b32 s39, 0, 0x80000000
    v_mov_b32 v101, 0x80000000
    v_lshlrev_b32 v100, 5, v35
    v_cmp_gt_u32 vcc, 16, v35
    s_nop 1
    v_cndmask_b32 v0, v101, v100, vcc
    s_cmp_eq_u32 s33, 0
    s_cselect_b32 s56, 0x80000000, s56
    v_writelane_b32 v0, s56, 4
    s_cmp_eq_u32 s5, 3
    s_cselect_b32 s56, 0, 0x80000000
    s_or_b32 s56, s56, 512
    v_mov_b32 v5, v101
    v_writelane_b32 v5, s56, 0
    v_and_b32 v100, 0x80, v18
    v_lshrrev_b32 v100, 3, v100
    v_xor_b32 v18, v18, v100
    s_mov_b32 s20, -1
    s_mov_b32 s42, 0
    s_mov_b32 s35, 1
    s_mov_b32 s50, s54
    s_mov_b32 s51, s54
    s_add_u32 s64, s31, s48
    s_mul_i32 s66, s5, 40960
    s_lshl_b32 s21, s4, 6
    s_add_u32 s66, s66, s21
    s_add_u32 s66, s66, s31
    s_mov_b32 s67, s29
    s_mov_b32 s68, s30
    s_mov_b32 s69, s26
    s_mov_b32 s70, s27
    s_mov_b32 s71, s28
    s_add_u32 s72, s64, 163840
    s_xor_b32 s72, s72, s64
    s_add_u32 s74, s66, 163840
    s_xor_b32 s74, s74, s66
    s_add_u32 s75, s67, 1048576
    s_xor_b32 s75, s75, s67
    s_add_u32 s76, s68, 1048576
    s_xor_b32 s76, s76, s68
    s_add_u32 s77, s69, 8192
    s_xor_b32 s77, s77, s69
    s_add_u32 s48, s70, 1048576
    s_xor_b32 s48, s48, s70
    s_add_u32 s49, s71, 1048576
    s_xor_b32 s49, s49, s71
    s_xor_b32 s64, s64, s72
    s_xor_b32 s66, s66, s74
    s_xor_b32 s67, s67, s75
    s_xor_b32 s68, s68, s76
    s_xor_b32 s71, s71, s49
    s_lshl_b32 s43, s5, 10
    s_lshl_b32 s44, s5, 8
    s_add_u32 s44, s44, 4096
    s_mov_b32 s45, 0x1f800000
    s_mov_b32 s46, 0x40000000
    s_cmp_eq_u32 s3, 0
    s_cbranch_scc1 C_GO0
    s_cmp_eq_u32 s58, 1
    s_cbranch_scc1 CF1_ENTRY
    s_branch CS1_ENTRY
C_GO0:
    s_cmp_eq_u32 s58, 1
    s_cbranch_scc0 CS0_ENTRY
    s_branch CF0_ENTRY
    .p2align 6
CF0_ENTRY:
    s_cmp_eq_u32 s33, 0
    s_cbranch_scc0 CF0_PUB0
CF0_TOPN:
    ds_read_b128 v[100:103], v19 offset:0
    v_mov_b32 v36, s35
    s_max_i32 s23, s20, 0
    ds_read_b128 v[104:107], v19 offset:1024
    v_mov_b32 v37, s35
    s_add_u32 s20, s20, 1
    ds_read_b128 v[108:111], v19 offset:2048
    v_mov_b32 v38, s35
    s_add_u32 s21, s20, 1
    ds_read_b128 v[112:115], v19 offset:3072
    v_mov_b32 v39, s35
    v_mov_b64 v[76:77], 0
    s_bfe_u32 s16, s21, 0x10001
    ds_read_b128 v[116:119], v19 offset:4096
    v_mov_b64 v[78:79], 0
    s_mov_b32 s37, s67
    ds_read_b128 v[120:123], v19 offset:5120
    v_mov_b64 v[80:81], 0
    s_xor_b32 s67, s67, s75
    ds_read_b128 v[124:127], v19 offset:6144
    v_mov_b64 v[82:83], 0
    s_xor_b32 s68, s68, s76
    ds_read_b128 v[128:131], v19 offset:7168
    v_mov_b64 v[84:85], 0
    v_mov_b64 v[86:87], 0
    s_xor_b32 s66, s66, s74
    s_barrier
CF0_TOP2:
    s_mov_b32 s36, s69
    v_mov_b32 v32, s35
    s_mov_b32 s41, s42
    s_mov_b32 s42, s16
    s_xor_b32 s35, s16, 1
    s_lshl1_add_u32 s23, s23, s35
    v_max_i32 v33, v1, v18
    s_xor_b32 s69, s69, s77
    s_xor_b32 s70, s70, s48
    s_xor_b32 s64, s64, s72
    v_max_i32 v33, v1, v18
    ds_read_b128 v[132:135], v19 offset:8192
    v_mov_b64 v[88:89], 0
    s_xor_b32 s71, s71, s49
    ds_read_b128 v[136:139], v19 offset:9216
    v_mov_b64 v[90:91], 0
    s_add_u32 s38, s40, 0x2000000
    ds_read_b128 v[140:143], v19 offset:10240
    v_mov_b64 v[92:93], 0
    s_add_u32 s55, s59, 4096
    ds_read_b128 v[144:147], v19 offset:11264
    v_mov_b64 v[94:95], 0
    v_mov_b64 v[96:97], 0
    s_add_u32 s59, s40, s34
    ds_read_b128 v[60:63], v19 offset:12288
    v_mov_b64 v[98:99], 0
    s_add_u32 s40, s40, 524288
    ds_read_b128 v[64:67], v19 offset:13312
    v_xor_b32 v40, 1024, v26
    s_and_b32 s22, s21, 3
    s_cselect_b32 s22, 0, 8192
    ds_read_b128 v[68:71], v19 offset:14336
    v_xor_b32 v44, 2048, v26
    s_xor_b32 s40, s40, s22
    ds_read_b128 v[72:75], v19 offset:15360
    v_xor_b32 v48, 3072, v26
    v_xor_b32 v23, 8192, v23
    s_xor_b32 s53, s53, 8192
    s_add_u32 m0, s43, 24576
    buffer_load_dwordx4 v[36:39], v26, s[8:11], s36 offen offset:0 sc1
    buffer_load_dword v32, v27, s[8:11], s36 offen sc1
    v_max_i32 v33, v1, v18
    v_max_i32 v33, v1, v18
    v_max_i32 v33, v1, v18
    v_max_i32 v33, v1, v18
    v_max_i32 v33, v1, v18
    v_max_i32 v33, v1, v18
    v_max_i32 v33, v1, v18
    v_max_i32 v33, v1, v18
    v_max_i32 v33, v1, v18
    v_max_i32 v33, v1, v18
    v_max_i32 v33, v1, v18
    v_max_i32 v33, v1, v18
    v_max_i32 v33, v1, v18
    v_max_i32 v33, v1, v18
    v_max_i32 v33, v1, v18
    v_max_i32 v33, v1, v18
    v_max_i32 v33, v1, v18
    v_max_i32 v33, v1, v18
    v_max_i32 v33, v1, v18
    v_max_i32 v33, v1, v18
    v_max_i32 v33, v1, v18
    v_max_i32 v33, v1, v18
    v_max_i32 v33, v1, v18
    v_max_i32 v33, v1, v18
    v_max_i32 v33, v1, v18
    buffer_load_dwordx4 v[36:39], v26, s[8:11], s36 offen offset:0 sc1
    buffer_load_dword v32, v27, s[8:11], s36 offen sc1
    v_max_i32 v33, v1, v18
    v_max_i32 v33, v1, v18
    v_max_i32 v33, v1, v18
    v_max_i32 v33, v1, v18
    v_max_i32 v33, v1, v18
    v_max_i32 v33, v1, v18
    v_max_i32 v33, v1, v18
    v_max_i32 v33, v1, v18
    v_max_i32 v33, v1, v18
    v_max_i32 v33, v1, v18
    v_max_i32 v33, v1, v18
    v_max_i32 v33, v1, v18
    v_max_i32 v33, v1, v18
    v_max_i32 v33, v1, v18
    v_max_i32 v33, v1, v18
    v_max_i32 v33, v1, v18
    v_max_i32 v33, v1, v18
    v_max_i32 v33, v1, v18
    v_max_i32 v33, v1, v18
    v_max_i32 v33, v1, v18
    v_max_i32 v33, v1, v18
    v_max_i32 v33, v1, v18
    v_max_i32 v33, v1, v18
    v_max_i32 v33, v1, v18
    v_max_i32 v33, v1, v18
    s_cmp_ge_u32 s21, s47
    s_cbranch_scc1 CF0_KVW
CF0_KVB:
    s_waitcnt lgkmcnt(0)
CF0_LC:
    s_waitcnt vmcnt(2)
    v_bitop3_b32 v14, v36, v37, s41 bitop3:0x7e
    v_bitop3_b32 v15, v38, v39, s41 bitop3:0x7e
    v_bitop3_b32 v14, v14, v32, s41 bitop3:0xf6
    v_bitop3_b32 v14, v14, v15, 1 bitop3:0xa8
    v_cmp_ne_u32 vcc, 0, v14
    ds_write_b128 v26, v[36:39] offset:16384
    s_cbranch_vccnz CF0_LS
    s_barrier
    v_smfmac_f32_16x16x64_bf16 v[76:79], v[36:39], v[100:107], v34
    ds_write_b32 v27, v32 offset:16384
    buffer_load_dwordx4 v[56:59], v26, s[8:11], s71 offen offset:0 sc1
    v_smfmac_f32_16x16x64_bf16 v[80:83], v[36:39], v[108:115], v34
    buffer_load_dword v148, v27, s[8:11], s71 offen sc1
    v_smfmac_f32_16x16x64_bf16 v[84:87], v[36:39], a[0:7], v34
    s_waitcnt lgkmcnt(0)
    s_barrier
    ds_read_b128 v[40:43], v40 offset:16384
    v_smfmac_f32_16x16x64_bf16 v[88:91], v[36:39], a[16:23], v34
    ds_read_b128 v[44:47], v44 offset:16384
    buffer_load_dwordx4 v26, s[8:11], s71 offen sc1 lds
    v_smfmac_f32_16x16x64_bf16 v[92:95], v[36:39], a[8:15], v34
    ds_read_b128 v[48:51], v48 offset:16384
    s_add_u32 m0, s44, 24576
    v_smfmac_f32_16x16x64_bf16 v[96:99], v[36:39], a[24:31], v34
    ds_read_b128 v[52:55], v1 offset:20480
    s_waitcnt lgkmcnt(3)
    v_smfmac_f32_16x16x64_bf16 v[76:79], v[40:43], v[116:123], v34
    ds_read_b128 v[100:103], v19 offset:16384
    buffer_load_dword v27, s[8:11], s71 offen sc1 lds
    v_smfmac_f32_16x16x64_bf16 v[80:83], v[40:43], v[124:131], v34
    ds_read_b128 v[104:107], v19 offset:17408
    s_waitcnt lgkmcnt(4)
    v_smfmac_f32_16x16x64_bf16 v[76:79], v[44:47], v[132:139], v34
    ds_read_b128 v[108:111], v19 offset:18432
    v_mov_b32 v150, s23
    v_smfmac_f32_16x16x64_bf16 v[80:83], v[44:47], v[140:147], v34
    ds_read_b128 v[112:115], v19 offset:19456
    s_waitcnt lgkmcnt(5)
    v_smfmac_f32_16x16x64_bf16 v[76:79], v[48:51], v[60:67], v34
    v_smfmac_f32_16x16x64_bf16 v[80:83], v[48:51], v[68:75], v34
    buffer_store_dword v150, v5, s[8:11], s37 offen offset:0 sc1
    v_xor_b32 v138, 8, v18
    v_smfmac_f32_16x16x64_bf16 v[84:87], v[40:43], a[32:39], v34
    buffer_store_dword v21, v35, s[8:11], s55 offen offset:0 sc1
    v_smfmac_f32_16x16x64_bf16 v[88:91], v[40:43], a[48:55], v34
    s_waitcnt lgkmcnt(0)
    v_smfmac_f32_16x16x64_bf16 v[76:79], v[52:55], v[100:107], v34
    s_nop 1
    v_smfmac_f32_16x16x64_bf16 v[80:83], v[52:55], v[108:115], v34
    ds_read_b128 v[100:103], v23 offset:0
    s_nop 0
    v_smfmac_f32_16x16x64_bf16 v[84:87], v[44:47], a[64:71], v34
    ds_read_b128 v[108:111], v23 offset:2048
    s_nop 0
    v_smfmac_f32_16x16x64_bf16 v[88:91], v[44:47], a[80:87], v34
    v_add_f32 v76, v76, v78
    v_add_f32 v77, v77, v79
    v_cvt_pk_bf16_f32 v132, v76, v77
    v_and_or_b32 v132, v132, -2, s41
    v_smfmac_f32_16x16x64_bf16 v[84:87], v[48:51], a[96:103], v34
    buffer_store_dword v132, v35, s[8:11], s67 offen offset:0 sc1
    v_add_f32 v80, v80, v82
    v_add_f32 v81, v81, v83
    v_cvt_pk_bf16_f32 v134, v80, v81
    v_and_or_b32 v134, v134, -2, s41
    v_smfmac_f32_16x16x64_bf16 v[88:91], v[48:51], a[112:119], v34
    buffer_store_dword v134, v35, s[8:11], s67 offen offset:256 sc1
    v_smfmac_f32_16x16x64_bf16 v[84:87], v[52:55], a[128:135], v34
    ds_read_b128 v[116:119], v23 offset:4096
    buffer_load_dwordx4 v[140:143], v31, s[8:11], s38 offen offset:0 sc1
    v_smfmac_f32_16x16x64_bf16 v[88:91], v[52:55], a[144:151], v34
    ds_read_b128 v[124:127], v23 offset:6144
    buffer_load_dwordx4 v[144:147], v31, s[8:11], s38 offen offset:256 sc1
    v_smfmac_f32_16x16x64_bf16 v[92:95], v[40:43], a[40:47], v34
    buffer_store_dword v132, v35, s[8:11], s59 offen offset:0 sc1
    v_smfmac_f32_16x16x64_bf16 v[96:99], v[40:43], a[56:63], v34
    buffer_store_dword v134, v35, s[8:11], s59 offen offset:256 sc1
    v_smfmac_f32_16x16x64_bf16 v[92:95], v[44:47], a[72:79], v34
    s_waitcnt vmcnt(8)
    v_bitop3_b32 v14, v56, v57, s41 bitop3:0x7e
    v_bitop3_b32 v15, v58, v59, s41 bitop3:0x7e
    v_smfmac_f32_16x16x64_bf16 v[96:99], v[44:47], a[88:95], v34
    v_bitop3_b32 v14, v14, v148, s41 bitop3:0xf6
    v_bitop3_b32 v14, v14, v15, 1 bitop3:0xa8
    v_cmp_ne_u32 vcc, 0, v14
    v_smfmac_f32_16x16x64_bf16 v[92:95], v[48:51], a[104:111], v34
    v_smfmac_f32_16x16x64_bf16 v[96:99], v[48:51], a[120:127], v34
    s_cbranch_vccnz CF0_RS
CF0_ROK:
    s_barrier
    ds_read_b128 v[56:59], v1 offset:24576
    v_smfmac_f32_16x16x64_bf16 v[92:95], v[52:55], a[136:143], v34
    ds_read_b128 v[60:63], v1 offset:25600
    v_smfmac_f32_16x16x64_bf16 v[96:99], v[52:55], a[152:159], v34
    ds_read_b128 v[64:67], v1 offset:26624
    s_waitcnt lgkmcnt(2)
    v_smfmac_f32_16x16x64_bf16 v[84:87], v[56:59], a[160:167], v34
    ds_read_b128 v[68:71], v1 offset:27648
    v_smfmac_f32_16x16x64_bf16 v[88:91], v[56:59], a[176:183], v34
    ds_read_b128 v[72:75], v1 offset:28672
    s_waitcnt lgkmcnt(3)
    v_smfmac_f32_16x16x64_bf16 v[84:87], v[60:63], a[192:199], v34
    ds_read_b128 v[104:107], v23 offset:1024
    v_smfmac_f32_16x16x64_bf16 v[88:91], v[60:63], a[208:215], v34
    ds_read_b128 v[112:115], v23 offset:3072
    s_waitcnt lgkmcnt(4)
    v_smfmac_f32_16x16x64_bf16 v[84:87], v[64:67], a[224:231], v34
    ds_read_b128 v[120:123], v23 offset:5120
    v_smfmac_f32_16x16x64_bf16 v[88:91], v[64:67], a[240:247], v34
    ds_read_b128 v[128:131], v23 offset:7168
    s_waitcnt lgkmcnt(5)
    v_smfmac_f32_16x16x64_bf16 v[84:87], v[68:71], v[152:159], v34
    buffer_store_dword v150, v0, s[8:11], s37 offen offset:0 sc1
    v_smfmac_f32_16x16x64_bf16 v[88:91], v[68:71], v[168:175], v34
    s_waitcnt lgkmcnt(4)
    v_smfmac_f32_16x16x64_bf16 v[84:87], v[72:75], v[184:191], v34
    s_nop 1
    v_smfmac_f32_16x16x64_bf16 v[88:91], v[72:75], v[200:207], v34
    s_nop 1
    v_smfmac_f32_16x16x64_bf16 v[92:95], v[56:59], a[168:175], v34
    s_nop 1
    v_smfmac_f32_16x16x64_bf16 v[96:99], v[56:59], a[184:191], v34
    v_add_f32 v84, v84, v86
    v_add_f32 v85, v85, v87
    v_mul_f32 v84, s54, v84
    v_mul_f32 v85, s54, v85
    v_smfmac_f32_16x16x64_bf16 v[92:95], v[60:63], a[200:207], v34
    v_add_f32 v88, v88, v90
    v_add_f32 v89, v89, v91
    v_mul_f32 v88, s54, v88
    v_mul_f32 v89, s54, v89
    v_smfmac_f32_16x16x64_bf16 v[96:99], v[60:63], a[216:223], v34
    v_cvt_pk_bf16_f32 v21, v84, v85
    v_cvt_pk_bf16_f32 v22, v88, v89
    ds_write2_b32 v20, v21, v22 offset0:0 offset1:64
    v_smfmac_f32_16x16x64_bf16 v[92:95], v[64:67], a[232:239], v34
    buffer_load_dword v133, v35, s[8:11], s68 offen offset:0 sc1
    v_smfmac_f32_16x16x64_bf16 v[96:99], v[64:67], a[248:255], v34
    buffer_load_dword v135, v35, s[8:11], s68 offen offset:256 sc1
    v_smfmac_f32_16x16x64_bf16 v[92:95], v[68:71], v[160:167], v34
    s_waitcnt lgkmcnt(0)
    s_barrier
    ds_read_b64_tr_b16 v[36:37], v18 offset:30720
    v_smfmac_f32_16x16x64_bf16 v[96:99], v[68:71], v[176:183], v34
    ds_read_b64_tr_b16 v[38:39], v138 offset:31232
    ds_read_b64_tr_b16 v[40:41], v18 offset:31744
    v_smfmac_f32_16x16x64_bf16 v[92:95], v[72:75], v[192:199], v34
    ds_read_b64_tr_b16 v[42:43], v138 offset:32256
    ds_read_b64_tr_b16 v[44:45], v18 offset:32768
    v_smfmac_f32_16x16x64_bf16 v[96:99], v[72:75], v[208:215], v34
    ds_read_b64_tr_b16 v[46:47], v138 offset:33280
    ds_read_b64_tr_b16 v[48:49], v18 offset:33792
    ds_read_b64_tr_b16 v[50:51], v138 offset:34304
    s_nop 1
    v_add_f32 v92, v92, v94
    v_add_f32 v93, v93, v95
    s_nop 0
    v_add_f32 v96, v96, v98
    v_add_f32 v97, v97, v99
    v_cvt_pk_bf16_f32 v21, v92, v93
    v_cvt_pk_bf16_f32 v22, v96, v97
    ds_write2_b32 v20, v21, v22 offset0:1 offset1:65
    s_waitcnt lgkmcnt(7)
    v_mfma_f32_16x16x32_bf16 v[84:87], v[100:103], v[36:39], 0
    buffer_load_dword v133, v35, s[8:11], s68 offen offset:0 sc1
    s_waitcnt lgkmcnt(5)
    v_mfma_f32_16x16x32_bf16 v[84:87], v[108:111], v[40:43], v[84:87]
    buffer_load_dword v135, v35, s[8:11], s68 offen offset:256 sc1
    s_waitcnt lgkmcnt(3)
    v_mfma_f32_16x16x32_bf16 v[84:87], v[116:119], v[44:47], v[84:87]
    s_cmp_eq_u32 s20, 63
    s_waitcnt lgkmcnt(1)
    v_mfma_f32_16x16x32_bf16 v[84:87], v[124:127], v[48:51], v[84:87]
    s_waitcnt lgkmcnt(0)
    s_barrier
    ds_read_b64_tr_b16 v[56:57], v18 offset:30720
    ds_read_b64_tr_b16 v[58:59], v138 offset:31232
    s_cbranch_scc1 C_LAST0
    v_mfma_f32_16x16x32_bf16 v[88:91], v[104:107], v[36:39], 0
    ds_read_b64_tr_b16 v[60:61], v18 offset:31744
    ds_read_b64_tr_b16 v[62:63], v138 offset:32256
    v_mfma_f32_16x16x32_bf16 v[88:91], v[112:115], v[40:43], v[88:91]
    ds_read_b64_tr_b16 v[64:65], v18 offset:32768
    ds_read_b64_tr_b16 v[66:67], v138 offset:33280
    v_exp_f32 v148, v84
    v_mfma_f32_16x16x32_bf16 v[88:91], v[120:123], v[44:47], v[88:91]
    ds_read_b64_tr_b16 v[68:69], v18 offset:33792
    ds_read_b64_tr_b16 v[70:71], v138 offset:34304
    v_exp_f32 v149, v85
    v_mfma_f32_16x16x32_bf16 v[88:91], v[128:131], v[48:51], v[88:91]
    v_exp_f32 v150, v86
    v_exp_f32 v151, v87
    v_cvt_pk_bf16_f32 v52, v148, v149
    v_cvt_pk_bf16_f32 v53, v150, v151
    s_add_u32 m0, s53, 0
    s_waitcnt lgkmcnt(6)
    v_mfma_f32_16x16x32_bf16 v[92:95], v[56:59], v[36:39], 0
    buffer_load_dwordx4 v30, s[8:11], s40 offen offset:0 sc1 lds
    v_exp_f32 v148, v88
    s_waitcnt lgkmcnt(4)
    v_mfma_f32_16x16x32_bf16 v[92:95], v[60:63], v[40:43], v[92:95]
    s_add_u32 m0, s53, 896
    v_exp_f32 v149, v89
    s_waitcnt lgkmcnt(2)
    v_mfma_f32_16x16x32_bf16 v[92:95], v[64:67], v[44:47], v[92:95]
    buffer_load_dwordx4 v30, s[8:11], s40 offen offset:128 sc1 lds
    v_exp_f32 v150, v90
    s_waitcnt lgkmcnt(0)
    v_mfma_f32_16x16x32_bf16 v[92:95], v[68:71], v[48:51], v[92:95]
    v_exp_f32 v151, v91
    v_cvt_pk_bf16_f32 v54, v148, v149
    v_cvt_pk_bf16_f32 v55, v150, v151
    s_waitcnt vmcnt(4)
    v_bitop3_b32 v14, v133, v135, s41 bitop3:0x7e
    v_and_b32 v14, 1, v14
    v_mfma_f32_16x16x32_bf16 v[96:99], v[10:13], v[52:55], 0
    v_cmp_ne_u32 vcc, 0, v14
    v_exp_f32 v148, v94
    v_mfma_f32_16x16x32_bf16 v[76:79], v[140:143], v[52:55], 0
    v_exp_f32 v149, v95
    v_mfma_f32_16x16x32_bf16 v[80:83], v[144:147], v[52:55], 0
    v_cvt_pk_bf16_f32 v136, v148, v149
    v_cvt_pk_bf16_f32 v137, v148, v149
    s_nop 1
    v_mfma_f32_16x16x16_bf16 v[96:99], v[2:3], v[136:137], v[96:99]
    s_cbranch_vccnz CF0_RV
CF0_BV:
    v_mfma_f32_16x16x16_bf16 v[76:79], v[132:133], v[136:137], v[76:79]
    ds_read_b128 v[100:103], v19 offset:20480
    v_mfma_f32_16x16x16_bf16 v[80:83], v[134:135], v[136:137], v[80:83]
    ds_read_b128 v[104:107], v19 offset:21504
    ds_read_b128 v[108:111], v19 offset:22528
    s_nop 1
    v_rcp_f32 v32, v96
    v_subrev_u32 v33, s45, v96
    v_cmp_le_u32 vcc, s46, v33
    v_mul_f32 v148, v76, v32
    v_mul_f32 v149, v77, v32
    v_mul_f32 v150, v78, v32
    v_mul_f32 v151, v79, v32
    v_cvt_pk_bf16_f32 v64, v148, v149
    v_cvt_pk_bf16_f32 v65, v150, v151
    ds_write_b64 v24, v[64:65]
    v_mul_f32 v148, v80, v32
    v_mul_f32 v149, v81, v32
    v_mul_f32 v150, v82, v32
    v_mul_f32 v151, v83, v32
    v_cvt_pk_bf16_f32 v66, v148, v149
    v_cvt_pk_bf16_f32 v67, v150, v151
    s_and_b64 vcc, vcc, s[60:61]
    s_cbranch_scc1 CF0_FB
CF0_BF:
    ds_write_b64 v24, v[66:67] offset:8
    v_mov_b64 v[36:37], 0
    v_mov_b64 v[38:39], 0
    v_mov_b64 v[40:41], 0
    v_mov_b64 v[42:43], 0
    v_mov_b64 v[44:45], 0
    v_mov_b64 v[46:47], 0
    v_mov_b64 v[48:49], 0
    v_mov_b64 v[50:51], 0
    v_mov_b64 v[52:53], 0
    v_mov_b64 v[54:55], 0
    s_waitcnt lgkmcnt(0)
    s_barrier
    ds_read_b128 v[88:91], v25 offset:1024
    ds_read_b128 v[84:87], v25
    ds_read_b128 v[112:115], v19 offset:23552
    ds_read_b128 v[116:119], v19 offset:24576
    ds_read_b128 v[120:123], v19 offset:25600
    s_waitcnt lgkmcnt(4)
    v_smfmac_f32_16x16x64_bf16 v[36:39], v[88:91], v[216:223], v34
    ds_read_b128 v[124:127], v19 offset:26624
    s_add_u32 s17, s66, 8192
    s_waitcnt lgkmcnt(4)
    v_smfmac_f32_16x16x64_bf16 v[36:39], v[84:87], v[100:107], v34
    ds_read_b128 v[128:131], v19 offset:27648
    s_add_u32 s18, s66, 16384
    v_smfmac_f32_16x16x64_bf16 v[40:43], v[88:91], v[224:231], v34
    ds_read_b128 v[56:59], v19 offset:28672
    s_add_u32 s19, s66, 24576
    s_waitcnt lgkmcnt(5)
    v_smfmac_f32_16x16x64_bf16 v[40:43], v[84:87], v[108:115], v34
    ds_read_b128 v[60:63], v19 offset:29696
    s_add_u32 s65, s66, 32768
    v_smfmac_f32_16x16x64_bf16 v[44:47], v[88:91], v[232:239], v34
    v_add_f32 v36, v36, v38
    v_add_f32 v37, v37, v39
    s_waitcnt lgkmcnt(4)
    v_smfmac_f32_16x16x64_bf16 v[44:47], v[84:87], v[116:123], v34
    v_cvt_pk_bf16_f32 v64, v36, v37
    v_and_or_b32 v64, v64, -2, s41
    v_smfmac_f32_16x16x64_bf16 v[48:51], v[88:91], v[240:247], v34
    buffer_store_dword v64, v28, s[8:11], s66 offen
    v_add_f32 v40, v40, v42
    v_add_f32 v41, v41, v43
    s_waitcnt lgkmcnt(2)
    v_smfmac_f32_16x16x64_bf16 v[48:51], v[84:87], v[124:131], v34
    v_cvt_pk_bf16_f32 v65, v40, v41
    v_and_or_b32 v65, v65, -2, s41
    v_smfmac_f32_16x16x64_bf16 v[52:55], v[88:91], v[248:255], v34
    buffer_store_dword v65, v28, s[8:11], s17 offen
    v_add_f32 v44, v44, v46
    v_add_f32 v45, v45, v47
    s_waitcnt lgkmcnt(0)
    v_smfmac_f32_16x16x64_bf16 v[52:55], v[84:87], v[56:63], v34
    v_cvt_pk_bf16_f32 v66, v44, v45
    v_and_or_b32 v66, v66, -2, s41
    buffer_store_dword v66, v28, s[8:11], s18 offen
    v_add_f32 v48, v48, v50
    v_add_f32 v49, v49, v51
    v_cvt_pk_bf16_f32 v67, v48, v49
    v_and_or_b32 v67, v67, -2, s41
    buffer_store_dword v67, v28, s[8:11], s19 offen
    v_add_f32 v52, v52, v54
    v_add_f32 v53, v53, v55
    v_cvt_pk_bf16_f32 v68, v52, v53
    v_and_or_b32 v68, v68, -2, s41
    buffer_store_dword v68, v28, s[8:11], s65 offen
    s_waitcnt vmcnt(7)
    s_cmp_eq_u32 s33, 0
    s_cbranch_scc1 CF0_TOPN
    ds_read_b128 v[100:103], v19 offset:0
    v_mov_b32 v36, s35
    s_max_i32 s23, s20, 0
    ds_read_b128 v[104:107], v19 offset:1024
    v_mov_b32 v37, s35
    s_add_u32 s20, s20, 1
    ds_read_b128 v[108:111], v19 offset:2048
    v_mov_b32 v38, s35
    s_add_u32 s21, s20, 1
    ds_read_b128 v[112:115], v19 offset:3072
    v_mov_b32 v39, s35
    v_mov_b64 v[76:77], 0
    s_bfe_u32 s16, s21, 0x10001
    ds_read_b128 v[116:119], v19 offset:4096
    v_mov_b64 v[78:79], 0
    s_mov_b32 s37, s67
    ds_read_b128 v[120:123], v19 offset:5120
    v_mov_b64 v[80:81], 0
    s_xor_b32 s67, s67, s75
    ds_read_b128 v[124:127], v19 offset:6144
    v_mov_b64 v[82:83], 0
    s_xor_b32 s68, s68, s76
    ds_read_b128 v[128:131], v19 offset:7168
    v_mov_b64 v[84:85], 0
    v_mov_b64 v[86:87], 0
    s_xor_b32 s66, s66, s74
    buffer_load_dwordx4 v[56:59], v4, s[8:11], s64 offen offset:0 sc1
    buffer_load_dwordx4 v[148:151], v4, s[8:11], s64 offen offset:1024 sc1
    v_max_i32 v33, v1, v18
    v_max_i32 v33, v1, v18
    v_max_i32 v33, v1, v18
    v_max_i32 v33, v1, v18
    v_max_i32 v33, v1, v18
    v_max_i32 v33, v1, v18
    buffer_load_dwordx4 v[56:59], v4, s[8:11], s64 offen offset:0 sc1
    buffer_load_dwordx4 v[148:151], v4, s[8:11], s64 offen offset:1024 sc1
    v_max_i32 v33, v1, v18
    v_max_i32 v33, v1, v18
    v_max_i32 v33, v1, v18
    v_max_i32 v33, v1, v18
    v_max_i32 v33, v1, v18
    v_max_i32 v33, v1, v18
    v_max_i32 v33, v1, v18
    v_max_i32 v33, v1, v18
    v_max_i32 v33, v1, v18
    v_max_i32 v33, v1, v18
    v_max_i32 v33, v1, v18
    v_max_i32 v33, v1, v18
    v_max_i32 v33, v1, v18
    v_max_i32 v33, v1, v18
    v_max_i32 v33, v1, v18
    v_max_i32 v33, v1, v18
    v_max_i32 v33, v1, v18
    v_max_i32 v33, v1, v18
    v_max_i32 v33, v1, v18
    v_max_i32 v33, v1, v18
    v_max_i32 v33, v1, v18
    v_max_i32 v33, v1, v18
    v_max_i32 v33, v1, v18
    v_max_i32 v33, v1, v18
    v_max_i32 v33, v1, v18
    v_max_i32 v33, v1, v18
    v_max_i32 v33, v1, v18
    v_max_i32 v33, v1, v18
    v_max_i32 v33, v1, v18
    v_max_i32 v33, v1, v18
CF0_EC:
    s_waitcnt vmcnt(2)
    v_bitop3_b32 v14, v56, v57, s41 bitop3:0x7e
    v_bitop3_b32 v15, v58, v59, s41 bitop3:0x7e
    v_bitop3_b32 v16, v148, v149, s41 bitop3:0x7e
    v_bitop3_b32 v17, v150, v151, s41 bitop3:0x7e
    v_mfma_f32_16x16x32_bf16 v[52:55], v[56:59], v[6:9], 0
    v_mfma_f32_16x16x32_bf16 v[52:55], v[148:151], v[6:9], v[52:55]
    v_or3_b32 v14, v14, v16, v17
    v_bitop3_b32 v14, v14, v15, 1 bitop3:0xa8
    v_cmp_ne_u32 vcc, 0, v14
    s_nop 4
    v_add_f32 v52, v52, v54
    v_add_f32 v53, v53, v55
    s_cbranch_vccnz CF0_ES
    v_add_f32 v32, v52, v53
CF0_PUB:
    s_nop 1
    v_mov_b32_dpp v33, v32 quad_perm:[1,1,3,3] row_mask:0xf bank_mask:0xf
    v_cvt_pk_bf16_f32 v32, v32, v33
    v_and_or_b32 v32, v32, -2, s42
    buffer_store_dword v32, v29, s[8:11], s69 offen
    s_barrier
    buffer_store_dword v32, v29, s[8:11], s70 offen sc1
    s_branch CF0_TOP2
CF0_PUB0:
    ds_read_b128 v[100:103], v19 offset:0
    v_mov_b32 v36, s35
    s_max_i32 s23, s20, 0
    ds_read_b128 v[104:107], v19 offset:1024
    v_mov_b32 v37, s35
    s_add_u32 s20, s20, 1
    ds_read_b128 v[108:111], v19 offset:2048
    v_mov_b32 v38, s35
    s_add_u32 s21, s20, 1
    ds_read_b128 v[112:115], v19 offset:3072
    v_mov_b32 v39, s35
    v_mov_b64 v[76:77], 0
    s_bfe_u32 s16, s21, 0x10001
    ds_read_b128 v[116:119], v19 offset:4096
    v_mov_b64 v[78:79], 0
    s_mov_b32 s37, s67
    ds_read_b128 v[120:123], v19 offset:5120
    v_mov_b64 v[80:81], 0
    s_xor_b32 s67, s67, s75
    ds_read_b128 v[124:127], v19 offset:6144
    v_mov_b64 v[82:83], 0
    s_xor_b32 s68, s68, s76
    ds_read_b128 v[128:131], v19 offset:7168
    v_mov_b64 v[84:85], 0
    v_mov_b64 v[86:87], 0
    s_xor_b32 s66, s66, s74
    s_branch CF0_PUB
CF0_LS:
    s_mov_b64 exec, vcc
    buffer_load_dwordx4 v[36:39], v26, s[8:11], s36 offen offset:0 sc1
    buffer_load_dword v32, v27, s[8:11], s36 offen sc1
    s_mov_b64 exec, -1
    s_sub_u32 s24, s24, 1
    s_cbranch_scc0 CF0_LC
    s_branch C_FAIL
CF0_RS:
    s_mov_b64 exec, vcc
    buffer_load_dwordx4 v[56:59], v26, s[8:11], s71 offen offset:0 sc1
    buffer_load_dword v148, v27, s[8:11], s71 offen sc1
    s_add_u32 m0, s43, 24576
    s_nop 0
    buffer_load_dwordx4 v26, s[8:11], s71 offen sc1 lds
    s_add_u32 m0, s44, 24576
    s_nop 0
    buffer_load_dword v27, s[8:11], s71 offen sc1 lds
    s_mov_b64 exec, -1
    s_waitcnt vmcnt(0)
    v_bitop3_b32 v14, v56, v57, s41 bitop3:0x7e
    v_bitop3_b32 v15, v58, v59, s41 bitop3:0x7e
    v_bitop3_b32 v14, v14, v148, s41 bitop3:0xf6
    v_bitop3_b32 v14, v14, v15, 1 bitop3:0xa8
    v_cmp_ne_u32 vcc, 0, v14
    s_cbranch_vccz CF0_ROK
    s_sub_u32 s24, s24, 1
    s_cbranch_scc0 CF0_RS
    s_branch C_FAIL
CF0_ES:
    s_mov_b64 exec, vcc
    buffer_load_dwordx4 v[56:59], v4, s[8:11], s64 offen offset:0 sc1
    buffer_load_dwordx4 v[148:151], v4, s[8:11], s64 offen offset:1024 sc1
    s_mov_b64 exec, -1
    s_sub_u32 s24, s24, 1
    s_cbranch_scc0 CF0_EC
    s_branch C_FAIL
CF0_KVW:
CF0_KVL:
    v_and_b32 v33, 63, v35
    buffer_load_dword v33, v33, s[8:11], s57 offen sc1
    s_waitcnt vmcnt(0)
    v_cmp_eq_u32 vcc, 0, v33
    s_nop 0
    s_or_b32 s47, vcc_lo, 0x10000
    s_ff1_i32_b32 s47, s47
    s_mul_i32 s47, s47, 4
    s_cmp_ge_u32 s47, 64
    s_cselect_b32 s47, 255, s47
    s_cmp_lt_u32 s21, s47
    s_cbranch_scc1 CF0_KVD
    s_sleep 1
    s_sub_u32 s24, s24, 1
    s_cbranch_scc0 CF0_KVL
    s_branch C_FAIL
CF0_KVD:
    s_cmp_eq_u32 s20, 0
    s_cbranch_scc0 CF0_KVB
    s_sub_u32 s22, s38, 0x2000000
    s_xor_b32 s53, s53, 8192
    s_add_u32 m0, s53, 0
    s_nop 0
    buffer_load_dwordx4 v30, s[8:11], s22 offen offset:0 sc1 lds
    s_add_u32 m0, s53, 896
    s_nop 0
    buffer_load_dwordx4 v30, s[8:11], s22 offen offset:128 sc1 lds
    s_xor_b32 s53, s53, 8192
    s_add_u32 m0, s43, 24576
    s_waitcnt vmcnt(0)
    s_branch CF0_KVB
CF0_RV:
    s_mov_b64 exec, vcc
    buffer_load_dword v133, v35, s[8:11], s68 offen offset:0 sc1
    buffer_load_dword v135, v35, s[8:11], s68 offen offset:256 sc1
    s_mov_b64 exec, -1
    v_bitop3_b32 v14, v133, v135, s41 bitop3:0x7e
    v_and_b32 v14, 1, v14
    v_cmp_ne_u32 vcc, 0, v14
    v_max_i32 v33, v1, v18
    v_max_i32 v33, v1, v18
    s_cbranch_vccz CF0_BV
    v_bitop3_b32 v14, v133, v135, s41 bitop3:0x7e
    v_and_b32 v14, 1, v14
    v_cmp_ne_u32 vcc, 0, v14
    v_max_i32 v33, v1, v18
    v_max_i32 v33, v1, v18
    s_cbranch_vccz CF0_BV
    s_sub_u32 s24, s24, 1
    s_cbranch_scc0 CF0_RV
    s_branch C_FAIL
CF0_FB:
    v_max3_f32 v32, v84, v85, v86
    v_max3_f32 v32, v32, v87, v88
    v_max3_f32 v32, v32, v89, v90
    v_max3_f32 v32, v32, v91, v94
    v_max_f32 v32, v32, v95
    v_mov_b32 v33, v32
    s_nop 1
    v_permlane32_swap_b32 v32, v33
    v_max_f32 v32, v32, v33
    v_mov_b32 v33, v32
    s_nop 1
    v_permlane16_swap_b32 v32, v33
    v_max_f32 v32, v32, v33
    v_sub_f32 v84, v84, v32
    v_sub_f32 v85, v85, v32
    v_sub_f32 v86, v86, v32
    v_sub_f32 v87, v87, v32
    v_sub_f32 v88, v88, v32
    v_sub_f32 v89, v89, v32
    v_sub_f32 v90, v90, v32
    v_sub_f32 v91, v91, v32
    v_sub_f32 v94, v94, v32
    v_sub_f32 v95, v95, v32
    v_exp_f32 v84, v84
    v_exp_f32 v85, v85
    v_exp_f32 v86, v86
    v_exp_f32 v87, v87
    v_exp_f32 v88, v88
    v_exp_f32 v89, v89
    v_exp_f32 v90, v90
    v_exp_f32 v91, v91
    v_exp_f32 v94, v94
    v_exp_f32 v95, v95
    v_cvt_pk_bf16_f32 v52, v84, v85
    v_cvt_pk_bf16_f32 v53, v86, v87
    v_cvt_pk_bf16_f32 v54, v88, v89
    v_cvt_pk_bf16_f32 v55, v90, v91
    v_cvt_pk_bf16_f32 v136, v94, v95
    v_cvt_pk_bf16_f32 v137, v94, v95
    v_mfma_f32_16x16x32_bf16 v[96:99], v[10:13], v[52:55], 0
    v_mfma_f32_16x16x32_bf16 v[76:79], v[140:143], v[52:55], 0
    v_mfma_f32_16x16x32_bf16 v[80:83], v[144:147], v[52:55], 0
    s_nop 3
    v_mfma_f32_16x16x16_bf16 v[96:99], v[2:3], v[136:137], v[96:99]
    v_mfma_f32_16x16x16_bf16 v[76:79], v[132:133], v[136:137], v[76:79]
    v_mfma_f32_16x16x16_bf16 v[80:83], v[134:135], v[136:137], v[80:83]
    s_nop 5
    v_rcp_f32 v32, v96
    s_nop 0
    v_mul_f32 v148, v76, v32
    v_mul_f32 v149, v77, v32
    v_mul_f32 v150, v78, v32
    v_mul_f32 v151, v79, v32
    v_cvt_pk_bf16_f32 v64, v148, v149
    v_cvt_pk_bf16_f32 v65, v150, v151
    ds_write_b64 v24, v[64:65]
    v_mul_f32 v148, v80, v32
    v_mul_f32 v149, v81, v32
    v_mul_f32 v150, v82, v32
    v_mul_f32 v151, v83, v32
    v_cvt_pk_bf16_f32 v66, v148, v149
    v_cvt_pk_bf16_f32 v67, v150, v151
    s_branch CF0_BF
    s_branch CS0_ENTRY
    .p2align 6
CS0_ENTRY:
    s_cmp_eq_u32 s33, 0
    s_cbranch_scc0 CS0_PUB0
CS0_TOPN:
    ds_read_b128 v[100:103], v19 offset:0
    v_mov_b32 v36, s35
    s_max_i32 s23, s20, 0
    ds_read_b128 v[104:107], v19 offset:1024
    v_mov_b32 v37, s35
    s_add_u32 s20, s20, 1
    ds_read_b128 v[108:111], v19 offset:2048
    v_mov_b32 v38, s35
    s_add_u32 s21, s20, 1
    ds_read_b128 v[112:115], v19 offset:3072
    v_mov_b32 v39, s35
    v_mov_b64 v[76:77], 0
    s_bfe_u32 s16, s21, 0x10001
    ds_read_b128 v[116:119], v19 offset:4096
    v_mov_b64 v[78:79], 0
    s_mov_b32 s37, s67
    ds_read_b128 v[120:123], v19 offset:5120
    v_mov_b64 v[80:81], 0
    s_xor_b32 s67, s67, s75
    ds_read_b128 v[124:127], v19 offset:6144
    v_mov_b64 v[82:83], 0
    s_xor_b32 s68, s68, s76
    ds_read_b128 v[128:131], v19 offset:7168
    v_mov_b64 v[84:85], 0
    v_mov_b64 v[86:87], 0
    s_xor_b32 s66, s66, s74
    s_barrier
CS0_TOP2:
    s_mov_b32 s36, s69
    v_mov_b32 v32, s35
    s_mov_b32 s41, s42
    s_mov_b32 s42, s16
    s_xor_b32 s35, s16, 1
    s_lshl1_add_u32 s23, s23, s35
    v_max_i32 v33, v1, v18
    s_xor_b32 s69, s69, s77
    s_xor_b32 s70, s70, s48
    s_xor_b32 s64, s64, s72
    v_max_i32 v33, v1, v18
    ds_read_b128 v[132:135], v19 offset:8192
    v_mov_b64 v[88:89], 0
    s_xor_b32 s71, s71, s49
    ds_read_b128 v[136:139], v19 offset:9216
    v_mov_b64 v[90:91], 0
    s_add_u32 s38, s40, 0x2000000
    ds_read_b128 v[140:143], v19 offset:10240
    v_mov_b64 v[92:93], 0
    s_add_u32 s55, s59, 4096
    ds_read_b128 v[144:147], v19 offset:11264
    v_mov_b64 v[94:95], 0
    v_mov_b64 v[96:97], 0
    s_add_u32 s59, s40, s34
    ds_read_b128 v[60:63], v19 offset:12288
    v_mov_b64 v[98:99], 0
    s_add_u32 s40, s40, 524288
    ds_read_b128 v[64:67], v19 offset:13312
    v_xor_b32 v40, 1024, v26
    s_and_b32 s22, s21, 3
    s_cselect_b32 s22, 0, 8192
    ds_read_b128 v[68:71], v19 offset:14336
    v_xor_b32 v44, 2048, v26
    s_xor_b32 s40, s40, s22
    ds_read_b128 v[72:75], v19 offset:15360
    v_xor_b32 v48, 3072, v26
    v_xor_b32 v23, 8192, v23
    s_xor_b32 s53, s53, 8192
    s_add_u32 m0, s43, 24576
    buffer_load_dwordx4 v[36:39], v26, s[8:11], s36 offen offset:0 sc1
    buffer_load_dword v32, v27, s[8:11], s36 offen sc1
    v_max_i32 v33, v1, v18
    v_max_i32 v33, v1, v18
    v_max_i32 v33, v1, v18
    v_max_i32 v33, v1, v18
    v_max_i32 v33, v1, v18
    v_max_i32 v33, v1, v18
    v_max_i32 v33, v1, v18
    v_max_i32 v33, v1, v18
    v_max_i32 v33, v1, v18
    v_max_i32 v33, v1, v18
    v_max_i32 v33, v1, v18
    v_max_i32 v33, v1, v18
    v_max_i32 v33, v1, v18
    v_max_i32 v33, v1, v18
    v_max_i32 v33, v1, v18
    v_max_i32 v33, v1, v18
    v_max_i32 v33, v1, v18
    v_max_i32 v33, v1, v18
    v_max_i32 v33, v1, v18
    v_max_i32 v33, v1, v18
    v_max_i32 v33, v1, v18
    v_max_i32 v33, v1, v18
    v_max_i32 v33, v1, v18
    v_max_i32 v33, v1, v18
    v_max_i32 v33, v1, v18
    buffer_load_dwordx4 v[36:39], v26, s[8:11], s36 offen offset:0 sc1
    buffer_load_dword v32, v27, s[8:11], s36 offen sc1
    v_max_i32 v33, v1, v18
    v_max_i32 v33, v1, v18
    v_max_i32 v33, v1, v18
    v_max_i32 v33, v1, v18
    v_max_i32 v33, v1, v18
    v_max_i32 v33, v1, v18
    v_max_i32 v33, v1, v18
    v_max_i32 v33, v1, v18
    v_max_i32 v33, v1, v18
    v_max_i32 v33, v1, v18
    v_max_i32 v33, v1, v18
    v_max_i32 v33, v1, v18
    v_max_i32 v33, v1, v18
    v_max_i32 v33, v1, v18
    v_max_i32 v33, v1, v18
    v_max_i32 v33, v1, v18
    v_max_i32 v33, v1, v18
    v_max_i32 v33, v1, v18
    v_max_i32 v33, v1, v18
    v_max_i32 v33, v1, v18
    v_max_i32 v33, v1, v18
    v_max_i32 v33, v1, v18
    v_max_i32 v33, v1, v18
    v_max_i32 v33, v1, v18
    v_max_i32 v33, v1, v18
    s_cmp_ge_u32 s21, s47
    s_cbranch_scc1 CS0_KVW
CS0_KVB:
    s_waitcnt lgkmcnt(0)
CS0_LC:
    s_waitcnt vmcnt(2)
    v_bitop3_b32 v14, v36, v37, s41 bitop3:0x7e
    v_bitop3_b32 v15, v38, v39, s41 bitop3:0x7e
    v_bitop3_b32 v14, v14, v32, s41 bitop3:0xf6
    v_bitop3_b32 v14, v14, v15, 1 bitop3:0xa8
    v_cmp_ne_u32 vcc, 0, v14
    ds_write_b128 v26, v[36:39] offset:16384
    s_cbranch_vccnz CS0_LS
    s_barrier
    v_smfmac_f32_16x16x64_bf16 v[76:79], v[36:39], v[100:107], v34
    ds_write_b32 v27, v32 offset:16384
    buffer_load_dwordx4 v[56:59], v26, s[8:11], s71 offen offset:0 sc1
    v_smfmac_f32_16x16x64_bf16 v[80:83], v[36:39], v[108:115], v34
    buffer_load_dword v148, v27, s[8:11], s71 offen sc1
    v_smfmac_f32_16x16x64_bf16 v[84:87], v[36:39], a[0:7], v34
    s_waitcnt lgkmcnt(0)
    s_barrier
    ds_read_b128 v[40:43], v40 offset:16384
    v_smfmac_f32_16x16x64_bf16 v[88:91], v[36:39], a[16:23], v34
    ds_read_b128 v[44:47], v44 offset:16384
    buffer_load_dwordx4 v26, s[8:11], s71 offen sc1 lds
    v_smfmac_f32_16x16x64_bf16 v[92:95], v[36:39], a[8:15], v34
    ds_read_b128 v[48:51], v48 offset:16384
    s_add_u32 m0, s44, 24576
    v_smfmac_f32_16x16x64_bf16 v[96:99], v[36:39], a[24:31], v34
    ds_read_b128 v[52:55], v1 offset:20480
    s_waitcnt lgkmcnt(3)
    v_smfmac_f32_16x16x64_bf16 v[76:79], v[40:43], v[116:123], v34
    ds_read_b128 v[100:103], v19 offset:16384
    buffer_load_dword v27, s[8:11], s71 offen sc1 lds
    v_smfmac_f32_16x16x64_bf16 v[80:83], v[40:43], v[124:131], v34
    ds_read_b128 v[104:107], v19 offset:17408
    s_waitcnt lgkmcnt(4)
    v_smfmac_f32_16x16x64_bf16 v[76:79], v[44:47], v[132:139], v34
    ds_read_b128 v[108:111], v19 offset:18432
    v_mov_b32 v150, s23
    v_smfmac_f32_16x16x64_bf16 v[80:83], v[44:47], v[140:147], v34
    ds_read_b128 v[112:115], v19 offset:19456
    s_waitcnt lgkmcnt(5)
    v_smfmac_f32_16x16x64_bf16 v[76:79], v[48:51], v[60:67], v34
    v_smfmac_f32_16x16x64_bf16 v[80:83], v[48:51], v[68:75], v34
    buffer_store_dword v150, v5, s[8:11], s37 offen offset:0 sc1
    v_xor_b32 v138, 8, v18
    v_smfmac_f32_16x16x64_bf16 v[84:87], v[40:43], a[32:39], v34
    buffer_store_dword v21, v35, s[8:11], s55 offen offset:0 sc1
    v_smfmac_f32_16x16x64_bf16 v[88:91], v[40:43], a[48:55], v34
    s_waitcnt lgkmcnt(0)
    v_smfmac_f32_16x16x64_bf16 v[76:79], v[52:55], v[100:107], v34
    s_nop 1
    v_smfmac_f32_16x16x64_bf16 v[80:83], v[52:55], v[108:115], v34
    ds_read_b128 v[100:103], v23 offset:0
    s_nop 0
    v_smfmac_f32_16x16x64_bf16 v[84:87], v[44:47], a[64:71], v34
    ds_read_b128 v[108:111], v23 offset:2048
    s_nop 0
    v_smfmac_f32_16x16x64_bf16 v[88:91], v[44:47], a[80:87], v34
    v_add_f32 v76, v76, v78
    v_add_f32 v77, v77, v79
    v_cvt_pk_bf16_f32 v132, v76, v77
    v_and_or_b32 v132, v132, -2, s41
    v_smfmac_f32_16x16x64_bf16 v[84:87], v[48:51], a[96:103], v34
    buffer_store_dword v132, v35, s[8:11], s67 offen offset:0 sc1
    v_add_f32 v80, v80, v82
    v_add_f32 v81, v81, v83
    v_cvt_pk_bf16_f32 v134, v80, v81
    v_and_or_b32 v134, v134, -2, s41
    v_smfmac_f32_16x16x64_bf16 v[88:91], v[48:51], a[112:119], v34
    buffer_store_dword v134, v35, s[8:11], s67 offen offset:256 sc1
    v_smfmac_f32_16x16x64_bf16 v[84:87], v[52:55], a[128:135], v34
    ds_read_b128 v[116:119], v23 offset:4096
    buffer_load_dwordx4 v[140:143], v31, s[8:11], s38 offen offset:0 sc1
    v_smfmac_f32_16x16x64_bf16 v[88:91], v[52:55], a[144:151], v34
    ds_read_b128 v[124:127], v23 offset:6144
    buffer_load_dwordx4 v[144:147], v31, s[8:11], s38 offen offset:256 sc1
    v_smfmac_f32_16x16x64_bf16 v[92:95], v[40:43], a[40:47], v34
    buffer_store_dword v132, v35, s[8:11], s59 offen offset:0 sc1
    v_smfmac_f32_16x16x64_bf16 v[96:99], v[40:43], a[56:63], v34
    buffer_store_dword v134, v35, s[8:11], s59 offen offset:256 sc1
    v_smfmac_f32_16x16x64_bf16 v[92:95], v[44:47], a[72:79], v34
    s_waitcnt vmcnt(8)
    v_bitop3_b32 v14, v56, v57, s41 bitop3:0x7e
    v_bitop3_b32 v15, v58, v59, s41 bitop3:0x7e
    v_smfmac_f32_16x16x64_bf16 v[96:99], v[44:47], a[88:95], v34
    v_bitop3_b32 v14, v14, v148, s41 bitop3:0xf6
    v_bitop3_b32 v14, v14, v15, 1 bitop3:0xa8
    v_cmp_ne_u32 vcc, 0, v14
    v_smfmac_f32_16x16x64_bf16 v[92:95], v[48:51], a[104:111], v34
    v_smfmac_f32_16x16x64_bf16 v[96:99], v[48:51], a[120:127], v34
    s_cbranch_vccnz CS0_RS
CS0_ROK:
    s_barrier
    ds_read_b128 v[56:59], v1 offset:24576
    v_smfmac_f32_16x16x64_bf16 v[92:95], v[52:55], a[136:143], v34
    ds_read_b128 v[60:63], v1 offset:25600
    v_smfmac_f32_16x16x64_bf16 v[96:99], v[52:55], a[152:159], v34
    ds_read_b128 v[64:67], v1 offset:26624
    s_waitcnt lgkmcnt(2)
    v_smfmac_f32_16x16x64_bf16 v[84:87], v[56:59], a[160:167], v34
    ds_read_b128 v[68:71], v1 offset:27648
    v_smfmac_f32_16x16x64_bf16 v[88:91], v[56:59], a[176:183], v34
    ds_read_b128 v[72:75], v1 offset:28672
    s_waitcnt lgkmcnt(3)
    v_smfmac_f32_16x16x64_bf16 v[84:87], v[60:63], a[192:199], v34
    ds_read_b128 v[104:107], v23 offset:1024
    v_smfmac_f32_16x16x64_bf16 v[88:91], v[60:63], a[208:215], v34
    ds_read_b128 v[112:115], v23 offset:3072
    s_waitcnt lgkmcnt(4)
    v_smfmac_f32_16x16x64_bf16 v[84:87], v[64:67], a[224:231], v34
    ds_read_b128 v[120:123], v23 offset:5120
    v_smfmac_f32_16x16x64_bf16 v[88:91], v[64:67], a[240:247], v34
    ds_read_b128 v[128:131], v23 offset:7168
    s_waitcnt lgkmcnt(5)
    v_smfmac_f32_16x16x64_bf16 v[84:87], v[68:71], v[152:159], v34
    buffer_store_dword v150, v0, s[8:11], s37 offen offset:0 sc1
    v_smfmac_f32_16x16x64_bf16 v[88:91], v[68:71], v[168:175], v34
    s_waitcnt lgkmcnt(4)
    v_smfmac_f32_16x16x64_bf16 v[84:87], v[72:75], v[184:191], v34
    s_nop 1
    v_smfmac_f32_16x16x64_bf16 v[88:91], v[72:75], v[200:207], v34
    s_nop 1
    v_smfmac_f32_16x16x64_bf16 v[92:95], v[56:59], a[168:175], v34
    s_nop 1
    v_smfmac_f32_16x16x64_bf16 v[96:99], v[56:59], a[184:191], v34
    v_add_f32 v84, v84, v86
    v_add_f32 v85, v85, v87
    v_mul_f32 v84, s54, v84
    v_mul_f32 v85, s54, v85
    v_smfmac_f32_16x16x64_bf16 v[92:95], v[60:63], a[200:207], v34
    v_add_f32 v88, v88, v90
    v_add_f32 v89, v89, v91
    v_mul_f32 v88, s54, v88
    v_mul_f32 v89, s54, v89
    v_smfmac_f32_16x16x64_bf16 v[96:99], v[60:63], a[216:223], v34
    v_cvt_pk_bf16_f32 v21, v84, v85
    v_cvt_pk_bf16_f32 v22, v88, v89
    ds_write2_b32 v20, v21, v22 offset0:0 offset1:64
    v_smfmac_f32_16x16x64_bf16 v[92:95], v[64:67], a[232:239], v34
    buffer_load_dword v133, v35, s[8:11], s68 offen offset:0 sc1
    v_smfmac_f32_16x16x64_bf16 v[96:99], v[64:67], a[248:255], v34
    buffer_load_dword v135, v35, s[8:11], s68 offen offset:256 sc1
    v_smfmac_f32_16x16x64_bf16 v[92:95], v[68:71], v[160:167], v34
    s_waitcnt lgkmcnt(0)
    s_barrier
    ds_read_b64_tr_b16 v[36:37], v18 offset:30720
    v_smfmac_f32_16x16x64_bf16 v[96:99], v[68:71], v[176:183], v34
    ds_read_b64_tr_b16 v[38:39], v138 offset:31232
    ds_read_b64_tr_b16 v[40:41], v18 offset:31744
    v_smfmac_f32_16x16x64_bf16 v[92:95], v[72:75], v[192:199], v34
    ds_read_b64_tr_b16 v[42:43], v138 offset:32256
    ds_read_b64_tr_b16 v[44:45], v18 offset:32768
    v_smfmac_f32_16x16x64_bf16 v[96:99], v[72:75], v[208:215], v34
    ds_read_b64_tr_b16 v[46:47], v138 offset:33280
    ds_read_b64_tr_b16 v[48:49], v18 offset:33792
    ds_read_b64_tr_b16 v[50:51], v138 offset:34304
    s_nop 1
    v_add_f32 v92, v92, v94
    v_add_f32 v93, v93, v95
    s_nop 0
    v_add_f32 v96, v96, v98
    v_add_f32 v97, v97, v99
    v_cvt_pk_bf16_f32 v21, v92, v93
    v_cvt_pk_bf16_f32 v22, v96, v97
    ds_write2_b32 v20, v21, v22 offset0:1 offset1:65
    s_waitcnt lgkmcnt(7)
    v_mfma_f32_16x16x32_bf16 v[84:87], v[100:103], v[36:39], 0
    buffer_load_dword v133, v35, s[8:11], s68 offen offset:0 sc1
    s_waitcnt lgkmcnt(5)
    v_mfma_f32_16x16x32_bf16 v[84:87], v[108:111], v[40:43], v[84:87]
    buffer_load_dword v135, v35, s[8:11], s68 offen offset:256 sc1
    s_waitcnt lgkmcnt(3)
    v_mfma_f32_16x16x32_bf16 v[84:87], v[116:119], v[44:47], v[84:87]
    s_cmp_eq_u32 s20, 63
    s_waitcnt lgkmcnt(1)
    v_mfma_f32_16x16x32_bf16 v[84:87], v[124:127], v[48:51], v[84:87]
    s_waitcnt lgkmcnt(0)
    s_barrier
    ds_read_b64_tr_b16 v[56:57], v18 offset:30720
    ds_read_b64_tr_b16 v[58:59], v138 offset:31232
    s_cbranch_scc1 C_LAST0
    v_mfma_f32_16x16x32_bf16 v[88:91], v[104:107], v[36:39], 0
    ds_read_b64_tr_b16 v[60:61], v18 offset:31744
    ds_read_b64_tr_b16 v[62:63], v138 offset:32256
    v_mfma_f32_16x16x32_bf16 v[88:91], v[112:115], v[40:43], v[88:91]
    ds_read_b64_tr_b16 v[64:65], v18 offset:32768
    ds_read_b64_tr_b16 v[66:67], v138 offset:33280
    v_exp_f32 v148, v84
    v_mfma_f32_16x16x32_bf16 v[88:91], v[120:123], v[44:47], v[88:91]
    ds_read_b64_tr_b16 v[68:69], v18 offset:33792
    ds_read_b64_tr_b16 v[70:71], v138 offset:34304
    v_exp_f32 v149, v85
    v_mfma_f32_16x16x32_bf16 v[88:91], v[128:131], v[48:51], v[88:91]
    v_exp_f32 v150, v86
    v_exp_f32 v151, v87
    v_cvt_pk_bf16_f32 v52, v148, v149
    v_cvt_pk_bf16_f32 v53, v150, v151
    s_add_u32 m0, s53, 0
    s_waitcnt lgkmcnt(6)
    v_mfma_f32_16x16x32_bf16 v[92:95], v[56:59], v[36:39], 0
    buffer_load_dwordx4 v30, s[8:11], s40 offen offset:0 sc1 lds
    v_exp_f32 v148, v88
    s_waitcnt lgkmcnt(4)
    v_mfma_f32_16x16x32_bf16 v[92:95], v[60:63], v[40:43], v[92:95]
    s_add_u32 m0, s53, 896
    v_exp_f32 v149, v89
    s_waitcnt lgkmcnt(2)
    v_mfma_f32_16x16x32_bf16 v[92:95], v[64:67], v[44:47], v[92:95]
    buffer_load_dwordx4 v30, s[8:11], s40 offen offset:128 sc1 lds
    v_exp_f32 v150, v90
    s_waitcnt lgkmcnt(0)
    v_mfma_f32_16x16x32_bf16 v[92:95], v[68:71], v[48:51], v[92:95]
    v_exp_f32 v151, v91
    v_cvt_pk_bf16_f32 v54, v148, v149
    v_cvt_pk_bf16_f32 v55, v150, v151
    s_waitcnt vmcnt(4)
    v_bitop3_b32 v14, v133, v135, s41 bitop3:0x7e
    v_and_b32 v14, 1, v14
    v_mfma_f32_16x16x32_bf16 v[96:99], v[10:13], v[52:55], 0
    v_cmp_ne_u32 vcc, 0, v14
    v_exp_f32 v148, v94
    v_mfma_f32_16x16x32_bf16 v[76:79], v[140:143], v[52:55], 0
    v_exp_f32 v149, v95
    v_mfma_f32_16x16x32_bf16 v[80:83], v[144:147], v[52:55], 0
    v_cvt_pk_bf16_f32 v136, v148, v149
    v_cvt_pk_bf16_f32 v137, v148, v149
    s_nop 1
    v_mfma_f32_16x16x16_bf16 v[96:99], v[2:3], v[136:137], v[96:99]
    s_cbranch_vccnz CS0_RV
CS0_BV:
    v_mfma_f32_16x16x16_bf16 v[76:79], v[132:133], v[136:137], v[76:79]
    ds_read_b128 v[100:103], v19 offset:20480
    v_mfma_f32_16x16x16_bf16 v[80:83], v[134:135], v[136:137], v[80:83]
    ds_read_b128 v[104:107], v19 offset:21504
    ds_read_b128 v[108:111], v19 offset:22528
    s_nop 1
    v_rcp_f32 v32, v96
    v_subrev_u32 v33, s45, v96
    v_cmp_le_u32 vcc, s46, v33
    v_mul_f32 v148, v76, v32
    v_mul_f32 v149, v77, v32
    v_mul_f32 v150, v78, v32
    v_mul_f32 v151, v79, v32
    v_cvt_pk_bf16_f32 v64, v148, v149
    v_cvt_pk_bf16_f32 v65, v150, v151
    ds_write_b64 v24, v[64:65]
    v_mul_f32 v148, v80, v32
    v_mul_f32 v149, v81, v32
    v_mul_f32 v150, v82, v32
    v_mul_f32 v151, v83, v32
    v_cvt_pk_bf16_f32 v66, v148, v149
    v_cvt_pk_bf16_f32 v67, v150, v151
    s_and_b64 vcc, vcc, s[60:61]
    s_cbranch_scc1 CS0_FB
CS0_BF:
    ds_write_b64 v24, v[66:67] offset:8
    v_mov_b64 v[36:37], 0
    v_mov_b64 v[38:39], 0
    v_mov_b64 v[40:41], 0
    v_mov_b64 v[42:43], 0
    v_mov_b64 v[44:45], 0
    v_mov_b64 v[46:47], 0
    v_mov_b64 v[48:49], 0
    v_mov_b64 v[50:51], 0
    v_mov_b64 v[52:53], 0
    v_mov_b64 v[54:55], 0
    s_waitcnt lgkmcnt(0)
    s_barrier
    ds_read_b128 v[88:91], v25 offset:1024
    ds_read_b128 v[84:87], v25
    ds_read_b128 v[112:115], v19 offset:23552
    ds_read_b128 v[116:119], v19 offset:24576
    ds_read_b128 v[120:123], v19 offset:25600
    s_waitcnt lgkmcnt(4)
    v_smfmac_f32_16x16x64_bf16 v[36:39], v[88:91], v[216:223], v34
    ds_read_b128 v[124:127], v19 offset:26624
    s_add_u32 s17, s66, 8192
    s_waitcnt lgkmcnt(4)
    v_smfmac_f32_16x16x64_bf16 v[36:39], v[84:87], v[100:107], v34
    ds_read_b128 v[128:131], v19 offset:27648
    s_add_u32 s18, s66, 16384
    v_smfmac_f32_16x16x64_bf16 v[40:43], v[88:91], v[224:231], v34
    ds_read_b128 v[56:59], v19 offset:28672
    s_add_u32 s19, s66, 24576
    s_waitcnt lgkmcnt(5)
    v_smfmac_f32_16x16x64_bf16 v[40:43], v[84:87], v[108:115], v34
    ds_read_b128 v[60:63], v19 offset:29696
    s_add_u32 s65, s66, 32768
    v_smfmac_f32_16x16x64_bf16 v[44:47], v[88:91], v[232:239], v34
    v_add_f32 v36, v36, v38
    v_add_f32 v37, v37, v39
    s_waitcnt lgkmcnt(4)
    v_smfmac_f32_16x16x64_bf16 v[44:47], v[84:87], v[116:123], v34
    v_cvt_pk_bf16_f32 v64, v36, v37
    v_and_or_b32 v64, v64, -2, s41
    v_smfmac_f32_16x16x64_bf16 v[48:51], v[88:91], v[240:247], v34
    buffer_store_dword v64, v28, s[8:11], s66 offen sc1
    v_add_f32 v40, v40, v42
    v_add_f32 v41, v41, v43
    s_waitcnt lgkmcnt(2)
    v_smfmac_f32_16x16x64_bf16 v[48:51], v[84:87], v[124:131], v34
    v_cvt_pk_bf16_f32 v65, v40, v41
    v_and_or_b32 v65, v65, -2, s41
    v_smfmac_f32_16x16x64_bf16 v[52:55], v[88:91], v[248:255], v34
    buffer_store_dword v65, v28, s[8:11], s17 offen sc1
    v_add_f32 v44, v44, v46
    v_add_f32 v45, v45, v47
    s_waitcnt lgkmcnt(0)
    v_smfmac_f32_16x16x64_bf16 v[52:55], v[84:87], v[56:63], v34
    v_cvt_pk_bf16_f32 v66, v44, v45
    v_and_or_b32 v66, v66, -2, s41
    buffer_store_dword v66, v28, s[8:11], s18 offen sc1
    v_add_f32 v48, v48, v50
    v_add_f32 v49, v49, v51
    v_cvt_pk_bf16_f32 v67, v48, v49
    v_and_or_b32 v67, v67, -2, s41
    buffer_store_dword v67, v28, s[8:11], s19 offen sc1
    v_add_f32 v52, v52, v54
    v_add_f32 v53, v53, v55
    v_cvt_pk_bf16_f32 v68, v52, v53
    v_and_or_b32 v68, v68, -2, s41
    buffer_store_dword v68, v28, s[8:11], s65 offen sc1
    s_waitcnt vmcnt(7)
    s_cmp_eq_u32 s33, 0
    s_cbranch_scc1 CS0_TOPN
    ds_read_b128 v[100:103], v19 offset:0
    v_mov_b32 v36, s35
    s_max_i32 s23, s20, 0
    ds_read_b128 v[104:107], v19 offset:1024
    v_mov_b32 v37, s35
    s_add_u32 s20, s20, 1
    ds_read_b128 v[108:111], v19 offset:2048
    v_mov_b32 v38, s35
    s_add_u32 s21, s20, 1
    ds_read_b128 v[112:115], v19 offset:3072
    v_mov_b32 v39, s35
    v_mov_b64 v[76:77], 0
    s_bfe_u32 s16, s21, 0x10001
    ds_read_b128 v[116:119], v19 offset:4096
    v_mov_b64 v[78:79], 0
    s_mov_b32 s37, s67
    ds_read_b128 v[120:123], v19 offset:5120
    v_mov_b64 v[80:81], 0
    s_xor_b32 s67, s67, s75
    ds_read_b128 v[124:127], v19 offset:6144
    v_mov_b64 v[82:83], 0
    s_xor_b32 s68, s68, s76
    ds_read_b128 v[128:131], v19 offset:7168
    v_mov_b64 v[84:85], 0
    v_mov_b64 v[86:87], 0
    s_xor_b32 s66, s66, s74
    buffer_load_dwordx4 v[56:59], v4, s[8:11], s64 offen offset:0 sc1
    buffer_load_dwordx4 v[148:151], v4, s[8:11], s64 offen offset:1024 sc1
    v_max_i32 v33, v1, v18
    v_max_i32 v33, v1, v18
    v_max_i32 v33, v1, v18
    v_max_i32 v33, v1, v18
    v_max_i32 v33, v1, v18
    v_max_i32 v33, v1, v18
    buffer_load_dwordx4 v[56:59], v4, s[8:11], s64 offen offset:0 sc1
    buffer_load_dwordx4 v[148:151], v4, s[8:11], s64 offen offset:1024 sc1
    v_max_i32 v33, v1, v18
    v_max_i32 v33, v1, v18
    v_max_i32 v33, v1, v18
    v_max_i32 v33, v1, v18
    v_max_i32 v33, v1, v18
    v_max_i32 v33, v1, v18
    v_max_i32 v33, v1, v18
    v_max_i32 v33, v1, v18
    v_max_i32 v33, v1, v18
    v_max_i32 v33, v1, v18
    v_max_i32 v33, v1, v18
    v_max_i32 v33, v1, v18
    v_max_i32 v33, v1, v18
    v_max_i32 v33, v1, v18
    v_max_i32 v33, v1, v18
    v_max_i32 v33, v1, v18
    v_max_i32 v33, v1, v18
    v_max_i32 v33, v1, v18
    v_max_i32 v33, v1, v18
    v_max_i32 v33, v1, v18
    v_max_i32 v33, v1, v18
    v_max_i32 v33, v1, v18
    v_max_i32 v33, v1, v18
    v_max_i32 v33, v1, v18
    v_max_i32 v33, v1, v18
    v_max_i32 v33, v1, v18
    v_max_i32 v33, v1, v18
    v_max_i32 v33, v1, v18
    v_max_i32 v33, v1, v18
    v_max_i32 v33, v1, v18
CS0_EC:
    s_waitcnt vmcnt(2)
    v_bitop3_b32 v14, v56, v57, s41 bitop3:0x7e
    v_bitop3_b32 v15, v58, v59, s41 bitop3:0x7e
    v_bitop3_b32 v16, v148, v149, s41 bitop3:0x7e
    v_bitop3_b32 v17, v150, v151, s41 bitop3:0x7e
    v_mfma_f32_16x16x32_bf16 v[52:55], v[56:59], v[6:9], 0
    v_mfma_f32_16x16x32_bf16 v[52:55], v[148:151], v[6:9], v[52:55]
    v_or3_b32 v14, v14, v16, v17
    v_bitop3_b32 v14, v14, v15, 1 bitop3:0xa8
    v_cmp_ne_u32 vcc, 0, v14
    s_nop 4
    v_add_f32 v52, v52, v54
    v_add_f32 v53, v53, v55
    s_cbranch_vccnz CS0_ES
    v_add_f32 v32, v52, v53
CS0_PUB:
    s_nop 1
    v_mov_b32_dpp v33, v32 quad_perm:[1,1,3,3] row_mask:0xf bank_mask:0xf
    v_cvt_pk_bf16_f32 v32, v32, v33
    v_and_or_b32 v32, v32, -2, s42
    buffer_store_dword v32, v29, s[8:11], s69 offen sc1
    s_barrier
    buffer_store_dword v32, v29, s[8:11], s70 offen sc1
    s_branch CS0_TOP2
CS0_PUB0:
    ds_read_b128 v[100:103], v19 offset:0
    v_mov_b32 v36, s35
    s_max_i32 s23, s20, 0
    ds_read_b128 v[104:107], v19 offset:1024
    v_mov_b32 v37, s35
    s_add_u32 s20, s20, 1
    ds_read_b128 v[108:111], v19 offset:2048
    v_mov_b32 v38, s35
    s_add_u32 s21, s20, 1
    ds_read_b128 v[112:115], v19 offset:3072
    v_mov_b32 v39, s35
    v_mov_b64 v[76:77], 0
    s_bfe_u32 s16, s21, 0x10001
    ds_read_b128 v[116:119], v19 offset:4096
    v_mov_b64 v[78:79], 0
    s_mov_b32 s37, s67
    ds_read_b128 v[120:123], v19 offset:5120
    v_mov_b64 v[80:81], 0
    s_xor_b32 s67, s67, s75
    ds_read_b128 v[124:127], v19 offset:6144
    v_mov_b64 v[82:83], 0
    s_xor_b32 s68, s68, s76
    ds_read_b128 v[128:131], v19 offset:7168
    v_mov_b64 v[84:85], 0
    v_mov_b64 v[86:87], 0
    s_xor_b32 s66, s66, s74
    s_branch CS0_PUB
CS0_LS:
    s_mov_b64 exec, vcc
    buffer_load_dwordx4 v[36:39], v26, s[8:11], s36 offen offset:0 sc1
    buffer_load_dword v32, v27, s[8:11], s36 offen sc1
    s_mov_b64 exec, -1
    s_sub_u32 s24, s24, 1
    s_cbranch_scc0 CS0_LC
    s_branch C_FAIL
CS0_RS:
    s_mov_b64 exec, vcc
    buffer_load_dwordx4 v[56:59], v26, s[8:11], s71 offen offset:0 sc1
    buffer_load_dword v148, v27, s[8:11], s71 offen sc1
    s_add_u32 m0, s43, 24576
    s_nop 0
    buffer_load_dwordx4 v26, s[8:11], s71 offen sc1 lds
    s_add_u32 m0, s44, 24576
    s_nop 0
    buffer_load_dword v27, s[8:11], s71 offen sc1 lds
    s_mov_b64 exec, -1
    s_waitcnt vmcnt(0)
    v_bitop3_b32 v14, v56, v57, s41 bitop3:0x7e
    v_bitop3_b32 v15, v58, v59, s41 bitop3:0x7e
    v_bitop3_b32 v14, v14, v148, s41 bitop3:0xf6
    v_bitop3_b32 v14, v14, v15, 1 bitop3:0xa8
    v_cmp_ne_u32 vcc, 0, v14
    s_cbranch_vccz CS0_ROK
    s_sub_u32 s24, s24, 1
    s_cbranch_scc0 CS0_RS
    s_branch C_FAIL
CS0_ES:
    s_mov_b64 exec, vcc
    buffer_load_dwordx4 v[56:59], v4, s[8:11], s64 offen offset:0 sc1
    buffer_load_dwordx4 v[148:151], v4, s[8:11], s64 offen offset:1024 sc1
    s_mov_b64 exec, -1
    s_sub_u32 s24, s24, 1
    s_cbranch_scc0 CS0_EC
    s_branch C_FAIL
CS0_KVW:
CS0_KVL:
    v_and_b32 v33, 63, v35
    buffer_load_dword v33, v33, s[8:11], s57 offen sc1
    s_waitcnt vmcnt(0)
    v_cmp_eq_u32 vcc, 0, v33
    s_nop 0
    s_or_b32 s47, vcc_lo, 0x10000
    s_ff1_i32_b32 s47, s47
    s_mul_i32 s47, s47, 4
    s_cmp_ge_u32 s47, 64
    s_cselect_b32 s47, 255, s47
    s_cmp_lt_u32 s21, s47
    s_cbranch_scc1 CS0_KVD
    s_sleep 1
    s_sub_u32 s24, s24, 1
    s_cbranch_scc0 CS0_KVL
    s_branch C_FAIL
CS0_KVD:
    s_cmp_eq_u32 s20, 0
    s_cbranch_scc0 CS0_KVB
    s_sub_u32 s22, s38, 0x2000000
    s_xor_b32 s53, s53, 8192
    s_add_u32 m0, s53, 0
    s_nop 0
    buffer_load_dwordx4 v30, s[8:11], s22 offen offset:0 sc1 lds
    s_add_u32 m0, s53, 896
    s_nop 0
    buffer_load_dwordx4 v30, s[8:11], s22 offen offset:128 sc1 lds
    s_xor_b32 s53, s53, 8192
    s_add_u32 m0, s43, 24576
    s_waitcnt vmcnt(0)
    s_branch CS0_KVB
CS0_RV:
    s_mov_b64 exec, vcc
    buffer_load_dword v133, v35, s[8:11], s68 offen offset:0 sc1
    buffer_load_dword v135, v35, s[8:11], s68 offen offset:256 sc1
    s_mov_b64 exec, -1
    v_bitop3_b32 v14, v133, v135, s41 bitop3:0x7e
    v_and_b32 v14, 1, v14
    v_cmp_ne_u32 vcc, 0, v14
    v_max_i32 v33, v1, v18
    v_max_i32 v33, v1, v18
    s_cbranch_vccz CS0_BV
    v_bitop3_b32 v14, v133, v135, s41 bitop3:0x7e
    v_and_b32 v14, 1, v14
    v_cmp_ne_u32 vcc, 0, v14
    v_max_i32 v33, v1, v18
    v_max_i32 v33, v1, v18
    s_cbranch_vccz CS0_BV
    s_sub_u32 s24, s24, 1
    s_cbranch_scc0 CS0_RV
    s_branch C_FAIL
CS0_FB:
    v_max3_f32 v32, v84, v85, v86
    v_max3_f32 v32, v32, v87, v88
    v_max3_f32 v32, v32, v89, v90
    v_max3_f32 v32, v32, v91, v94
    v_max_f32 v32, v32, v95
    v_mov_b32 v33, v32
    s_nop 1
    v_permlane32_swap_b32 v32, v33
    v_max_f32 v32, v32, v33
    v_mov_b32 v33, v32
    s_nop 1
    v_permlane16_swap_b32 v32, v33
    v_max_f32 v32, v32, v33
    v_sub_f32 v84, v84, v32
    v_sub_f32 v85, v85, v32
    v_sub_f32 v86, v86, v32
    v_sub_f32 v87, v87, v32
    v_sub_f32 v88, v88, v32
    v_sub_f32 v89, v89, v32
    v_sub_f32 v90, v90, v32
    v_sub_f32 v91, v91, v32
    v_sub_f32 v94, v94, v32
    v_sub_f32 v95, v95, v32
    v_exp_f32 v84, v84
    v_exp_f32 v85, v85
    v_exp_f32 v86, v86
    v_exp_f32 v87, v87
    v_exp_f32 v88, v88
    v_exp_f32 v89, v89
    v_exp_f32 v90, v90
    v_exp_f32 v91, v91
    v_exp_f32 v94, v94
    v_exp_f32 v95, v95
    v_cvt_pk_bf16_f32 v52, v84, v85
    v_cvt_pk_bf16_f32 v53, v86, v87
    v_cvt_pk_bf16_f32 v54, v88, v89
    v_cvt_pk_bf16_f32 v55, v90, v91
    v_cvt_pk_bf16_f32 v136, v94, v95
    v_cvt_pk_bf16_f32 v137, v94, v95
    v_mfma_f32_16x16x32_bf16 v[96:99], v[10:13], v[52:55], 0
    v_mfma_f32_16x16x32_bf16 v[76:79], v[140:143], v[52:55], 0
    v_mfma_f32_16x16x32_bf16 v[80:83], v[144:147], v[52:55], 0
    s_nop 3
    v_mfma_f32_16x16x16_bf16 v[96:99], v[2:3], v[136:137], v[96:99]
    v_mfma_f32_16x16x16_bf16 v[76:79], v[132:133], v[136:137], v[76:79]
    v_mfma_f32_16x16x16_bf16 v[80:83], v[134:135], v[136:137], v[80:83]
    s_nop 5
    v_rcp_f32 v32, v96
    s_nop 0
    v_mul_f32 v148, v76, v32
    v_mul_f32 v149, v77, v32
    v_mul_f32 v150, v78, v32
    v_mul_f32 v151, v79, v32
    v_cvt_pk_bf16_f32 v64, v148, v149
    v_cvt_pk_bf16_f32 v65, v150, v151
    ds_write_b64 v24, v[64:65]
    v_mul_f32 v148, v80, v32
    v_mul_f32 v149, v81, v32
    v_mul_f32 v150, v82, v32
    v_mul_f32 v151, v83, v32
    v_cvt_pk_bf16_f32 v66, v148, v149
    v_cvt_pk_bf16_f32 v67, v150, v151
    s_branch CS0_BF
    s_branch CF1_ENTRY
    .p2align 6
CF1_ENTRY:
    s_cmp_eq_u32 s33, 0
    s_cbranch_scc0 CF1_PUB0
CF1_TOPN:
    ds_read_b128 v[100:103], v19 offset:0
    v_mov_b32 v36, s35
    s_max_i32 s23, s20, 0
    ds_read_b128 v[104:107], v19 offset:1024
    v_mov_b32 v37, s35
    s_add_u32 s20, s20, 1
    ds_read_b128 v[108:111], v19 offset:2048
    v_mov_b32 v38, s35
    s_add_u32 s21, s20, 1
    ds_read_b128 v[112:115], v19 offset:3072
    v_mov_b32 v39, s35
    v_mov_b64 v[76:77], 0
    s_bfe_u32 s16, s21, 0x10001
    ds_read_b128 v[116:119], v19 offset:4096
    v_mov_b64 v[78:79], 0
    s_mov_b32 s37, s67
    ds_read_b128 v[120:123], v19 offset:5120
    v_mov_b64 v[80:81], 0
    s_xor_b32 s67, s67, s75
    ds_read_b128 v[124:127], v19 offset:6144
    v_mov_b64 v[82:83], 0
    s_xor_b32 s68, s68, s76
    ds_read_b128 v[128:131], v19 offset:7168
    v_mov_b64 v[84:85], 0
    v_mov_b64 v[86:87], 0
    s_xor_b32 s66, s66, s74
    s_barrier
CF1_TOP2:
    s_mov_b32 s36, s69
    v_mov_b32 v32, s35
    s_mov_b32 s41, s42
    s_mov_b32 s42, s16
    s_xor_b32 s35, s16, 1
    s_lshl1_add_u32 s23, s23, s35
    v_max_i32 v33, v1, v18
    s_xor_b32 s69, s69, s77
    s_xor_b32 s70, s70, s48
    s_xor_b32 s64, s64, s72
    v_max_i32 v33, v1, v18
    ds_read_b128 v[132:135], v19 offset:8192
    v_mov_b64 v[88:89], 0
    s_xor_b32 s71, s71, s49
    ds_read_b128 v[136:139], v19 offset:9216
    v_mov_b64 v[90:91], 0
    s_add_u32 s38, s40, 0x2000000
    ds_read_b128 v[140:143], v19 offset:10240
    v_mov_b64 v[92:93], 0
    s_add_u32 s55, s59, 2048
    ds_read_b128 v[144:147], v19 offset:11264
    v_mov_b64 v[94:95], 0
    v_mov_b64 v[96:97], 0
    s_add_u32 s59, s40, s34
    ds_read_b128 v[60:63], v19 offset:12288
    v_mov_b64 v[98:99], 0
    s_add_u32 s40, s40, 524288
    ds_read_b128 v[64:67], v19 offset:13312
    v_xor_b32 v40, 1024, v26
    s_and_b32 s22, s21, 3
    s_cselect_b32 s22, 0, 8192
    ds_read_b128 v[68:71], v19 offset:14336
    v_xor_b32 v44, 2048, v26
    s_xor_b32 s40, s40, s22
    ds_read_b128 v[72:75], v19 offset:15360
    v_xor_b32 v48, 3072, v26
    v_xor_b32 v23, 8192, v23
    s_xor_b32 s53, s53, 8192
    s_add_u32 m0, s43, 24576
    buffer_load_dwordx4 v[36:39], v26, s[8:11], s36 offen offset:0 sc1
    buffer_load_dword v32, v27, s[8:11], s36 offen sc1
    v_max_i32 v33, v1, v18
    v_max_i32 v33, v1, v18
    v_max_i32 v33, v1, v18
    v_max_i32 v33, v1, v18
    v_max_i32 v33, v1, v18
    v_max_i32 v33, v1, v18
    v_max_i32 v33, v1, v18
    v_max_i32 v33, v1, v18
    v_max_i32 v33, v1, v18
    v_max_i32 v33, v1, v18
    v_max_i32 v33, v1, v18
    v_max_i32 v33, v1, v18
    v_max_i32 v33, v1, v18
    v_max_i32 v33, v1, v18
    v_max_i32 v33, v1, v18
    v_max_i32 v33, v1, v18
    v_max_i32 v33, v1, v18
    v_max_i32 v33, v1, v18
    v_max_i32 v33, v1, v18
    v_max_i32 v33, v1, v18
    v_max_i32 v33, v1, v18
    v_max_i32 v33, v1, v18
    v_max_i32 v33, v1, v18
    v_max_i32 v33, v1, v18
    v_max_i32 v33, v1, v18
    buffer_load_dwordx4 v[36:39], v26, s[8:11], s36 offen offset:0 sc1
    buffer_load_dword v32, v27, s[8:11], s36 offen sc1
    v_max_i32 v33, v1, v18
    v_max_i32 v33, v1, v18
    v_max_i32 v33, v1, v18
    v_max_i32 v33, v1, v18
    v_max_i32 v33, v1, v18
    v_max_i32 v33, v1, v18
    v_max_i32 v33, v1, v18
    v_max_i32 v33, v1, v18
    v_max_i32 v33, v1, v18
    v_max_i32 v33, v1, v18
    v_max_i32 v33, v1, v18
    v_max_i32 v33, v1, v18
    v_max_i32 v33, v1, v18
    v_max_i32 v33, v1, v18
    v_max_i32 v33, v1, v18
    v_max_i32 v33, v1, v18
    v_max_i32 v33, v1, v18
    v_max_i32 v33, v1, v18
    v_max_i32 v33, v1, v18
    v_max_i32 v33, v1, v18
    v_max_i32 v33, v1, v18
    v_max_i32 v33, v1, v18
    v_max_i32 v33, v1, v18
    v_max_i32 v33, v1, v18
    v_max_i32 v33, v1, v18
    s_cmp_ge_u32 s21, s47
    s_cbranch_scc1 CF1_KVW
CF1_KVB:
    s_waitcnt lgkmcnt(0)
CF1_LC:
    s_waitcnt vmcnt(2)
    v_bitop3_b32 v14, v36, v37, s41 bitop3:0x7e
    v_bitop3_b32 v15, v38, v39, s41 bitop3:0x7e
    v_bitop3_b32 v14, v14, v32, s41 bitop3:0xf6
    v_bitop3_b32 v14, v14, v15, 1 bitop3:0xa8
    v_cmp_ne_u32 vcc, 0, v14
    ds_write_b128 v26, v[36:39] offset:16384
    s_cbranch_vccnz CF1_LS
    s_barrier
    v_smfmac_f32_16x16x64_bf16 v[76:79], v[36:39], v[100:107], v34
    ds_write_b32 v27, v32 offset:16384
    buffer_load_dwordx4 v[56:59], v26, s[8:11], s71 offen offset:0 sc1
    v_smfmac_f32_16x16x64_bf16 v[80:83], v[36:39], v[108:115], v34
    buffer_load_dword v148, v27, s[8:11], s71 offen sc1
    v_smfmac_f32_16x16x64_bf16 v[84:87], v[36:39], a[0:7], v34
    s_waitcnt lgkmcnt(0)
    s_barrier
    ds_read_b128 v[40:43], v40 offset:16384
    v_smfmac_f32_16x16x64_bf16 v[88:91], v[36:39], a[16:23], v34
    ds_read_b128 v[44:47], v44 offset:16384
    buffer_load_dwordx4 v26, s[8:11], s71 offen sc1 lds
    v_smfmac_f32_16x16x64_bf16 v[92:95], v[36:39], a[8:15], v34
    ds_read_b128 v[48:51], v48 offset:16384
    s_add_u32 m0, s44, 24576
    v_smfmac_f32_16x16x64_bf16 v[96:99], v[36:39], a[24:31], v34
    ds_read_b128 v[52:55], v1 offset:20480
    s_waitcnt lgkmcnt(3)
    v_smfmac_f32_16x16x64_bf16 v[76:79], v[40:43], v[116:123], v34
    ds_read_b128 v[100:103], v19 offset:16384
    buffer_load_dword v27, s[8:11], s71 offen sc1 lds
    v_smfmac_f32_16x16x64_bf16 v[80:83], v[40:43], v[124:131], v34
    ds_read_b128 v[104:107], v19 offset:17408
    s_waitcnt lgkmcnt(4)
    v_smfmac_f32_16x16x64_bf16 v[76:79], v[44:47], v[132:139], v34
    ds_read_b128 v[108:111], v19 offset:18432
    v_mov_b32 v150, s23
    v_smfmac_f32_16x16x64_bf16 v[80:83], v[44:47], v[140:147], v34
    ds_read_b128 v[112:115], v19 offset:19456
    s_waitcnt lgkmcnt(5)
    v_smfmac_f32_16x16x64_bf16 v[76:79], v[48:51], v[60:67], v34
    v_smfmac_f32_16x16x64_bf16 v[80:83], v[48:51], v[68:75], v34
    buffer_store_dword v150, v5, s[8:11], s37 offen offset:0 sc1
    v_xor_b32 v138, 8, v18
    v_smfmac_f32_16x16x64_bf16 v[84:87], v[40:43], a[32:39], v34
    buffer_store_dword v22, v35, s[8:11], s55 offen offset:256 sc1
    v_smfmac_f32_16x16x64_bf16 v[88:91], v[40:43], a[48:55], v34
    s_waitcnt lgkmcnt(0)
    v_smfmac_f32_16x16x64_bf16 v[76:79], v[52:55], v[100:107], v34
    s_nop 1
    v_smfmac_f32_16x16x64_bf16 v[80:83], v[52:55], v[108:115], v34
    ds_read_b128 v[100:103], v23 offset:0
    s_nop 0
    v_smfmac_f32_16x16x64_bf16 v[84:87], v[44:47], a[64:71], v34
    ds_read_b128 v[108:111], v23 offset:2048
    s_nop 0
    v_smfmac_f32_16x16x64_bf16 v[88:91], v[44:47], a[80:87], v34
    v_add_f32 v76, v76, v78
    v_add_f32 v77, v77, v79
    v_cvt_pk_bf16_f32 v132, v76, v77
    v_and_or_b32 v132, v132, -2, s41
    v_smfmac_f32_16x16x64_bf16 v[84:87], v[48:51], a[96:103], v34
    buffer_store_dword v132, v35, s[8:11], s67 offen offset:0 sc1
    v_add_f32 v80, v80, v82
    v_add_f32 v81, v81, v83
    v_cvt_pk_bf16_f32 v134, v80, v81
    v_and_or_b32 v134, v134, -2, s41
    v_smfmac_f32_16x16x64_bf16 v[88:91], v[48:51], a[112:119], v34
    buffer_store_dword v134, v35, s[8:11], s67 offen offset:256 sc1
    v_smfmac_f32_16x16x64_bf16 v[84:87], v[52:55], a[128:135], v34
    ds_read_b128 v[116:119], v23 offset:4096
    buffer_load_dwordx4 v[140:143], v31, s[8:11], s38 offen offset:0 sc1
    v_smfmac_f32_16x16x64_bf16 v[88:91], v[52:55], a[144:151], v34
    ds_read_b128 v[124:127], v23 offset:6144
    buffer_load_dwordx4 v[144:147], v31, s[8:11], s38 offen offset:256 sc1
    v_smfmac_f32_16x16x64_bf16 v[92:95], v[40:43], a[40:47], v34
    buffer_store_dword v132, v35, s[8:11], s59 offen offset:0 sc1
    v_smfmac_f32_16x16x64_bf16 v[96:99], v[40:43], a[56:63], v34
    buffer_store_dword v134, v35, s[8:11], s59 offen offset:256 sc1
    v_smfmac_f32_16x16x64_bf16 v[92:95], v[44:47], a[72:79], v34
    s_waitcnt vmcnt(8)
    v_bitop3_b32 v14, v56, v57, s41 bitop3:0x7e
    v_bitop3_b32 v15, v58, v59, s41 bitop3:0x7e
    v_smfmac_f32_16x16x64_bf16 v[96:99], v[44:47], a[88:95], v34
    v_bitop3_b32 v14, v14, v148, s41 bitop3:0xf6
    v_bitop3_b32 v14, v14, v15, 1 bitop3:0xa8
    v_cmp_ne_u32 vcc, 0, v14
    v_smfmac_f32_16x16x64_bf16 v[92:95], v[48:51], a[104:111], v34
    v_smfmac_f32_16x16x64_bf16 v[96:99], v[48:51], a[120:127], v34
    s_cbranch_vccnz CF1_RS
CF1_ROK:
    s_barrier
    ds_read_b128 v[56:59], v1 offset:24576
    v_smfmac_f32_16x16x64_bf16 v[92:95], v[52:55], a[136:143], v34
    ds_read_b128 v[60:63], v1 offset:25600
    v_smfmac_f32_16x16x64_bf16 v[96:99], v[52:55], a[152:159], v34
    ds_read_b128 v[64:67], v1 offset:26624
    s_waitcnt lgkmcnt(2)
    v_smfmac_f32_16x16x64_bf16 v[84:87], v[56:59], a[160:167], v34
    ds_read_b128 v[68:71], v1 offset:27648
    v_smfmac_f32_16x16x64_bf16 v[88:91], v[56:59], a[176:183], v34
    ds_read_b128 v[72:75], v1 offset:28672
    s_waitcnt lgkmcnt(3)
    v_smfmac_f32_16x16x64_bf16 v[84:87], v[60:63], a[192:199], v34
    ds_read_b128 v[104:107], v23 offset:1024
    v_smfmac_f32_16x16x64_bf16 v[88:91], v[60:63], a[208:215], v34
    ds_read_b128 v[112:115], v23 offset:3072
    s_waitcnt lgkmcnt(4)
    v_smfmac_f32_16x16x64_bf16 v[84:87], v[64:67], a[224:231], v34
    ds_read_b128 v[120:123], v23 offset:5120
    v_smfmac_f32_16x16x64_bf16 v[88:91], v[64:67], a[240:247], v34
    ds_read_b128 v[128:131], v23 offset:7168
    s_waitcnt lgkmcnt(5)
    v_smfmac_f32_16x16x64_bf16 v[84:87], v[68:71], v[152:159], v34
    buffer_store_dword v150, v0, s[8:11], s37 offen offset:0 sc1
    v_smfmac_f32_16x16x64_bf16 v[88:91], v[68:71], v[168:175], v34
    s_waitcnt lgkmcnt(4)
    v_smfmac_f32_16x16x64_bf16 v[84:87], v[72:75], v[184:191], v34
    s_nop 1
    v_smfmac_f32_16x16x64_bf16 v[88:91], v[72:75], v[200:207], v34
    s_nop 1
    v_smfmac_f32_16x16x64_bf16 v[92:95], v[56:59], a[168:175], v34
    s_nop 1
    v_smfmac_f32_16x16x64_bf16 v[96:99], v[56:59], a[184:191], v34
    v_add_f32 v84, v84, v86
    v_add_f32 v85, v85, v87
    v_mul_f32 v84, s54, v84
    v_mul_f32 v85, s54, v85
    v_smfmac_f32_16x16x64_bf16 v[92:95], v[60:63], a[200:207], v34
    v_add_f32 v88, v88, v90
    v_add_f32 v89, v89, v91
    v_mul_f32 v88, s54, v88
    v_mul_f32 v89, s54, v89
    v_smfmac_f32_16x16x64_bf16 v[96:99], v[60:63], a[216:223], v34
    v_cvt_pk_bf16_f32 v21, v84, v85
    v_cvt_pk_bf16_f32 v22, v88, v89
    ds_write2_b32 v20, v21, v22 offset0:0 offset1:64
    v_smfmac_f32_16x16x64_bf16 v[92:95], v[64:67], a[232:239], v34
    buffer_load_dword v133, v35, s[8:11], s68 offen offset:0 sc1
    v_smfmac_f32_16x16x64_bf16 v[96:99], v[64:67], a[248:255], v34
    buffer_load_dword v135, v35, s[8:11], s68 offen offset:256 sc1
    v_smfmac_f32_16x16x64_bf16 v[92:95], v[68:71], v[160:167], v34
    s_waitcnt lgkmcnt(0)
    s_barrier
    ds_read_b64_tr_b16 v[36:37], v18 offset:30720
    v_smfmac_f32_16x16x64_bf16 v[96:99], v[68:71], v[176:183], v34
    ds_read_b64_tr_b16 v[38:39], v138 offset:31232
    ds_read_b64_tr_b16 v[40:41], v18 offset:31744
    v_smfmac_f32_16x16x64_bf16 v[92:95], v[72:75], v[192:199], v34
    ds_read_b64_tr_b16 v[42:43], v138 offset:32256
    ds_read_b64_tr_b16 v[44:45], v18 offset:32768
    v_smfmac_f32_16x16x64_bf16 v[96:99], v[72:75], v[208:215], v34
    ds_read_b64_tr_b16 v[46:47], v138 offset:33280
    ds_read_b64_tr_b16 v[48:49], v18 offset:33792
    ds_read_b64_tr_b16 v[50:51], v138 offset:34304
    s_nop 1
    v_add_f32 v92, v92, v94
    v_add_f32 v93, v93, v95
    s_nop 0
    v_add_f32 v96, v96, v98
    v_add_f32 v97, v97, v99
    v_cvt_pk_bf16_f32 v21, v92, v93
    v_cvt_pk_bf16_f32 v22, v96, v97
    ds_write2_b32 v20, v21, v22 offset0:1 offset1:65
    s_waitcnt lgkmcnt(7)
    v_mfma_f32_16x16x32_bf16 v[84:87], v[100:103], v[36:39], 0
    buffer_load_dword v133, v35, s[8:11], s68 offen offset:0 sc1
    s_waitcnt lgkmcnt(5)
    v_mfma_f32_16x16x32_bf16 v[84:87], v[108:111], v[40:43], v[84:87]
    buffer_load_dword v135, v35, s[8:11], s68 offen offset:256 sc1
    s_waitcnt lgkmcnt(3)
    v_mfma_f32_16x16x32_bf16 v[84:87], v[116:119], v[44:47], v[84:87]
    s_cmp_eq_u32 s20, 63
    s_waitcnt lgkmcnt(1)
    v_mfma_f32_16x16x32_bf16 v[84:87], v[124:127], v[48:51], v[84:87]
    s_waitcnt lgkmcnt(0)
    s_barrier
    ds_read_b64_tr_b16 v[56:57], v18 offset:30720
    ds_read_b64_tr_b16 v[58:59], v138 offset:31232
    s_cbranch_scc1 C_LAST1
    v_mfma_f32_16x16x32_bf16 v[88:91], v[104:107], v[36:39], 0
    ds_read_b64_tr_b16 v[60:61], v18 offset:31744
    ds_read_b64_tr_b16 v[62:63], v138 offset:32256
    v_mfma_f32_16x16x32_bf16 v[88:91], v[112:115], v[40:43], v[88:91]
    ds_read_b64_tr_b16 v[64:65], v18 offset:32768
    ds_read_b64_tr_b16 v[66:67], v138 offset:33280
    v_exp_f32 v148, v84
    v_mfma_f32_16x16x32_bf16 v[88:91], v[120:123], v[44:47], v[88:91]
    ds_read_b64_tr_b16 v[68:69], v18 offset:33792
    ds_read_b64_tr_b16 v[70:71], v138 offset:34304
    v_exp_f32 v149, v85
    v_mfma_f32_16x16x32_bf16 v[88:91], v[128:131], v[48:51], v[88:91]
    v_exp_f32 v150, v86
    v_exp_f32 v151, v87
    v_cvt_pk_bf16_f32 v52, v148, v149
    v_cvt_pk_bf16_f32 v53, v150, v151
    s_add_u32 m0, s53, 0
    s_waitcnt lgkmcnt(6)
    v_mfma_f32_16x16x32_bf16 v[92:95], v[56:59], v[36:39], 0
    buffer_load_dwordx4 v30, s[8:11], s40 offen offset:0 sc1 lds
    v_exp_f32 v148, v88
    s_waitcnt lgkmcnt(4)
    v_mfma_f32_16x16x32_bf16 v[92:95], v[60:63], v[40:43], v[92:95]
    s_add_u32 m0, s53, 896
    v_exp_f32 v149, v89
    s_waitcnt lgkmcnt(2)
    v_mfma_f32_16x16x32_bf16 v[92:95], v[64:67], v[44:47], v[92:95]
    buffer_load_dwordx4 v30, s[8:11], s40 offen offset:128 sc1 lds
    v_exp_f32 v150, v90
    s_waitcnt lgkmcnt(0)
    v_mfma_f32_16x16x32_bf16 v[92:95], v[68:71], v[48:51], v[92:95]
    v_exp_f32 v151, v91
    v_cvt_pk_bf16_f32 v54, v148, v149
    v_cvt_pk_bf16_f32 v55, v150, v151
    s_waitcnt vmcnt(4)
    v_bitop3_b32 v14, v133, v135, s41 bitop3:0x7e
    v_and_b32 v14, 1, v14
    v_mfma_f32_16x16x32_bf16 v[96:99], v[10:13], v[52:55], 0
    v_cmp_ne_u32 vcc, 0, v14
    v_exp_f32 v148, v94
    v_mfma_f32_16x16x32_bf16 v[76:79], v[140:143], v[52:55], 0
    v_exp_f32 v149, v95
    v_mfma_f32_16x16x32_bf16 v[80:83], v[144:147], v[52:55], 0
    v_cvt_pk_bf16_f32 v136, v148, v149
    v_cvt_pk_bf16_f32 v137, v148, v149
    s_nop 1
    v_mfma_f32_16x16x16_bf16 v[96:99], v[2:3], v[136:137], v[96:99]
    s_cbranch_vccnz CF1_RV
CF1_BV:
    v_mfma_f32_16x16x16_bf16 v[76:79], v[132:133], v[136:137], v[76:79]
    ds_read_b128 v[100:103], v19 offset:20480
    v_mfma_f32_16x16x16_bf16 v[80:83], v[134:135], v[136:137], v[80:83]
    ds_read_b128 v[104:107], v19 offset:21504
    ds_read_b128 v[108:111], v19 offset:22528
    s_nop 1
    v_rcp_f32 v32, v96
    v_subrev_u32 v33, s45, v96
    v_cmp_le_u32 vcc, s46, v33
    v_mul_f32 v148, v76, v32
    v_mul_f32 v149, v77, v32
    v_mul_f32 v150, v78, v32
    v_mul_f32 v151, v79, v32
    v_cvt_pk_bf16_f32 v64, v148, v149
    v_cvt_pk_bf16_f32 v65, v150, v151
    ds_write_b64 v24, v[64:65]
    v_mul_f32 v148, v80, v32
    v_mul_f32 v149, v81, v32
    v_mul_f32 v150, v82, v32
    v_mul_f32 v151, v83, v32
    v_cvt_pk_bf16_f32 v66, v148, v149
    v_cvt_pk_bf16_f32 v67, v150, v151
    s_and_b64 vcc, vcc, s[60:61]
    s_cbranch_scc1 CF1_FB
CF1_BF:
    ds_write_b64 v24, v[66:67] offset:8
    v_mov_b64 v[36:37], 0
    v_mov_b64 v[38:39], 0
    v_mov_b64 v[40:41], 0
    v_mov_b64 v[42:43], 0
    v_mov_b64 v[44:45], 0
    v_mov_b64 v[46:47], 0
    v_mov_b64 v[48:49], 0
    v_mov_b64 v[50:51], 0
    v_mov_b64 v[52:53], 0
    v_mov_b64 v[54:55], 0
    s_waitcnt lgkmcnt(0)
    s_barrier
    ds_read_b128 v[88:91], v25 offset:1024
    ds_read_b128 v[84:87], v25
    ds_read_b128 v[112:115], v19 offset:23552
    ds_read_b128 v[116:119], v19 offset:24576
    ds_read_b128 v[120:123], v19 offset:25600
    s_waitcnt lgkmcnt(4)
    v_smfmac_f32_16x16x64_bf16 v[36:39], v[88:91], v[216:223], v34
    ds_read_b128 v[124:127], v19 offset:26624
    s_add_u32 s17, s66, 8192
    s_waitcnt lgkmcnt(4)
    v_smfmac_f32_16x16x64_bf16 v[36:39], v[84:87], v[100:107], v34
    ds_read_b128 v[128:131], v19 offset:27648
    s_add_u32 s18, s66, 16384
    v_smfmac_f32_16x16x64_bf16 v[40:43], v[88:91], v[224:231], v34
    ds_read_b128 v[56:59], v19 offset:28672
    s_add_u32 s19, s66, 24576
    s_waitcnt lgkmcnt(5)
    v_smfmac_f32_16x16x64_bf16 v[40:43], v[84:87], v[108:115], v34
    ds_read_b128 v[60:63], v19 offset:29696
    s_add_u32 s65, s66, 32768
    v_smfmac_f32_16x16x64_bf16 v[44:47], v[88:91], v[232:239], v34
    v_add_f32 v36, v36, v38
    v_add_f32 v37, v37, v39
    s_waitcnt lgkmcnt(4)
    v_smfmac_f32_16x16x64_bf16 v[44:47], v[84:87], v[116:123], v34
    v_cvt_pk_bf16_f32 v64, v36, v37
    v_and_or_b32 v64, v64, -2, s41
    v_smfmac_f32_16x16x64_bf16 v[48:51], v[88:91], v[240:247], v34
    buffer_store_dword v64, v28, s[8:11], s66 offen
    v_add_f32 v40, v40, v42
    v_add_f32 v41, v41, v43
    s_waitcnt lgkmcnt(2)
    v_smfmac_f32_16x16x64_bf16 v[48:51], v[84:87], v[124:131], v34
    v_cvt_pk_bf16_f32 v65, v40, v41
    v_and_or_b32 v65, v65, -2, s41
    v_smfmac_f32_16x16x64_bf16 v[52:55], v[88:91], v[248:255], v34
    buffer_store_dword v65, v28, s[8:11], s17 offen
    v_add_f32 v44, v44, v46
    v_add_f32 v45, v45, v47
    s_waitcnt lgkmcnt(0)
    v_smfmac_f32_16x16x64_bf16 v[52:55], v[84:87], v[56:63], v34
    v_cvt_pk_bf16_f32 v66, v44, v45
    v_and_or_b32 v66, v66, -2, s41
    buffer_store_dword v66, v28, s[8:11], s18 offen
    v_add_f32 v48, v48, v50
    v_add_f32 v49, v49, v51
    v_cvt_pk_bf16_f32 v67, v48, v49
    v_and_or_b32 v67, v67, -2, s41
    buffer_store_dword v67, v28, s[8:11], s19 offen
    v_add_f32 v52, v52, v54
    v_add_f32 v53, v53, v55
    v_cvt_pk_bf16_f32 v68, v52, v53
    v_and_or_b32 v68, v68, -2, s41
    buffer_store_dword v68, v28, s[8:11], s65 offen
    s_waitcnt vmcnt(7)
    s_cmp_eq_u32 s33, 0
    s_cbranch_scc1 CF1_TOPN
    ds_read_b128 v[100:103], v19 offset:0
    v_mov_b32 v36, s35
    s_max_i32 s23, s20, 0
    ds_read_b128 v[104:107], v19 offset:1024
    v_mov_b32 v37, s35
    s_add_u32 s20, s20, 1
    ds_read_b128 v[108:111], v19 offset:2048
    v_mov_b32 v38, s35
    s_add_u32 s21, s20, 1
    ds_read_b128 v[112:115], v19 offset:3072
    v_mov_b32 v39, s35
    v_mov_b64 v[76:77], 0
    s_bfe_u32 s16, s21, 0x10001
    ds_read_b128 v[116:119], v19 offset:4096
    v_mov_b64 v[78:79], 0
    s_mov_b32 s37, s67
    ds_read_b128 v[120:123], v19 offset:5120
    v_mov_b64 v[80:81], 0
    s_xor_b32 s67, s67, s75
    ds_read_b128 v[124:127], v19 offset:6144
    v_mov_b64 v[82:83], 0
    s_xor_b32 s68, s68, s76
    ds_read_b128 v[128:131], v19 offset:7168
    v_mov_b64 v[84:85], 0
    v_mov_b64 v[86:87], 0
    s_xor_b32 s66, s66, s74
    buffer_load_dwordx4 v[56:59], v4, s[8:11], s64 offen offset:0 sc1
    buffer_load_dwordx4 v[148:151], v4, s[8:11], s64 offen offset:1024 sc1
    v_max_i32 v33, v1, v18
    v_max_i32 v33, v1, v18
    v_max_i32 v33, v1, v18
    v_max_i32 v33, v1, v18
    v_max_i32 v33, v1, v18
    v_max_i32 v33, v1, v18
    buffer_load_dwordx4 v[56:59], v4, s[8:11], s64 offen offset:0 sc1
    buffer_load_dwordx4 v[148:151], v4, s[8:11], s64 offen offset:1024 sc1
    v_max_i32 v33, v1, v18
    v_max_i32 v33, v1, v18
    v_max_i32 v33, v1, v18
    v_max_i32 v33, v1, v18
    v_max_i32 v33, v1, v18
    v_max_i32 v33, v1, v18
    v_max_i32 v33, v1, v18
    v_max_i32 v33, v1, v18
    v_max_i32 v33, v1, v18
    v_max_i32 v33, v1, v18
    v_max_i32 v33, v1, v18
    v_max_i32 v33, v1, v18
    v_max_i32 v33, v1, v18
    v_max_i32 v33, v1, v18
    v_max_i32 v33, v1, v18
    v_max_i32 v33, v1, v18
    v_max_i32 v33, v1, v18
    v_max_i32 v33, v1, v18
    v_max_i32 v33, v1, v18
    v_max_i32 v33, v1, v18
    v_max_i32 v33, v1, v18
    v_max_i32 v33, v1, v18
    v_max_i32 v33, v1, v18
    v_max_i32 v33, v1, v18
    v_max_i32 v33, v1, v18
    v_max_i32 v33, v1, v18
    v_max_i32 v33, v1, v18
    v_max_i32 v33, v1, v18
    v_max_i32 v33, v1, v18
    v_max_i32 v33, v1, v18
CF1_EC:
    s_waitcnt vmcnt(2)
    v_bitop3_b32 v14, v56, v57, s41 bitop3:0x7e
    v_bitop3_b32 v15, v58, v59, s41 bitop3:0x7e
    v_bitop3_b32 v16, v148, v149, s41 bitop3:0x7e
    v_bitop3_b32 v17, v150, v151, s41 bitop3:0x7e
    v_mfma_f32_16x16x32_bf16 v[52:55], v[56:59], v[6:9], 0
    v_mfma_f32_16x16x32_bf16 v[52:55], v[148:151], v[6:9], v[52:55]
    v_or3_b32 v14, v14, v16, v17
    v_bitop3_b32 v14, v14, v15, 1 bitop3:0xa8
    v_cmp_ne_u32 vcc, 0, v14
    s_nop 4
    v_add_f32 v52, v52, v54
    v_add_f32 v53, v53, v55
    s_cbranch_vccnz CF1_ES
    v_add_f32 v32, v52, v53
CF1_PUB:
    s_nop 1
    v_mov_b32_dpp v33, v32 quad_perm:[1,1,3,3] row_mask:0xf bank_mask:0xf
    v_cvt_pk_bf16_f32 v32, v32, v33
    v_and_or_b32 v32, v32, -2, s42
    buffer_store_dword v32, v29, s[8:11], s69 offen
    s_barrier
    buffer_store_dword v32, v29, s[8:11], s70 offen sc1
    s_branch CF1_TOP2
CF1_PUB0:
    ds_read_b128 v[100:103], v19 offset:0
    v_mov_b32 v36, s35
    s_max_i32 s23, s20, 0
    ds_read_b128 v[104:107], v19 offset:1024
    v_mov_b32 v37, s35
    s_add_u32 s20, s20, 1
    ds_read_b128 v[108:111], v19 offset:2048
    v_mov_b32 v38, s35
    s_add_u32 s21, s20, 1
    ds_read_b128 v[112:115], v19 offset:3072
    v_mov_b32 v39, s35
    v_mov_b64 v[76:77], 0
    s_bfe_u32 s16, s21, 0x10001
    ds_read_b128 v[116:119], v19 offset:4096
    v_mov_b64 v[78:79], 0
    s_mov_b32 s37, s67
    ds_read_b128 v[120:123], v19 offset:5120
    v_mov_b64 v[80:81], 0
    s_xor_b32 s67, s67, s75
    ds_read_b128 v[124:127], v19 offset:6144
    v_mov_b64 v[82:83], 0
    s_xor_b32 s68, s68, s76
    ds_read_b128 v[128:131], v19 offset:7168
    v_mov_b64 v[84:85], 0
    v_mov_b64 v[86:87], 0
    s_xor_b32 s66, s66, s74
    s_branch CF1_PUB
CF1_LS:
    s_mov_b64 exec, vcc
    buffer_load_dwordx4 v[36:39], v26, s[8:11], s36 offen offset:0 sc1
    buffer_load_dword v32, v27, s[8:11], s36 offen sc1
    s_mov_b64 exec, -1
    s_sub_u32 s24, s24, 1
    s_cbranch_scc0 CF1_LC
    s_branch C_FAIL
CF1_RS:
    s_mov_b64 exec, vcc
    buffer_load_dwordx4 v[56:59], v26, s[8:11], s71 offen offset:0 sc1
    buffer_load_dword v148, v27, s[8:11], s71 offen sc1
    s_add_u32 m0, s43, 24576
    s_nop 0
    buffer_load_dwordx4 v26, s[8:11], s71 offen sc1 lds
    s_add_u32 m0, s44, 24576
    s_nop 0
    buffer_load_dword v27, s[8:11], s71 offen sc1 lds
    s_mov_b64 exec, -1
    s_waitcnt vmcnt(0)
    v_bitop3_b32 v14, v56, v57, s41 bitop3:0x7e
    v_bitop3_b32 v15, v58, v59, s41 bitop3:0x7e
    v_bitop3_b32 v14, v14, v148, s41 bitop3:0xf6
    v_bitop3_b32 v14, v14, v15, 1 bitop3:0xa8
    v_cmp_ne_u32 vcc, 0, v14
    s_cbranch_vccz CF1_ROK
    s_sub_u32 s24, s24, 1
    s_cbranch_scc0 CF1_RS
    s_branch C_FAIL
CF1_ES:
    s_mov_b64 exec, vcc
    buffer_load_dwordx4 v[56:59], v4, s[8:11], s64 offen offset:0 sc1
    buffer_load_dwordx4 v[148:151], v4, s[8:11], s64 offen offset:1024 sc1
    s_mov_b64 exec, -1
    s_sub_u32 s24, s24, 1
    s_cbranch_scc0 CF1_EC
    s_branch C_FAIL
CF1_KVW:
CF1_KVL:
    v_and_b32 v33, 63, v35
    buffer_load_dword v33, v33, s[8:11], s57 offen sc1
    s_waitcnt vmcnt(0)
    v_cmp_eq_u32 vcc, 0, v33
    s_nop 0
    s_or_b32 s47, vcc_lo, 0x10000
    s_ff1_i32_b32 s47, s47
    s_mul_i32 s47, s47, 4
    s_cmp_ge_u32 s47, 64
    s_cselect_b32 s47, 255, s47
    s_cmp_lt_u32 s21, s47
    s_cbranch_scc1 CF1_KVD
    s_sleep 1
    s_sub_u32 s24, s24, 1
    s_cbranch_scc0 CF1_KVL
    s_branch C_FAIL
CF1_KVD:
    s_cmp_eq_u32 s20, 0
    s_cbranch_scc0 CF1_KVB
    s_sub_u32 s22, s38, 0x2000000
    s_xor_b32 s53, s53, 8192
    s_add_u32 m0, s53, 0
    s_nop 0
    buffer_load_dwordx4 v30, s[8:11], s22 offen offset:0 sc1 lds
    s_add_u32 m0, s53, 896
    s_nop 0
    buffer_load_dwordx4 v30, s[8:11], s22 offen offset:128 sc1 lds
    s_xor_b32 s53, s53, 8192
    s_add_u32 m0, s43, 24576
    s_waitcnt vmcnt(0)
    s_branch CF1_KVB
CF1_RV:
    s_mov_b64 exec, vcc
    buffer_load_dword v133, v35, s[8:11], s68 offen offset:0 sc1
    buffer_load_dword v135, v35, s[8:11], s68 offen offset:256 sc1
    s_mov_b64 exec, -1
    v_bitop3_b32 v14, v133, v135, s41 bitop3:0x7e
    v_and_b32 v14, 1, v14
    v_cmp_ne_u32 vcc, 0, v14
    v_max_i32 v33, v1, v18
    v_max_i32 v33, v1, v18
    s_cbranch_vccz CF1_BV
    v_bitop3_b32 v14, v133, v135, s41 bitop3:0x7e
    v_and_b32 v14, 1, v14
    v_cmp_ne_u32 vcc, 0, v14
    v_max_i32 v33, v1, v18
    v_max_i32 v33, v1, v18
    s_cbranch_vccz CF1_BV
    s_sub_u32 s24, s24, 1
    s_cbranch_scc0 CF1_RV
    s_branch C_FAIL
CF1_FB:
    v_max3_f32 v32, v84, v85, v86
    v_max3_f32 v32, v32, v87, v88
    v_max3_f32 v32, v32, v89, v90
    v_max3_f32 v32, v32, v91, v94
    v_max_f32 v32, v32, v95
    v_mov_b32 v33, v32
    s_nop 1
    v_permlane32_swap_b32 v32, v33
    v_max_f32 v32, v32, v33
    v_mov_b32 v33, v32
    s_nop 1
    v_permlane16_swap_b32 v32, v33
    v_max_f32 v32, v32, v33
    v_sub_f32 v84, v84, v32
    v_sub_f32 v85, v85, v32
    v_sub_f32 v86, v86, v32
    v_sub_f32 v87, v87, v32
    v_sub_f32 v88, v88, v32
    v_sub_f32 v89, v89, v32
    v_sub_f32 v90, v90, v32
    v_sub_f32 v91, v91, v32
    v_sub_f32 v94, v94, v32
    v_sub_f32 v95, v95, v32
    v_exp_f32 v84, v84
    v_exp_f32 v85, v85
    v_exp_f32 v86, v86
    v_exp_f32 v87, v87
    v_exp_f32 v88, v88
    v_exp_f32 v89, v89
    v_exp_f32 v90, v90
    v_exp_f32 v91, v91
    v_exp_f32 v94, v94
    v_exp_f32 v95, v95
    v_cvt_pk_bf16_f32 v52, v84, v85
    v_cvt_pk_bf16_f32 v53, v86, v87
    v_cvt_pk_bf16_f32 v54, v88, v89
    v_cvt_pk_bf16_f32 v55, v90, v91
    v_cvt_pk_bf16_f32 v136, v94, v95
    v_cvt_pk_bf16_f32 v137, v94, v95
    v_mfma_f32_16x16x32_bf16 v[96:99], v[10:13], v[52:55], 0
    v_mfma_f32_16x16x32_bf16 v[76:79], v[140:143], v[52:55], 0
    v_mfma_f32_16x16x32_bf16 v[80:83], v[144:147], v[52:55], 0
    s_nop 3
    v_mfma_f32_16x16x16_bf16 v[96:99], v[2:3], v[136:137], v[96:99]
    v_mfma_f32_16x16x16_bf16 v[76:79], v[132:133], v[136:137], v[76:79]
    v_mfma_f32_16x16x16_bf16 v[80:83], v[134:135], v[136:137], v[80:83]
    s_nop 5
    v_rcp_f32 v32, v96
    s_nop 0
    v_mul_f32 v148, v76, v32
    v_mul_f32 v149, v77, v32
    v_mul_f32 v150, v78, v32
    v_mul_f32 v151, v79, v32
    v_cvt_pk_bf16_f32 v64, v148, v149
    v_cvt_pk_bf16_f32 v65, v150, v151
    ds_write_b64 v24, v[64:65]
    v_mul_f32 v148, v80, v32
    v_mul_f32 v149, v81, v32
    v_mul_f32 v150, v82, v32
    v_mul_f32 v151, v83, v32
    v_cvt_pk_bf16_f32 v66, v148, v149
    v_cvt_pk_bf16_f32 v67, v150, v151
    s_branch CF1_BF
    s_branch CS1_ENTRY
    .p2align 6
CS1_ENTRY:
    s_cmp_eq_u32 s33, 0
    s_cbranch_scc0 CS1_PUB0
CS1_TOPN:
    ds_read_b128 v[100:103], v19 offset:0
    v_mov_b32 v36, s35
    s_max_i32 s23, s20, 0
    ds_read_b128 v[104:107], v19 offset:1024
    v_mov_b32 v37, s35
    s_add_u32 s20, s20, 1
    ds_read_b128 v[108:111], v19 offset:2048
    v_mov_b32 v38, s35
    s_add_u32 s21, s20, 1
    ds_read_b128 v[112:115], v19 offset:3072
    v_mov_b32 v39, s35
    v_mov_b64 v[76:77], 0
    s_bfe_u32 s16, s21, 0x10001
    ds_read_b128 v[116:119], v19 offset:4096
    v_mov_b64 v[78:79], 0
    s_mov_b32 s37, s67
    ds_read_b128 v[120:123], v19 offset:5120
    v_mov_b64 v[80:81], 0
    s_xor_b32 s67, s67, s75
    ds_read_b128 v[124:127], v19 offset:6144
    v_mov_b64 v[82:83], 0
    s_xor_b32 s68, s68, s76
    ds_read_b128 v[128:131], v19 offset:7168
    v_mov_b64 v[84:85], 0
    v_mov_b64 v[86:87], 0
    s_xor_b32 s66, s66, s74
    s_barrier
CS1_TOP2:
    s_mov_b32 s36, s69
    v_mov_b32 v32, s35
    s_mov_b32 s41, s42
    s_mov_b32 s42, s16
    s_xor_b32 s35, s16, 1
    s_lshl1_add_u32 s23, s23, s35
    v_max_i32 v33, v1, v18
    s_xor_b32 s69, s69, s77
    s_xor_b32 s70, s70, s48
    s_xor_b32 s64, s64, s72
    v_max_i32 v33, v1, v18
    ds_read_b128 v[132:135], v19 offset:8192
    v_mov_b64 v[88:89], 0
    s_xor_b32 s71, s71, s49
    ds_read_b128 v[136:139], v19 offset:9216
    v_mov_b64 v[90:91], 0
    s_add_u32 s38, s40, 0x2000000
    ds_read_b128 v[140:143], v19 offset:10240
    v_mov_b64 v[92:93], 0
    s_add_u32 s55, s59, 2048
    ds_read_b128 v[144:147], v19 offset:11264
    v_mov_b64 v[94:95], 0
    v_mov_b64 v[96:97], 0
    s_add_u32 s59, s40, s34
    ds_read_b128 v[60:63], v19 offset:12288
    v_mov_b64 v[98:99], 0
    s_add_u32 s40, s40, 524288
    ds_read_b128 v[64:67], v19 offset:13312
    v_xor_b32 v40, 1024, v26
    s_and_b32 s22, s21, 3
    s_cselect_b32 s22, 0, 8192
    ds_read_b128 v[68:71], v19 offset:14336
    v_xor_b32 v44, 2048, v26
    s_xor_b32 s40, s40, s22
    ds_read_b128 v[72:75], v19 offset:15360
    v_xor_b32 v48, 3072, v26
    v_xor_b32 v23, 8192, v23
    s_xor_b32 s53, s53, 8192
    s_add_u32 m0, s43, 24576
    buffer_load_dwordx4 v[36:39], v26, s[8:11], s36 offen offset:0 sc1
    buffer_load_dword v32, v27, s[8:11], s36 offen sc1
    v_max_i32 v33, v1, v18
    v_max_i32 v33, v1, v18
    v_max_i32 v33, v1, v18
    v_max_i32 v33, v1, v18
    v_max_i32 v33, v1, v18
    v_max_i32 v33, v1, v18
    v_max_i32 v33, v1, v18
    v_max_i32 v33, v1, v18
    v_max_i32 v33, v1, v18
    v_max_i32 v33, v1, v18
    v_max_i32 v33, v1, v18
    v_max_i32 v33, v1, v18
    v_max_i32 v33, v1, v18
    v_max_i32 v33, v1, v18
    v_max_i32 v33, v1, v18
    v_max_i32 v33, v1, v18
    v_max_i32 v33, v1, v18
    v_max_i32 v33, v1, v18
    v_max_i32 v33, v1, v18
    v_max_i32 v33, v1, v18
    v_max_i32 v33, v1, v18
    v_max_i32 v33, v1, v18
    v_max_i32 v33, v1, v18
    v_max_i32 v33, v1, v18
    v_max_i32 v33, v1, v18
    buffer_load_dwordx4 v[36:39], v26, s[8:11], s36 offen offset:0 sc1
    buffer_load_dword v32, v27, s[8:11], s36 offen sc1
    v_max_i32 v33, v1, v18
    v_max_i32 v33, v1, v18
    v_max_i32 v33, v1, v18
    v_max_i32 v33, v1, v18
    v_max_i32 v33, v1, v18
    v_max_i32 v33, v1, v18
    v_max_i32 v33, v1, v18
    v_max_i32 v33, v1, v18
    v_max_i32 v33, v1, v18
    v_max_i32 v33, v1, v18
    v_max_i32 v33, v1, v18
    v_max_i32 v33, v1, v18
    v_max_i32 v33, v1, v18
    v_max_i32 v33, v1, v18
    v_max_i32 v33, v1, v18
    v_max_i32 v33, v1, v18
    v_max_i32 v33, v1, v18
    v_max_i32 v33, v1, v18
    v_max_i32 v33, v1, v18
    v_max_i32 v33, v1, v18
    v_max_i32 v33, v1, v18
    v_max_i32 v33, v1, v18
    v_max_i32 v33, v1, v18
    v_max_i32 v33, v1, v18
    v_max_i32 v33, v1, v18
    s_cmp_ge_u32 s21, s47
    s_cbranch_scc1 CS1_KVW
CS1_KVB:
    s_waitcnt lgkmcnt(0)
CS1_LC:
    s_waitcnt vmcnt(2)
    v_bitop3_b32 v14, v36, v37, s41 bitop3:0x7e
    v_bitop3_b32 v15, v38, v39, s41 bitop3:0x7e
    v_bitop3_b32 v14, v14, v32, s41 bitop3:0xf6
    v_bitop3_b32 v14, v14, v15, 1 bitop3:0xa8
    v_cmp_ne_u32 vcc, 0, v14
    ds_write_b128 v26, v[36:39] offset:16384
    s_cbranch_vccnz CS1_LS
    s_barrier
    v_smfmac_f32_16x16x64_bf16 v[76:79], v[36:39], v[100:107], v34
    ds_write_b32 v27, v32 offset:16384
    buffer_load_dwordx4 v[56:59], v26, s[8:11], s71 offen offset:0 sc1
    v_smfmac_f32_16x16x64_bf16 v[80:83], v[36:39], v[108:115], v34
    buffer_load_dword v148, v27, s[8:11], s71 offen sc1
    v_smfmac_f32_16x16x64_bf16 v[84:87], v[36:39], a[0:7], v34
    s_waitcnt lgkmcnt(0)
    s_barrier
    ds_read_b128 v[40:43], v40 offset:16384
    v_smfmac_f32_16x16x64_bf16 v[88:91], v[36:39], a[16:23], v34
    ds_read_b128 v[44:47], v44 offset:16384
    buffer_load_dwordx4 v26, s[8:11], s71 offen sc1 lds
    v_smfmac_f32_16x16x64_bf16 v[92:95], v[36:39], a[8:15], v34
    ds_read_b128 v[48:51], v48 offset:16384
    s_add_u32 m0, s44, 24576
    v_smfmac_f32_16x16x64_bf16 v[96:99], v[36:39], a[24:31], v34
    ds_read_b128 v[52:55], v1 offset:20480
    s_waitcnt lgkmcnt(3)
    v_smfmac_f32_16x16x64_bf16 v[76:79], v[40:43], v[116:123], v34
    ds_read_b128 v[100:103], v19 offset:16384
    buffer_load_dword v27, s[8:11], s71 offen sc1 lds
    v_smfmac_f32_16x16x64_bf16 v[80:83], v[40:43], v[124:131], v34
    ds_read_b128 v[104:107], v19 offset:17408
    s_waitcnt lgkmcnt(4)
    v_smfmac_f32_16x16x64_bf16 v[76:79], v[44:47], v[132:139], v34
    ds_read_b128 v[108:111], v19 offset:18432
    v_mov_b32 v150, s23
    v_smfmac_f32_16x16x64_bf16 v[80:83], v[44:47], v[140:147], v34
    ds_read_b128 v[112:115], v19 offset:19456
    s_waitcnt lgkmcnt(5)
    v_smfmac_f32_16x16x64_bf16 v[76:79], v[48:51], v[60:67], v34
    v_smfmac_f32_16x16x64_bf16 v[80:83], v[48:51], v[68:75], v34
    buffer_store_dword v150, v5, s[8:11], s37 offen offset:0 sc1
    v_xor_b32 v138, 8, v18
    v_smfmac_f32_16x16x64_bf16 v[84:87], v[40:43], a[32:39], v34
    buffer_store_dword v22, v35, s[8:11], s55 offen offset:256 sc1
    v_smfmac_f32_16x16x64_bf16 v[88:91], v[40:43], a[48:55], v34
    s_waitcnt lgkmcnt(0)
    v_smfmac_f32_16x16x64_bf16 v[76:79], v[52:55], v[100:107], v34
    s_nop 1
    v_smfmac_f32_16x16x64_bf16 v[80:83], v[52:55], v[108:115], v34
    ds_read_b128 v[100:103], v23 offset:0
    s_nop 0
    v_smfmac_f32_16x16x64_bf16 v[84:87], v[44:47], a[64:71], v34
    ds_read_b128 v[108:111], v23 offset:2048
    s_nop 0
    v_smfmac_f32_16x16x64_bf16 v[88:91], v[44:47], a[80:87], v34
    v_add_f32 v76, v76, v78
    v_add_f32 v77, v77, v79
    v_cvt_pk_bf16_f32 v132, v76, v77
    v_and_or_b32 v132, v132, -2, s41
    v_smfmac_f32_16x16x64_bf16 v[84:87], v[48:51], a[96:103], v34
    buffer_store_dword v132, v35, s[8:11], s67 offen offset:0 sc1
    v_add_f32 v80, v80, v82
    v_add_f32 v81, v81, v83
    v_cvt_pk_bf16_f32 v134, v80, v81
    v_and_or_b32 v134, v134, -2, s41
    v_smfmac_f32_16x16x64_bf16 v[88:91], v[48:51], a[112:119], v34
    buffer_store_dword v134, v35, s[8:11], s67 offen offset:256 sc1
    v_smfmac_f32_16x16x64_bf16 v[84:87], v[52:55], a[128:135], v34
    ds_read_b128 v[116:119], v23 offset:4096
    buffer_load_dwordx4 v[140:143], v31, s[8:11], s38 offen offset:0 sc1
    v_smfmac_f32_16x16x64_bf16 v[88:91], v[52:55], a[144:151], v34
    ds_read_b128 v[124:127], v23 offset:6144
    buffer_load_dwordx4 v[144:147], v31, s[8:11], s38 offen offset:256 sc1
    v_smfmac_f32_16x16x64_bf16 v[92:95], v[40:43], a[40:47], v34
    buffer_store_dword v132, v35, s[8:11], s59 offen offset:0 sc1
    v_smfmac_f32_16x16x64_bf16 v[96:99], v[40:43], a[56:63], v34
    buffer_store_dword v134, v35, s[8:11], s59 offen offset:256 sc1
    v_smfmac_f32_16x16x64_bf16 v[92:95], v[44:47], a[72:79], v34
    s_waitcnt vmcnt(8)
    v_bitop3_b32 v14, v56, v57, s41 bitop3:0x7e
    v_bitop3_b32 v15, v58, v59, s41 bitop3:0x7e
    v_smfmac_f32_16x16x64_bf16 v[96:99], v[44:47], a[88:95], v34
    v_bitop3_b32 v14, v14, v148, s41 bitop3:0xf6
    v_bitop3_b32 v14, v14, v15, 1 bitop3:0xa8
    v_cmp_ne_u32 vcc, 0, v14
    v_smfmac_f32_16x16x64_bf16 v[92:95], v[48:51], a[104:111], v34
    v_smfmac_f32_16x16x64_bf16 v[96:99], v[48:51], a[120:127], v34
    s_cbranch_vccnz CS1_RS
CS1_ROK:
    s_barrier
    ds_read_b128 v[56:59], v1 offset:24576
    v_smfmac_f32_16x16x64_bf16 v[92:95], v[52:55], a[136:143], v34
    ds_read_b128 v[60:63], v1 offset:25600
    v_smfmac_f32_16x16x64_bf16 v[96:99], v[52:55], a[152:159], v34
    ds_read_b128 v[64:67], v1 offset:26624
    s_waitcnt lgkmcnt(2)
    v_smfmac_f32_16x16x64_bf16 v[84:87], v[56:59], a[160:167], v34
    ds_read_b128 v[68:71], v1 offset:27648
    v_smfmac_f32_16x16x64_bf16 v[88:91], v[56:59], a[176:183], v34
    ds_read_b128 v[72:75], v1 offset:28672
    s_waitcnt lgkmcnt(3)
    v_smfmac_f32_16x16x64_bf16 v[84:87], v[60:63], a[192:199], v34
    ds_read_b128 v[104:107], v23 offset:1024
    v_smfmac_f32_16x16x64_bf16 v[88:91], v[60:63], a[208:215], v34
    ds_read_b128 v[112:115], v23 offset:3072
    s_waitcnt lgkmcnt(4)
    v_smfmac_f32_16x16x64_bf16 v[84:87], v[64:67], a[224:231], v34
    ds_read_b128 v[120:123], v23 offset:5120
    v_smfmac_f32_16x16x64_bf16 v[88:91], v[64:67], a[240:247], v34
    ds_read_b128 v[128:131], v23 offset:7168
    s_waitcnt lgkmcnt(5)
    v_smfmac_f32_16x16x64_bf16 v[84:87], v[68:71], v[152:159], v34
    buffer_store_dword v150, v0, s[8:11], s37 offen offset:0 sc1
    v_smfmac_f32_16x16x64_bf16 v[88:91], v[68:71], v[168:175], v34
    s_waitcnt lgkmcnt(4)
    v_smfmac_f32_16x16x64_bf16 v[84:87], v[72:75], v[184:191], v34
    s_nop 1
    v_smfmac_f32_16x16x64_bf16 v[88:91], v[72:75], v[200:207], v34
    s_nop 1
    v_smfmac_f32_16x16x64_bf16 v[92:95], v[56:59], a[168:175], v34
    s_nop 1
    v_smfmac_f32_16x16x64_bf16 v[96:99], v[56:59], a[184:191], v34
    v_add_f32 v84, v84, v86
    v_add_f32 v85, v85, v87
    v_mul_f32 v84, s54, v84
    v_mul_f32 v85, s54, v85
    v_smfmac_f32_16x16x64_bf16 v[92:95], v[60:63], a[200:207], v34
    v_add_f32 v88, v88, v90
    v_add_f32 v89, v89, v91
    v_mul_f32 v88, s54, v88
    v_mul_f32 v89, s54, v89
    v_smfmac_f32_16x16x64_bf16 v[96:99], v[60:63], a[216:223], v34
    v_cvt_pk_bf16_f32 v21, v84, v85
    v_cvt_pk_bf16_f32 v22, v88, v89
    ds_write2_b32 v20, v21, v22 offset0:0 offset1:64
    v_smfmac_f32_16x16x64_bf16 v[92:95], v[64:67], a[232:239], v34
    buffer_load_dword v133, v35, s[8:11], s68 offen offset:0 sc1
    v_smfmac_f32_16x16x64_bf16 v[96:99], v[64:67], a[248:255], v34
    buffer_load_dword v135, v35, s[8:11], s68 offen offset:256 sc1
    v_smfmac_f32_16x16x64_bf16 v[92:95], v[68:71], v[160:167], v34
    s_waitcnt lgkmcnt(0)
    s_barrier
    ds_read_b64_tr_b16 v[36:37], v18 offset:30720
    v_smfmac_f32_16x16x64_bf16 v[96:99], v[68:71], v[176:183], v34
    ds_read_b64_tr_b16 v[38:39], v138 offset:31232
    ds_read_b64_tr_b16 v[40:41], v18 offset:31744
    v_smfmac_f32_16x16x64_bf16 v[92:95], v[72:75], v[192:199], v34
    ds_read_b64_tr_b16 v[42:43], v138 offset:32256
    ds_read_b64_tr_b16 v[44:45], v18 offset:32768
    v_smfmac_f32_16x16x64_bf16 v[96:99], v[72:75], v[208:215], v34
    ds_read_b64_tr_b16 v[46:47], v138 offset:33280
    ds_read_b64_tr_b16 v[48:49], v18 offset:33792
    ds_read_b64_tr_b16 v[50:51], v138 offset:34304
    s_nop 1
    v_add_f32 v92, v92, v94
    v_add_f32 v93, v93, v95
    s_nop 0
    v_add_f32 v96, v96, v98
    v_add_f32 v97, v97, v99
    v_cvt_pk_bf16_f32 v21, v92, v93
    v_cvt_pk_bf16_f32 v22, v96, v97
    ds_write2_b32 v20, v21, v22 offset0:1 offset1:65
    s_waitcnt lgkmcnt(7)
    v_mfma_f32_16x16x32_bf16 v[84:87], v[100:103], v[36:39], 0
    buffer_load_dword v133, v35, s[8:11], s68 offen offset:0 sc1
    s_waitcnt lgkmcnt(5)
    v_mfma_f32_16x16x32_bf16 v[84:87], v[108:111], v[40:43], v[84:87]
    buffer_load_dword v135, v35, s[8:11], s68 offen offset:256 sc1
    s_waitcnt lgkmcnt(3)
    v_mfma_f32_16x16x32_bf16 v[84:87], v[116:119], v[44:47], v[84:87]
    s_cmp_eq_u32 s20, 63
    s_waitcnt lgkmcnt(1)
    v_mfma_f32_16x16x32_bf16 v[84:87], v[124:127], v[48:51], v[84:87]
    s_waitcnt lgkmcnt(0)
    s_barrier
    ds_read_b64_tr_b16 v[56:57], v18 offset:30720
    ds_read_b64_tr_b16 v[58:59], v138 offset:31232
    s_cbranch_scc1 C_LAST1
    v_mfma_f32_16x16x32_bf16 v[88:91], v[104:107], v[36:39], 0
    ds_read_b64_tr_b16 v[60:61], v18 offset:31744
    ds_read_b64_tr_b16 v[62:63], v138 offset:32256
    v_mfma_f32_16x16x32_bf16 v[88:91], v[112:115], v[40:43], v[88:91]
    ds_read_b64_tr_b16 v[64:65], v18 offset:32768
    ds_read_b64_tr_b16 v[66:67], v138 offset:33280
    v_exp_f32 v148, v84
    v_mfma_f32_16x16x32_bf16 v[88:91], v[120:123], v[44:47], v[88:91]
    ds_read_b64_tr_b16 v[68:69], v18 offset:33792
    ds_read_b64_tr_b16 v[70:71], v138 offset:34304
    v_exp_f32 v149, v85
    v_mfma_f32_16x16x32_bf16 v[88:91], v[128:131], v[48:51], v[88:91]
    v_exp_f32 v150, v86
    v_exp_f32 v151, v87
    v_cvt_pk_bf16_f32 v52, v148, v149
    v_cvt_pk_bf16_f32 v53, v150, v151
    s_add_u32 m0, s53, 0
    s_waitcnt lgkmcnt(6)
    v_mfma_f32_16x16x32_bf16 v[92:95], v[56:59], v[36:39], 0
    buffer_load_dwordx4 v30, s[8:11], s40 offen offset:0 sc1 lds
    v_exp_f32 v148, v88
    s_waitcnt lgkmcnt(4)
    v_mfma_f32_16x16x32_bf16 v[92:95], v[60:63], v[40:43], v[92:95]
    s_add_u32 m0, s53, 896
    v_exp_f32 v149, v89
    s_waitcnt lgkmcnt(2)
    v_mfma_f32_16x16x32_bf16 v[92:95], v[64:67], v[44:47], v[92:95]
    buffer_load_dwordx4 v30, s[8:11], s40 offen offset:128 sc1 lds
    v_exp_f32 v150, v90
    s_waitcnt lgkmcnt(0)
    v_mfma_f32_16x16x32_bf16 v[92:95], v[68:71], v[48:51], v[92:95]
    v_exp_f32 v151, v91
    v_cvt_pk_bf16_f32 v54, v148, v149
    v_cvt_pk_bf16_f32 v55, v150, v151
    s_waitcnt vmcnt(4)
    v_bitop3_b32 v14, v133, v135, s41 bitop3:0x7e
    v_and_b32 v14, 1, v14
    v_mfma_f32_16x16x32_bf16 v[96:99], v[10:13], v[52:55], 0
    v_cmp_ne_u32 vcc, 0, v14
    v_exp_f32 v148, v94
    v_mfma_f32_16x16x32_bf16 v[76:79], v[140:143], v[52:55], 0
    v_exp_f32 v149, v95
    v_mfma_f32_16x16x32_bf16 v[80:83], v[144:147], v[52:55], 0
    v_cvt_pk_bf16_f32 v136, v148, v149
    v_cvt_pk_bf16_f32 v137, v148, v149
    s_nop 1
    v_mfma_f32_16x16x16_bf16 v[96:99], v[2:3], v[136:137], v[96:99]
    s_cbranch_vccnz CS1_RV
CS1_BV:
    v_mfma_f32_16x16x16_bf16 v[76:79], v[132:133], v[136:137], v[76:79]
    ds_read_b128 v[100:103], v19 offset:20480
    v_mfma_f32_16x16x16_bf16 v[80:83], v[134:135], v[136:137], v[80:83]
    ds_read_b128 v[104:107], v19 offset:21504
    ds_read_b128 v[108:111], v19 offset:22528
    s_nop 1
    v_rcp_f32 v32, v96
    v_subrev_u32 v33, s45, v96
    v_cmp_le_u32 vcc, s46, v33
    v_mul_f32 v148, v76, v32
    v_mul_f32 v149, v77, v32
    v_mul_f32 v150, v78, v32
    v_mul_f32 v151, v79, v32
    v_cvt_pk_bf16_f32 v64, v148, v149
    v_cvt_pk_bf16_f32 v65, v150, v151
    ds_write_b64 v24, v[64:65]
    v_mul_f32 v148, v80, v32
    v_mul_f32 v149, v81, v32
    v_mul_f32 v150, v82, v32
    v_mul_f32 v151, v83, v32
    v_cvt_pk_bf16_f32 v66, v148, v149
    v_cvt_pk_bf16_f32 v67, v150, v151
    s_and_b64 vcc, vcc, s[60:61]
    s_cbranch_scc1 CS1_FB
CS1_BF:
    ds_write_b64 v24, v[66:67] offset:8
    v_mov_b64 v[36:37], 0
    v_mov_b64 v[38:39], 0
    v_mov_b64 v[40:41], 0
    v_mov_b64 v[42:43], 0
    v_mov_b64 v[44:45], 0
    v_mov_b64 v[46:47], 0
    v_mov_b64 v[48:49], 0
    v_mov_b64 v[50:51], 0
    v_mov_b64 v[52:53], 0
    v_mov_b64 v[54:55], 0
    s_waitcnt lgkmcnt(0)
    s_barrier
    ds_read_b128 v[88:91], v25 offset:1024
    ds_read_b128 v[84:87], v25
    ds_read_b128 v[112:115], v19 offset:23552
    ds_read_b128 v[116:119], v19 offset:24576
    ds_read_b128 v[120:123], v19 offset:25600
    s_waitcnt lgkmcnt(4)
    v_smfmac_f32_16x16x64_bf16 v[36:39], v[88:91], v[216:223], v34
    ds_read_b128 v[124:127], v19 offset:26624
    s_add_u32 s17, s66, 8192
    s_waitcnt lgkmcnt(4)
    v_smfmac_f32_16x16x64_bf16 v[36:39], v[84:87], v[100:107], v34
    ds_read_b128 v[128:131], v19 offset:27648
    s_add_u32 s18, s66, 16384
    v_smfmac_f32_16x16x64_bf16 v[40:43], v[88:91], v[224:231], v34
    ds_read_b128 v[56:59], v19 offset:28672
    s_add_u32 s19, s66, 24576
    s_waitcnt lgkmcnt(5)
    v_smfmac_f32_16x16x64_bf16 v[40:43], v[84:87], v[108:115], v34
    ds_read_b128 v[60:63], v19 offset:29696
    s_add_u32 s65, s66, 32768
    v_smfmac_f32_16x16x64_bf16 v[44:47], v[88:91], v[232:239], v34
    v_add_f32 v36, v36, v38
    v_add_f32 v37, v37, v39
    s_waitcnt lgkmcnt(4)
    v_smfmac_f32_16x16x64_bf16 v[44:47], v[84:87], v[116:123], v34
    v_cvt_pk_bf16_f32 v64, v36, v37
    v_and_or_b32 v64, v64, -2, s41
    v_smfmac_f32_16x16x64_bf16 v[48:51], v[88:91], v[240:247], v34
    buffer_store_dword v64, v28, s[8:11], s66 offen sc1
    v_add_f32 v40, v40, v42
    v_add_f32 v41, v41, v43
    s_waitcnt lgkmcnt(2)
    v_smfmac_f32_16x16x64_bf16 v[48:51], v[84:87], v[124:131], v34
    v_cvt_pk_bf16_f32 v65, v40, v41
    v_and_or_b32 v65, v65, -2, s41
    v_smfmac_f32_16x16x64_bf16 v[52:55], v[88:91], v[248:255], v34
    buffer_store_dword v65, v28, s[8:11], s17 offen sc1
    v_add_f32 v44, v44, v46
    v_add_f32 v45, v45, v47
    s_waitcnt lgkmcnt(0)
    v_smfmac_f32_16x16x64_bf16 v[52:55], v[84:87], v[56:63], v34
    v_cvt_pk_bf16_f32 v66, v44, v45
    v_and_or_b32 v66, v66, -2, s41
    buffer_store_dword v66, v28, s[8:11], s18 offen sc1
    v_add_f32 v48, v48, v50
    v_add_f32 v49, v49, v51
    v_cvt_pk_bf16_f32 v67, v48, v49
    v_and_or_b32 v67, v67, -2, s41
    buffer_store_dword v67, v28, s[8:11], s19 offen sc1
    v_add_f32 v52, v52, v54
    v_add_f32 v53, v53, v55
    v_cvt_pk_bf16_f32 v68, v52, v53
    v_and_or_b32 v68, v68, -2, s41
    buffer_store_dword v68, v28, s[8:11], s65 offen sc1
    s_waitcnt vmcnt(7)
    s_cmp_eq_u32 s33, 0
    s_cbranch_scc1 CS1_TOPN
    ds_read_b128 v[100:103], v19 offset:0
    v_mov_b32 v36, s35
    s_max_i32 s23, s20, 0
    ds_read_b128 v[104:107], v19 offset:1024
    v_mov_b32 v37, s35
    s_add_u32 s20, s20, 1
    ds_read_b128 v[108:111], v19 offset:2048
    v_mov_b32 v38, s35
    s_add_u32 s21, s20, 1
    ds_read_b128 v[112:115], v19 offset:3072
    v_mov_b32 v39, s35
    v_mov_b64 v[76:77], 0
    s_bfe_u32 s16, s21, 0x10001
    ds_read_b128 v[116:119], v19 offset:4096
    v_mov_b64 v[78:79], 0
    s_mov_b32 s37, s67
    ds_read_b128 v[120:123], v19 offset:5120
    v_mov_b64 v[80:81], 0
    s_xor_b32 s67, s67, s75
    ds_read_b128 v[124:127], v19 offset:6144
    v_mov_b64 v[82:83], 0
    s_xor_b32 s68, s68, s76
    ds_read_b128 v[128:131], v19 offset:7168
    v_mov_b64 v[84:85], 0
    v_mov_b64 v[86:87], 0
    s_xor_b32 s66, s66, s74
    buffer_load_dwordx4 v[56:59], v4, s[8:11], s64 offen offset:0 sc1
    buffer_load_dwordx4 v[148:151], v4, s[8:11], s64 offen offset:1024 sc1
    v_max_i32 v33, v1, v18
    v_max_i32 v33, v1, v18
    v_max_i32 v33, v1, v18
    v_max_i32 v33, v1, v18
    v_max_i32 v33, v1, v18
    v_max_i32 v33, v1, v18
    buffer_load_dwordx4 v[56:59], v4, s[8:11], s64 offen offset:0 sc1
    buffer_load_dwordx4 v[148:151], v4, s[8:11], s64 offen offset:1024 sc1
    v_max_i32 v33, v1, v18
    v_max_i32 v33, v1, v18
    v_max_i32 v33, v1, v18
    v_max_i32 v33, v1, v18
    v_max_i32 v33, v1, v18
    v_max_i32 v33, v1, v18
    v_max_i32 v33, v1, v18
    v_max_i32 v33, v1, v18
    v_max_i32 v33, v1, v18
    v_max_i32 v33, v1, v18
    v_max_i32 v33, v1, v18
    v_max_i32 v33, v1, v18
    v_max_i32 v33, v1, v18
    v_max_i32 v33, v1, v18
    v_max_i32 v33, v1, v18
    v_max_i32 v33, v1, v18
    v_max_i32 v33, v1, v18
    v_max_i32 v33, v1, v18
    v_max_i32 v33, v1, v18
    v_max_i32 v33, v1, v18
    v_max_i32 v33, v1, v18
    v_max_i32 v33, v1, v18
    v_max_i32 v33, v1, v18
    v_max_i32 v33, v1, v18
    v_max_i32 v33, v1, v18
    v_max_i32 v33, v1, v18
    v_max_i32 v33, v1, v18
    v_max_i32 v33, v1, v18
    v_max_i32 v33, v1, v18
    v_max_i32 v33, v1, v18
CS1_EC:
    s_waitcnt vmcnt(2)
    v_bitop3_b32 v14, v56, v57, s41 bitop3:0x7e
    v_bitop3_b32 v15, v58, v59, s41 bitop3:0x7e
    v_bitop3_b32 v16, v148, v149, s41 bitop3:0x7e
    v_bitop3_b32 v17, v150, v151, s41 bitop3:0x7e
    v_mfma_f32_16x16x32_bf16 v[52:55], v[56:59], v[6:9], 0
    v_mfma_f32_16x16x32_bf16 v[52:55], v[148:151], v[6:9], v[52:55]
    v_or3_b32 v14, v14, v16, v17
    v_bitop3_b32 v14, v14, v15, 1 bitop3:0xa8
    v_cmp_ne_u32 vcc, 0, v14
    s_nop 4
    v_add_f32 v52, v52, v54
    v_add_f32 v53, v53, v55
    s_cbranch_vccnz CS1_ES
    v_add_f32 v32, v52, v53
CS1_PUB:
    s_nop 1
    v_mov_b32_dpp v33, v32 quad_perm:[1,1,3,3] row_mask:0xf bank_mask:0xf
    v_cvt_pk_bf16_f32 v32, v32, v33
    v_and_or_b32 v32, v32, -2, s42
    buffer_store_dword v32, v29, s[8:11], s69 offen sc1
    s_barrier
    buffer_store_dword v32, v29, s[8:11], s70 offen sc1
    s_branch CS1_TOP2
CS1_PUB0:
    ds_read_b128 v[100:103], v19 offset:0
    v_mov_b32 v36, s35
    s_max_i32 s23, s20, 0
    ds_read_b128 v[104:107], v19 offset:1024
    v_mov_b32 v37, s35
    s_add_u32 s20, s20, 1
    ds_read_b128 v[108:111], v19 offset:2048
    v_mov_b32 v38, s35
    s_add_u32 s21, s20, 1
    ds_read_b128 v[112:115], v19 offset:3072
    v_mov_b32 v39, s35
    v_mov_b64 v[76:77], 0
    s_bfe_u32 s16, s21, 0x10001
    ds_read_b128 v[116:119], v19 offset:4096
    v_mov_b64 v[78:79], 0
    s_mov_b32 s37, s67
    ds_read_b128 v[120:123], v19 offset:5120
    v_mov_b64 v[80:81], 0
    s_xor_b32 s67, s67, s75
    ds_read_b128 v[124:127], v19 offset:6144
    v_mov_b64 v[82:83], 0
    s_xor_b32 s68, s68, s76
    ds_read_b128 v[128:131], v19 offset:7168
    v_mov_b64 v[84:85], 0
    v_mov_b64 v[86:87], 0
    s_xor_b32 s66, s66, s74
    s_branch CS1_PUB
CS1_LS:
    s_mov_b64 exec, vcc
    buffer_load_dwordx4 v[36:39], v26, s[8:11], s36 offen offset:0 sc1
    buffer_load_dword v32, v27, s[8:11], s36 offen sc1
    s_mov_b64 exec, -1
    s_sub_u32 s24, s24, 1
    s_cbranch_scc0 CS1_LC
    s_branch C_FAIL
CS1_RS:
    s_mov_b64 exec, vcc
    buffer_load_dwordx4 v[56:59], v26, s[8:11], s71 offen offset:0 sc1
    buffer_load_dword v148, v27, s[8:11], s71 offen sc1
    s_add_u32 m0, s43, 24576
    s_nop 0
    buffer_load_dwordx4 v26, s[8:11], s71 offen sc1 lds
    s_add_u32 m0, s44, 24576
    s_nop 0
    buffer_load_dword v27, s[8:11], s71 offen sc1 lds
    s_mov_b64 exec, -1
    s_waitcnt vmcnt(0)
    v_bitop3_b32 v14, v56, v57, s41 bitop3:0x7e
    v_bitop3_b32 v15, v58, v59, s41 bitop3:0x7e
    v_bitop3_b32 v14, v14, v148, s41 bitop3:0xf6
    v_bitop3_b32 v14, v14, v15, 1 bitop3:0xa8
    v_cmp_ne_u32 vcc, 0, v14
    s_cbranch_vccz CS1_ROK
    s_sub_u32 s24, s24, 1
    s_cbranch_scc0 CS1_RS
    s_branch C_FAIL
CS1_ES:
    s_mov_b64 exec, vcc
    buffer_load_dwordx4 v[56:59], v4, s[8:11], s64 offen offset:0 sc1
    buffer_load_dwordx4 v[148:151], v4, s[8:11], s64 offen offset:1024 sc1
    s_mov_b64 exec, -1
    s_sub_u32 s24, s24, 1
    s_cbranch_scc0 CS1_EC
    s_branch C_FAIL
CS1_KVW:
CS1_KVL:
    v_and_b32 v33, 63, v35
    buffer_load_dword v33, v33, s[8:11], s57 offen sc1
    s_waitcnt vmcnt(0)
    v_cmp_eq_u32 vcc, 0, v33
    s_nop 0
    s_or_b32 s47, vcc_lo, 0x10000
    s_ff1_i32_b32 s47, s47
    s_mul_i32 s47, s47, 4
    s_cmp_ge_u32 s47, 64
    s_cselect_b32 s47, 255, s47
    s_cmp_lt_u32 s21, s47
    s_cbranch_scc1 CS1_KVD
    s_sleep 1
    s_sub_u32 s24, s24, 1
    s_cbranch_scc0 CS1_KVL
    s_branch C_FAIL
CS1_KVD:
    s_cmp_eq_u32 s20, 0
    s_cbranch_scc0 CS1_KVB
    s_sub_u32 s22, s38, 0x2000000
    s_xor_b32 s53, s53, 8192
    s_add_u32 m0, s53, 0
    s_nop 0
    buffer_load_dwordx4 v30, s[8:11], s22 offen offset:0 sc1 lds
    s_add_u32 m0, s53, 896
    s_nop 0
    buffer_load_dwordx4 v30, s[8:11], s22 offen offset:128 sc1 lds
    s_xor_b32 s53, s53, 8192
    s_add_u32 m0, s43, 24576
    s_waitcnt vmcnt(0)
    s_branch CS1_KVB
CS1_RV:
    s_mov_b64 exec, vcc
    buffer_load_dword v133, v35, s[8:11], s68 offen offset:0 sc1
    buffer_load_dword v135, v35, s[8:11], s68 offen offset:256 sc1
    s_mov_b64 exec, -1
    v_bitop3_b32 v14, v133, v135, s41 bitop3:0x7e
    v_and_b32 v14, 1, v14
    v_cmp_ne_u32 vcc, 0, v14
    v_max_i32 v33, v1, v18
    v_max_i32 v33, v1, v18
    s_cbranch_vccz CS1_BV
    v_bitop3_b32 v14, v133, v135, s41 bitop3:0x7e
    v_and_b32 v14, 1, v14
    v_cmp_ne_u32 vcc, 0, v14
    v_max_i32 v33, v1, v18
    v_max_i32 v33, v1, v18
    s_cbranch_vccz CS1_BV
    s_sub_u32 s24, s24, 1
    s_cbranch_scc0 CS1_RV
    s_branch C_FAIL
CS1_FB:
    v_max3_f32 v32, v84, v85, v86
    v_max3_f32 v32, v32, v87, v88
    v_max3_f32 v32, v32, v89, v90
    v_max3_f32 v32, v32, v91, v94
    v_max_f32 v32, v32, v95
    v_mov_b32 v33, v32
    s_nop 1
    v_permlane32_swap_b32 v32, v33
    v_max_f32 v32, v32, v33
    v_mov_b32 v33, v32
    s_nop 1
    v_permlane16_swap_b32 v32, v33
    v_max_f32 v32, v32, v33
    v_sub_f32 v84, v84, v32
    v_sub_f32 v85, v85, v32
    v_sub_f32 v86, v86, v32
    v_sub_f32 v87, v87, v32
    v_sub_f32 v88, v88, v32
    v_sub_f32 v89, v89, v32
    v_sub_f32 v90, v90, v32
    v_sub_f32 v91, v91, v32
    v_sub_f32 v94, v94, v32
    v_sub_f32 v95, v95, v32
    v_exp_f32 v84, v84
    v_exp_f32 v85, v85
    v_exp_f32 v86, v86
    v_exp_f32 v87, v87
    v_exp_f32 v88, v88
    v_exp_f32 v89, v89
    v_exp_f32 v90, v90
    v_exp_f32 v91, v91
    v_exp_f32 v94, v94
    v_exp_f32 v95, v95
    v_cvt_pk_bf16_f32 v52, v84, v85
    v_cvt_pk_bf16_f32 v53, v86, v87
    v_cvt_pk_bf16_f32 v54, v88, v89
    v_cvt_pk_bf16_f32 v55, v90, v91
    v_cvt_pk_bf16_f32 v136, v94, v95
    v_cvt_pk_bf16_f32 v137, v94, v95
    v_mfma_f32_16x16x32_bf16 v[96:99], v[10:13], v[52:55], 0
    v_mfma_f32_16x16x32_bf16 v[76:79], v[140:143], v[52:55], 0
    v_mfma_f32_16x16x32_bf16 v[80:83], v[144:147], v[52:55], 0
    s_nop 3
    v_mfma_f32_16x16x16_bf16 v[96:99], v[2:3], v[136:137], v[96:99]
    v_mfma_f32_16x16x16_bf16 v[76:79], v[132:133], v[136:137], v[76:79]
    v_mfma_f32_16x16x16_bf16 v[80:83], v[134:135], v[136:137], v[80:83]
    s_nop 5
    v_rcp_f32 v32, v96
    s_nop 0
    v_mul_f32 v148, v76, v32
    v_mul_f32 v149, v77, v32
    v_mul_f32 v150, v78, v32
    v_mul_f32 v151, v79, v32
    v_cvt_pk_bf16_f32 v64, v148, v149
    v_cvt_pk_bf16_f32 v65, v150, v151
    ds_write_b64 v24, v[64:65]
    v_mul_f32 v148, v80, v32
    v_mul_f32 v149, v81, v32
    v_mul_f32 v150, v82, v32
    v_mul_f32 v151, v83, v32
    v_cvt_pk_bf16_f32 v66, v148, v149
    v_cvt_pk_bf16_f32 v67, v150, v151
    s_branch CS1_BF
C_LAST0:
    s_add_u32 s55, s59, 4096
    buffer_store_dword v21, v35, s[8:11], s55 offen sc1
    s_branch C_LAST
C_LAST1:
    s_add_u32 s55, s59, 2048
    buffer_store_dword v22, v35, s[8:11], s55 offen offset:256 sc1
C_LAST:
    s_waitcnt vmcnt(0)
    s_barrier
    s_or_b32 s21, s35, 128
    v_mov_b32 v32, s21
    buffer_store_dword v32, v5, s[8:11], s37 offen sc1
C_DONE:
    s_waitcnt vmcnt(0)
    s_endpgm
C_FAIL:
    v_mov_b32 v32, s20
    v_add_u32 v32, 0x1000, v32
    s_mov_b64 exec, 1
    buffer_store_dword v32, off, s[12:15], 0 offset:20 sc1
    s_waitcnt vmcnt(0)
    s_endpgm
K_EXIT:
    s_endpgm
K_CODE_END:
.section .rodata,"a"
.p2align 6
.amdhsa_kernel gated_mix__memory_aug_recurrent_mem_tr__glu_gated_bilinear__prompt_kernel
  .amdhsa_next_free_vgpr 512
  .amdhsa_next_free_sgpr 102
  .amdhsa_accum_offset 256
  .amdhsa_group_segment_fixed_size 0
  .amdhsa_kernarg_size 120
  .amdhsa_user_sgpr_count 2
  .amdhsa_user_sgpr_kernarg_segment_ptr 1
  .amdhsa_system_sgpr_workgroup_id_x 1
.end_amdhsa_kernel
```
